```python
import torch

def _softmax(x, axis=-1):
    return torch.softmax(x, dim=axis)
def _gelu(x):
    return torch.nn.functional.gelu(x, approximate="tanh")
def _silu(x):
    return torch.nn.functional.silu(x)
def _sigmoid(x):
    return torch.sigmoid(x)
def _layernorm(x, axis=-1, eps=1e-5):
    m = x.mean(dim=axis, keepdim=True)
    v = x.var(dim=axis, keepdim=True, unbiased=False)
    return (x - m) / torch.sqrt(v + eps)
def _scatter_add(tgt, idx, src, axis=0):
    return tgt.clone().index_add_(axis, idx, src)
def _segment_sum(src, seg, n):
    out = torch.zeros((n,) + src.shape[1:], dtype=src.dtype)
    return out.index_add_(0, seg, src)
def _pad(x, pw):
    flat = tuple(v for pair in reversed(pw) for v in pair)
    return torch.nn.functional.pad(x, flat)

kernel_name = 'gated_mix__mha_block__linear_attn_block__prompt'

def setup_inputs():

    _w = (lambda a: (lambda t: t.to(torch.bfloat16) if t.is_floating_point() else t)(torch.as_tensor(a)))
    def _A_setup():
        B, S, D, H = 1, 2048, 576, 32
        return {
            "x": _w((lambda *s: torch.randn(*s, dtype=torch.bfloat16) * 0.05)(B, S, D)),
            "wqkv": _w((lambda *s: torch.randn(*s, dtype=torch.bfloat16) * 0.8)(D, 3 * D)),
            "wo": _w((lambda *s: torch.randn(*s, dtype=torch.bfloat16) * 0.05)(D, D)),
        }
    _A_in = _A_setup()

    def _B_setup():
        B, S, D = 1, 2048, 576
        return {
            "x": _w((lambda *s: torch.randn(*s, dtype=torch.bfloat16) * 0.05)(B, S, D)),
            "wqkv": _w((lambda *s: torch.randn(*s, dtype=torch.bfloat16) * 0.8)(D, 3 * D)),
            "wo": _w((lambda *s: torch.randn(*s, dtype=torch.bfloat16) * 0.1)(D, D)),
        }
    _B_in = _B_setup()

    return {
        "A_x": _A_in["x"],
        "A_wqkv": _A_in["wqkv"],
        "A_wo": _A_in["wo"],
        "B_x": _B_in["x"],
        "B_wqkv": _B_in["wqkv"],
        "B_wo": _B_in["wo"],
        "gate_w": _w((lambda *s: torch.randn(*s, dtype=torch.bfloat16) * 0.05)(576) * 16.0),
    }

def reference(A_x, A_wqkv, A_wo, B_x, B_wqkv, B_wo, gate_w):
    def _A_ref(x, wqkv, wo):
        B, S, D = x.shape
        H = 32
        Dh = D // H
        qkv = (lambda x, *d: x.permute(*d))((x @ wqkv).reshape(B, S, 3, H, Dh), 2, 0, 3, 1, 4)
        q, k, v = qkv[0], qkv[1], qkv[2]
        scores = torch.einsum("bhqd,bhkd->bhqk", q, k) * (Dh ** -0.5)
        p = _softmax(scores, axis=-1)
        o = torch.einsum("bhqk,bhkd->bhqd", p, v)
        return (lambda x, *d: x.permute(*d))(o, 0, 2, 1, 3).reshape(B, S, D) @ wo

    def _B_ref(x, wqkv, wo):
        B, S, D = x.shape
        H = 32; Dh = D // H
        qkv = (lambda x, *d: x.permute(*d))((x @ wqkv).reshape(B, S, 3, H, Dh), 2, 0, 3, 1, 4)
        q, k, v = qkv[0], qkv[1], qkv[2]
        phi = lambda t: torch.where(t > 0, t + 1, torch.exp(t)) + 1e-6
        pq, pk = phi(q), phi(k)
        kv = torch.einsum("bhsd,bhse->bhde", pk, v)
        z = torch.einsum("bhsd->bhd", pk)
        num = torch.einsum("bhqd,bhde->bhqe", pq, kv)
        den = torch.einsum("bhqd,bhd->bhq", pq, z)[..., None] + 1e-6
        o = num / den
        return (lambda x, *d: x.permute(*d))(o, 0, 2, 1, 3).reshape(B, S, D) @ wo

    x = A_x
    g = _sigmoid((x * gate_w).sum(-1, keepdims=True))
    a = _A_ref(x, A_wqkv, A_wo)
    b = _B_ref(x, B_wqkv, B_wo)
    return g * a + (1 - g) * b
```

```asm
; @launch kernel=k1_kernel grid=(256,1,1) block=(512,1,1) lds=149504
; @launch kernel=k2_kernel grid=(256,1,1) block=(512,1,1) lds=155648
.amdgcn_target "amdgcn-amd-amdhsa--gfx950"
.text
.globl k1_kernel
.type k1_kernel,@function
.globl k2_kernel
.type k2_kernel,@function
.p2align 8
k1_kernel:
    s_cmp_ge_u32 s2, 256
    s_cbranch_scc1 L_k1_end

    s_load_dwordx2 s[4:5], s[0:1], 0
    s_load_dwordx2 s[36:37], s[0:1], 8
    s_load_dwordx2 s[38:39], s[0:1], 32
    s_load_dwordx2 s[16:17], s[0:1], 48
    s_load_dwordx2 s[12:13], s[0:1], 72
    v_lshrrev_b32 v2, 6, v0
    v_and_b32 v1, 63, v0
    v_readfirstlane_b32 s20, v2
    s_and_b32 s21, s2, 7
    s_lshr_b32 s33, s2, 3

    s_and_b32 s22, s33, 15
    s_lshr_b32 s25, s33, 4
    s_mov_b32 s47, s21
    s_or_b32 s34, s21, s25

    s_lshr_b32 s41, s20, 2
    s_and_b32 s20, s20, 3
    s_mov_b32 s6, 2359296
    s_mov_b32 s7, 0x00020000
    s_mov_b32 s10, 1990656
    s_mov_b32 s11, 0x00020000
    s_mov_b32 s14, 17825792
    s_mov_b32 s15, 0x00020000
    s_mov_b32 s18, 1152
    s_mov_b32 s19, 0x00020000
    s_cmp_eq_u32 s41, 0
    s_cbranch_scc1 L_k1_compute

L_k1_loader:
    v_lshrrev_b32 v2, 3, v1
    v_mul_u32_u24 v10, 1152, v2
    v_lshrrev_b32 v3, 4, v1
    v_and_b32 v4, 7, v1
    v_xor_b32 v3, v3, v4
    v_xor_b32 v4, 4, v3
    v_lshl_add_u32 v11, v4, 4, v10
    v_lshl_add_u32 v10, v3, 4, v10
    s_lshl_b32 s33, s22, 7
    s_lshl_b32 s34, s20, 5
    s_add_u32 s33, s33, s34
    s_mul_i32 s26, s33, 1152
    s_add_u32 s27, s26, 9216
    s_add_u32 s28, s26, 18432
    s_add_u32 s29, s26, 27648
    s_lshl_b32 s31, s20, 12
    s_add_u32 s32, s31, 51200
    s_add_u32 s31, s31, 2048
    s_and_b32 s73, s47, 3
    s_lshl_b32 s73, s73, 1
    s_and_b32 s33, s22, 7
    s_add_u32 s73, s73, s33
    s_mul_i32 s33, s25, 4
    s_add_u32 s73, s73, s33
    s_sub_u32 s33, s73, 9
    s_cmp_ge_u32 s73, 9
    s_cselect_b32 s73, s33, s73
    s_sub_u32 s33, s73, 9
    s_cmp_ge_u32 s73, 9
    s_cselect_b32 s73, s33, s73
    s_lshl_b32 s70, s73, 7
    s_waitcnt lgkmcnt(0)

    s_add_u32 m0, s31, 0
    s_add_u32 s71, s26, s70
    buffer_load_dwordx4 v10, s[4:7], s71 offen lds
    s_add_u32 m0, s31, 1024
    s_add_u32 s71, s27, s70
    buffer_load_dwordx4 v11, s[4:7], s71 offen lds
    s_add_u32 m0, s31, 2048
    s_add_u32 s71, s28, s70
    buffer_load_dwordx4 v10, s[4:7], s71 offen lds
    s_add_u32 m0, s31, 3072
    s_add_u32 s71, s29, s70
    buffer_load_dwordx4 v11, s[4:7], s71 offen lds
    s_add_u32 s70, s70, 128
    s_cmp_eq_u32 s70, 1152
    s_cselect_b32 s70, 0, s70
    v_lshrrev_b32 v2, 3, v1
    v_and_b32 v9, 7, v1
    s_lshl_b32 s33, s20, 4
    s_lshl_b32 s34, s73, 1

    v_add_u32 v2, s34, v2
    v_add_u32 v3, 0, v2
    v_subrev_u32 v4, 18, v3
    v_min_u32 v3, v3, v4
    v_subrev_u32 v4, 18, v3
    v_min_u32 v3, v3, v4
    v_lshlrev_b32 v3, 6, v3
    v_lshl_add_u32 v3, v9, 1, v3
    buffer_load_ushort v34, v3, s[16:19], s33 offen

    v_add_u32 v3, 8, v2
    v_subrev_u32 v4, 18, v3
    v_min_u32 v3, v3, v4
    v_subrev_u32 v4, 18, v3
    v_min_u32 v3, v3, v4
    v_lshlrev_b32 v3, 6, v3
    v_lshl_add_u32 v3, v9, 1, v3
    buffer_load_ushort v35, v3, s[16:19], s33 offen

    v_add_u32 v3, 16, v2
    v_subrev_u32 v4, 18, v3
    v_min_u32 v3, v3, v4
    v_subrev_u32 v4, 18, v3
    v_min_u32 v3, v3, v4
    v_lshlrev_b32 v3, 6, v3
    v_lshl_add_u32 v3, v9, 1, v3
    buffer_load_ushort v36, v3, s[16:19], s33 offen

    s_cmp_eq_u32 s25, 0
    s_cselect_b32 s8, s36, s38
    s_cselect_b32 s9, s37, s39
    s_and_b32 s33, s20, 1
    s_lshl_b32 s33, s33, 3
    v_lshrrev_b32 v2, 5, v1
    v_bfe_u32 v6, v1, 4, 1
    v_mul_u32_u24 v7, 3456, v2
    v_lshl_add_u32 v7, v6, 6, v7
    v_lshlrev_b32 v2, 1, v2
    v_add_u32 v2, s33, v2
    v_and_b32 v4, 15, v1
    v_xor_b32 v2, v2, v4

    v_xor_b32 v3, 0, v2
    v_mul_u32_u24 v4, 52, v3
    v_lshrrev_b32 v4, 8, v4
    v_mul_u32_u24 v5, 5, v4
    v_sub_u32 v5, v3, v5
    v_mul_u32_u24 v4, 1152, v4
    v_add_u32 v4, v4, v7
    v_lshl_add_u32 v4, v5, 4, v4
    v_cmp_ne_u32 s[42:43], 15, v3
    v_add_u32 v30, 0, v4
    v_add_u32 v32, 11776, v4

    v_xor_b32 v3, 4, v2
    v_mul_u32_u24 v4, 52, v3
    v_lshrrev_b32 v4, 8, v4
    v_mul_u32_u24 v5, 5, v4
    v_sub_u32 v5, v3, v5
    v_mul_u32_u24 v4, 1152, v4
    v_add_u32 v4, v4, v7
    v_lshl_add_u32 v4, v5, 4, v4
    v_cmp_ne_u32 s[44:45], 15, v3
    v_add_u32 v31, 5888, v4
    v_add_u32 v33, 17664, v4

    s_mul_i32 s30, s20, 27648
    s_mul_i32 s33, s47, 144
    s_add_u32 s30, s30, s33
    s_add_u32 s72, s30, 1990656
    s_mul_i32 s33, s73, 221184
    s_add_u32 s30, s30, s33

    s_add_u32 m0, s32, 0
    s_mov_b64 exec, s[42:43]
    buffer_load_dwordx4 v30, s[8:11], s30 offen offset:0 lds
    buffer_load_dwordx4 v32, s[8:11], s30 offen offset:2048 lds
    s_mov_b64 exec, s[44:45]
    buffer_load_dwordx4 v31, s[8:11], s30 offen offset:1024 lds
    buffer_load_dwordx4 v33, s[8:11], s30 offen offset:3072 lds
    s_add_u32 s30, s30, 110592
    s_add_u32 m0, s32, 16384
    s_mov_b64 exec, s[42:43]
    buffer_load_dwordx4 v30, s[8:11], s30 offen offset:0 lds
    buffer_load_dwordx4 v32, s[8:11], s30 offen offset:2048 lds
    s_mov_b64 exec, s[44:45]
    buffer_load_dwordx4 v31, s[8:11], s30 offen offset:1024 lds
    buffer_load_dwordx4 v33, s[8:11], s30 offen offset:3072 lds
    s_add_u32 s30, s30, 110592
    s_sub_u32 s71, s30, 1990656
    s_cmp_eq_u32 s30, s72
    s_cselect_b32 s30, s71, s30
    s_mov_b64 exec, -1
    s_and_b32 s33, s20, 1
    s_lshl_b32 s33, s33, 7
    s_xor_b32 s33, s33, 240
    v_and_b32 v2, 3, v9
    v_lshlrev_b32 v2, 5, v2
    v_xor_b32 v2, s33, v2
    v_lshl_add_u32 v2, v9, 9, v2
    v_add_u32 v37, s32, v2
    v_add_u32 v38, 49152, v37

    s_waitcnt vmcnt(8)
    s_mov_b32 exec_lo, 0x000000ff
    s_mov_b32 exec_hi, 0x00000000
    ds_write_b16 v37, v34 offset:0
    s_mov_b64 exec, -1
    s_mov_b32 exec_lo, 0x0000ff00
    s_mov_b32 exec_hi, 0x00000000
    ds_write_b16 v37, v34 offset:16384
    s_mov_b64 exec, -1
    s_mov_b32 exec_lo, 0x00ff0000
    s_mov_b32 exec_hi, 0x00000000
    ds_write_b16 v37, v34 offset:32768
    s_mov_b64 exec, -1
    s_mov_b32 exec_lo, 0xff000000
    s_mov_b32 exec_hi, 0x00000000
    ds_write_b16 v38, v34 offset:0
    s_mov_b64 exec, -1
    s_mov_b32 exec_lo, 0x00000000
    s_mov_b32 exec_hi, 0x000000ff
    ds_write_b16 v38, v34 offset:16384
    s_mov_b64 exec, -1
    s_mov_b32 exec_lo, 0x00000000
    s_mov_b32 exec_hi, 0x0000ff00
    ds_write_b16 v38, v34 offset:32768
    s_mov_b64 exec, -1
    s_add_u32 m0, s31, 16384
    s_add_u32 s71, s26, s70
    buffer_load_dwordx4 v10, s[4:7], s71 offen lds
    s_add_u32 m0, s31, 17408
    s_add_u32 s71, s27, s70
    buffer_load_dwordx4 v11, s[4:7], s71 offen lds
    s_add_u32 m0, s31, 18432
    s_add_u32 s71, s28, s70
    buffer_load_dwordx4 v10, s[4:7], s71 offen lds
    s_add_u32 m0, s31, 19456
    s_add_u32 s71, s29, s70
    buffer_load_dwordx4 v11, s[4:7], s71 offen lds
    s_add_u32 s70, s70, 128
    s_cmp_eq_u32 s70, 1152
    s_cselect_b32 s70, 0, s70
    s_add_u32 m0, s32, 32768
    s_mov_b64 exec, s[42:43]
    buffer_load_dwordx4 v30, s[8:11], s30 offen offset:0 lds
    buffer_load_dwordx4 v32, s[8:11], s30 offen offset:2048 lds
    s_mov_b64 exec, s[44:45]
    buffer_load_dwordx4 v31, s[8:11], s30 offen offset:1024 lds
    buffer_load_dwordx4 v33, s[8:11], s30 offen offset:3072 lds
    s_add_u32 s30, s30, 110592
    s_mov_b64 exec, -1
    s_add_u32 m0, s32, 49152
    s_mov_b64 exec, s[42:43]
    buffer_load_dwordx4 v30, s[8:11], s30 offen offset:0 lds
    buffer_load_dwordx4 v32, s[8:11], s30 offen offset:2048 lds
    s_mov_b64 exec, s[44:45]
    buffer_load_dwordx4 v31, s[8:11], s30 offen offset:1024 lds
    buffer_load_dwordx4 v33, s[8:11], s30 offen offset:3072 lds
    s_add_u32 s30, s30, 110592
    s_sub_u32 s71, s30, 1990656
    s_cmp_eq_u32 s30, s72
    s_cselect_b32 s30, s71, s30
    s_mov_b64 exec, -1
    s_waitcnt vmcnt(12) lgkmcnt(0)
    s_barrier
    s_add_u32 m0, s31, 32768
    s_add_u32 s71, s26, s70
    buffer_load_dwordx4 v10, s[4:7], s71 offen lds
    s_add_u32 m0, s31, 33792
    s_add_u32 s71, s27, s70
    buffer_load_dwordx4 v11, s[4:7], s71 offen lds
    s_add_u32 m0, s31, 34816
    s_add_u32 s71, s28, s70
    buffer_load_dwordx4 v10, s[4:7], s71 offen lds
    s_add_u32 m0, s31, 35840
    s_add_u32 s71, s29, s70
    buffer_load_dwordx4 v11, s[4:7], s71 offen lds
    s_add_u32 s70, s70, 128
    s_cmp_eq_u32 s70, 1152
    s_cselect_b32 s70, 0, s70
    s_add_u32 m0, s32, 65536
    s_mov_b64 exec, s[42:43]
    buffer_load_dwordx4 v30, s[8:11], s30 offen offset:0 lds
    buffer_load_dwordx4 v32, s[8:11], s30 offen offset:2048 lds
    s_mov_b64 exec, s[44:45]
    buffer_load_dwordx4 v31, s[8:11], s30 offen offset:1024 lds
    buffer_load_dwordx4 v33, s[8:11], s30 offen offset:3072 lds
    s_add_u32 s30, s30, 110592
    s_mov_b64 exec, -1
    s_add_u32 m0, s32, 81920
    s_mov_b64 exec, s[42:43]
    buffer_load_dwordx4 v30, s[8:11], s30 offen offset:0 lds
    buffer_load_dwordx4 v32, s[8:11], s30 offen offset:2048 lds
    s_mov_b64 exec, s[44:45]
    buffer_load_dwordx4 v31, s[8:11], s30 offen offset:1024 lds
    buffer_load_dwordx4 v33, s[8:11], s30 offen offset:3072 lds
    s_add_u32 s30, s30, 110592
    s_sub_u32 s71, s30, 1990656
    s_cmp_eq_u32 s30, s72
    s_cselect_b32 s30, s71, s30
    s_mov_b64 exec, -1
    s_waitcnt vmcnt(12) lgkmcnt(0)
    s_barrier
    s_add_u32 m0, s31, 0
    s_add_u32 s71, s26, s70
    buffer_load_dwordx4 v10, s[4:7], s71 offen lds
    s_add_u32 m0, s31, 1024
    s_add_u32 s71, s27, s70
    buffer_load_dwordx4 v11, s[4:7], s71 offen lds
    s_add_u32 m0, s31, 2048
    s_add_u32 s71, s28, s70
    buffer_load_dwordx4 v10, s[4:7], s71 offen lds
    s_add_u32 m0, s31, 3072
    s_add_u32 s71, s29, s70
    buffer_load_dwordx4 v11, s[4:7], s71 offen lds
    s_add_u32 s70, s70, 128
    s_cmp_eq_u32 s70, 1152
    s_cselect_b32 s70, 0, s70
    s_add_u32 m0, s32, 0
    s_mov_b64 exec, s[42:43]
    buffer_load_dwordx4 v30, s[8:11], s30 offen offset:0 lds
    buffer_load_dwordx4 v32, s[8:11], s30 offen offset:2048 lds
    s_mov_b64 exec, s[44:45]
    buffer_load_dwordx4 v31, s[8:11], s30 offen offset:1024 lds
    buffer_load_dwordx4 v33, s[8:11], s30 offen offset:3072 lds
    s_add_u32 s30, s30, 110592
    s_mov_b32 exec_lo, 0x00000000
    s_mov_b32 exec_hi, 0x00ff0000
    ds_write_b16 v37, v34 offset:0
    s_mov_b64 exec, -1
    s_add_u32 m0, s32, 16384
    s_mov_b64 exec, s[42:43]
    buffer_load_dwordx4 v30, s[8:11], s30 offen offset:0 lds
    buffer_load_dwordx4 v32, s[8:11], s30 offen offset:2048 lds
    s_mov_b64 exec, s[44:45]
    buffer_load_dwordx4 v31, s[8:11], s30 offen offset:1024 lds
    buffer_load_dwordx4 v33, s[8:11], s30 offen offset:3072 lds
    s_add_u32 s30, s30, 110592
    s_sub_u32 s71, s30, 1990656
    s_cmp_eq_u32 s30, s72
    s_cselect_b32 s30, s71, s30
    s_mov_b32 exec_lo, 0x00000000
    s_mov_b32 exec_hi, 0xff000000
    ds_write_b16 v37, v34 offset:16384
    s_mov_b64 exec, -1
    s_waitcnt vmcnt(12) lgkmcnt(0)
    s_barrier
    s_add_u32 m0, s31, 16384
    s_add_u32 s71, s26, s70
    buffer_load_dwordx4 v10, s[4:7], s71 offen lds
    s_add_u32 m0, s31, 17408
    s_add_u32 s71, s27, s70
    buffer_load_dwordx4 v11, s[4:7], s71 offen lds
    s_add_u32 m0, s31, 18432
    s_add_u32 s71, s28, s70
    buffer_load_dwordx4 v10, s[4:7], s71 offen lds
    s_add_u32 m0, s31, 19456
    s_add_u32 s71, s29, s70
    buffer_load_dwordx4 v11, s[4:7], s71 offen lds
    s_add_u32 s70, s70, 128
    s_cmp_eq_u32 s70, 1152
    s_cselect_b32 s70, 0, s70
    s_add_u32 m0, s32, 32768
    s_mov_b64 exec, s[42:43]
    buffer_load_dwordx4 v30, s[8:11], s30 offen offset:0 lds
    buffer_load_dwordx4 v32, s[8:11], s30 offen offset:2048 lds
    s_mov_b64 exec, s[44:45]
    buffer_load_dwordx4 v31, s[8:11], s30 offen offset:1024 lds
    buffer_load_dwordx4 v33, s[8:11], s30 offen offset:3072 lds
    s_add_u32 s30, s30, 110592
    s_mov_b32 exec_lo, 0x000000ff
    s_mov_b32 exec_hi, 0x00000000
    ds_write_b16 v37, v35 offset:32768
    s_mov_b64 exec, -1
    s_add_u32 m0, s32, 49152
    s_mov_b64 exec, s[42:43]
    buffer_load_dwordx4 v30, s[8:11], s30 offen offset:0 lds
    buffer_load_dwordx4 v32, s[8:11], s30 offen offset:2048 lds
    s_mov_b64 exec, s[44:45]
    buffer_load_dwordx4 v31, s[8:11], s30 offen offset:1024 lds
    buffer_load_dwordx4 v33, s[8:11], s30 offen offset:3072 lds
    s_add_u32 s30, s30, 110592
    s_sub_u32 s71, s30, 1990656
    s_cmp_eq_u32 s30, s72
    s_cselect_b32 s30, s71, s30
    s_mov_b32 exec_lo, 0x0000ff00
    s_mov_b32 exec_hi, 0x00000000
    ds_write_b16 v38, v35 offset:0
    s_mov_b64 exec, -1
    s_waitcnt vmcnt(12) lgkmcnt(0)
    s_barrier
    s_add_u32 m0, s31, 32768
    s_add_u32 s71, s26, s70
    buffer_load_dwordx4 v10, s[4:7], s71 offen lds
    s_add_u32 m0, s31, 33792
    s_add_u32 s71, s27, s70
    buffer_load_dwordx4 v11, s[4:7], s71 offen lds
    s_add_u32 m0, s31, 34816
    s_add_u32 s71, s28, s70
    buffer_load_dwordx4 v10, s[4:7], s71 offen lds
    s_add_u32 m0, s31, 35840
    s_add_u32 s71, s29, s70
    buffer_load_dwordx4 v11, s[4:7], s71 offen lds
    s_add_u32 s70, s70, 128
    s_cmp_eq_u32 s70, 1152
    s_cselect_b32 s70, 0, s70
    s_add_u32 m0, s32, 65536
    s_mov_b64 exec, s[42:43]
    buffer_load_dwordx4 v30, s[8:11], s30 offen offset:0 lds
    buffer_load_dwordx4 v32, s[8:11], s30 offen offset:2048 lds
    s_mov_b64 exec, s[44:45]
    buffer_load_dwordx4 v31, s[8:11], s30 offen offset:1024 lds
    buffer_load_dwordx4 v33, s[8:11], s30 offen offset:3072 lds
    s_add_u32 s30, s30, 110592
    s_mov_b32 exec_lo, 0x00ff0000
    s_mov_b32 exec_hi, 0x00000000
    ds_write_b16 v38, v35 offset:16384
    s_mov_b64 exec, -1
    s_add_u32 m0, s32, 81920
    s_mov_b64 exec, s[42:43]
    buffer_load_dwordx4 v30, s[8:11], s30 offen offset:0 lds
    buffer_load_dwordx4 v32, s[8:11], s30 offen offset:2048 lds
    s_mov_b64 exec, s[44:45]
    buffer_load_dwordx4 v31, s[8:11], s30 offen offset:1024 lds
    buffer_load_dwordx4 v33, s[8:11], s30 offen offset:3072 lds
    s_add_u32 s30, s30, 110592
    s_sub_u32 s71, s30, 1990656
    s_cmp_eq_u32 s30, s72
    s_cselect_b32 s30, s71, s30
    s_mov_b32 exec_lo, 0xff000000
    s_mov_b32 exec_hi, 0x00000000
    ds_write_b16 v38, v35 offset:32768
    s_mov_b64 exec, -1
    s_waitcnt vmcnt(12) lgkmcnt(0)
    s_barrier
    s_add_u32 m0, s31, 0
    s_add_u32 s71, s26, s70
    buffer_load_dwordx4 v10, s[4:7], s71 offen lds
    s_add_u32 m0, s31, 1024
    s_add_u32 s71, s27, s70
    buffer_load_dwordx4 v11, s[4:7], s71 offen lds
    s_add_u32 m0, s31, 2048
    s_add_u32 s71, s28, s70
    buffer_load_dwordx4 v10, s[4:7], s71 offen lds
    s_add_u32 m0, s31, 3072
    s_add_u32 s71, s29, s70
    buffer_load_dwordx4 v11, s[4:7], s71 offen lds
    s_add_u32 s70, s70, 128
    s_cmp_eq_u32 s70, 1152
    s_cselect_b32 s70, 0, s70
    s_add_u32 m0, s32, 0
    s_mov_b64 exec, s[42:43]
    buffer_load_dwordx4 v30, s[8:11], s30 offen offset:0 lds
    buffer_load_dwordx4 v32, s[8:11], s30 offen offset:2048 lds
    s_mov_b64 exec, s[44:45]
    buffer_load_dwordx4 v31, s[8:11], s30 offen offset:1024 lds
    buffer_load_dwordx4 v33, s[8:11], s30 offen offset:3072 lds
    s_add_u32 s30, s30, 110592
    s_mov_b32 exec_lo, 0x00000000
    s_mov_b32 exec_hi, 0x000000ff
    ds_write_b16 v37, v35 offset:0
    s_mov_b64 exec, -1
    s_add_u32 m0, s32, 16384
    s_mov_b64 exec, s[42:43]
    buffer_load_dwordx4 v30, s[8:11], s30 offen offset:0 lds
    buffer_load_dwordx4 v32, s[8:11], s30 offen offset:2048 lds
    s_mov_b64 exec, s[44:45]
    buffer_load_dwordx4 v31, s[8:11], s30 offen offset:1024 lds
    buffer_load_dwordx4 v33, s[8:11], s30 offen offset:3072 lds
    s_add_u32 s30, s30, 110592
    s_sub_u32 s71, s30, 1990656
    s_cmp_eq_u32 s30, s72
    s_cselect_b32 s30, s71, s30
    s_mov_b32 exec_lo, 0x00000000
    s_mov_b32 exec_hi, 0x0000ff00
    ds_write_b16 v37, v35 offset:16384
    s_mov_b64 exec, -1
    s_waitcnt vmcnt(12) lgkmcnt(0)
    s_barrier
    s_add_u32 m0, s31, 16384
    s_add_u32 s71, s26, s70
    buffer_load_dwordx4 v10, s[4:7], s71 offen lds
    s_add_u32 m0, s31, 17408
    s_add_u32 s71, s27, s70
    buffer_load_dwordx4 v11, s[4:7], s71 offen lds
    s_add_u32 m0, s31, 18432
    s_add_u32 s71, s28, s70
    buffer_load_dwordx4 v10, s[4:7], s71 offen lds
    s_add_u32 m0, s31, 19456
    s_add_u32 s71, s29, s70
    buffer_load_dwordx4 v11, s[4:7], s71 offen lds
    s_add_u32 s70, s70, 128
    s_cmp_eq_u32 s70, 1152
    s_cselect_b32 s70, 0, s70
    s_add_u32 m0, s32, 32768
    s_mov_b64 exec, s[42:43]
    buffer_load_dwordx4 v30, s[8:11], s30 offen offset:0 lds
    buffer_load_dwordx4 v32, s[8:11], s30 offen offset:2048 lds
    s_mov_b64 exec, s[44:45]
    buffer_load_dwordx4 v31, s[8:11], s30 offen offset:1024 lds
    buffer_load_dwordx4 v33, s[8:11], s30 offen offset:3072 lds
    s_add_u32 s30, s30, 110592
    s_mov_b32 exec_lo, 0x00000000
    s_mov_b32 exec_hi, 0x00ff0000
    ds_write_b16 v37, v35 offset:32768
    s_mov_b64 exec, -1
    s_add_u32 m0, s32, 49152
    s_mov_b64 exec, s[42:43]
    buffer_load_dwordx4 v30, s[8:11], s30 offen offset:0 lds
    buffer_load_dwordx4 v32, s[8:11], s30 offen offset:2048 lds
    s_mov_b64 exec, s[44:45]
    buffer_load_dwordx4 v31, s[8:11], s30 offen offset:1024 lds
    buffer_load_dwordx4 v33, s[8:11], s30 offen offset:3072 lds
    s_add_u32 s30, s30, 110592
    s_sub_u32 s71, s30, 1990656
    s_cmp_eq_u32 s30, s72
    s_cselect_b32 s30, s71, s30
    s_mov_b32 exec_lo, 0x00000000
    s_mov_b32 exec_hi, 0xff000000
    ds_write_b16 v38, v35 offset:0
    s_mov_b64 exec, -1
    s_waitcnt vmcnt(12) lgkmcnt(0)
    s_barrier
    s_add_u32 m0, s31, 32768
    s_add_u32 s71, s26, s70
    buffer_load_dwordx4 v10, s[4:7], s71 offen lds
    s_add_u32 m0, s31, 33792
    s_add_u32 s71, s27, s70
    buffer_load_dwordx4 v11, s[4:7], s71 offen lds
    s_add_u32 m0, s31, 34816
    s_add_u32 s71, s28, s70
    buffer_load_dwordx4 v10, s[4:7], s71 offen lds
    s_add_u32 m0, s31, 35840
    s_add_u32 s71, s29, s70
    buffer_load_dwordx4 v11, s[4:7], s71 offen lds
    s_add_u32 s70, s70, 128
    s_cmp_eq_u32 s70, 1152
    s_cselect_b32 s70, 0, s70
    s_add_u32 m0, s32, 65536
    s_mov_b64 exec, s[42:43]
    buffer_load_dwordx4 v30, s[8:11], s30 offen offset:0 lds
    buffer_load_dwordx4 v32, s[8:11], s30 offen offset:2048 lds
    s_mov_b64 exec, s[44:45]
    buffer_load_dwordx4 v31, s[8:11], s30 offen offset:1024 lds
    buffer_load_dwordx4 v33, s[8:11], s30 offen offset:3072 lds
    s_add_u32 s30, s30, 110592
    s_mov_b32 exec_lo, 0x000000ff
    s_mov_b32 exec_hi, 0x00000000
    ds_write_b16 v38, v36 offset:16384
    s_mov_b64 exec, -1
    s_add_u32 m0, s32, 81920
    s_mov_b64 exec, s[42:43]
    buffer_load_dwordx4 v30, s[8:11], s30 offen offset:0 lds
    buffer_load_dwordx4 v32, s[8:11], s30 offen offset:2048 lds
    s_mov_b64 exec, s[44:45]
    buffer_load_dwordx4 v31, s[8:11], s30 offen offset:1024 lds
    buffer_load_dwordx4 v33, s[8:11], s30 offen offset:3072 lds
    s_add_u32 s30, s30, 110592
    s_sub_u32 s71, s30, 1990656
    s_cmp_eq_u32 s30, s72
    s_cselect_b32 s30, s71, s30
    s_mov_b32 exec_lo, 0x0000ff00
    s_mov_b32 exec_hi, 0x00000000
    ds_write_b16 v38, v36 offset:32768
    s_mov_b64 exec, -1
    s_waitcnt vmcnt(12) lgkmcnt(0)
    s_barrier
    s_waitcnt vmcnt(0) lgkmcnt(0)
    s_barrier
    s_endpgm
L_k1_compute:
    s_and_b32 s35, s20, 1
    s_or_b32 s34, s34, s35
    s_cmp_eq_u32 s34, 0
    s_cselect_b32 s3, 1, 0
    s_lshl_b32 s24, s47, 1
    s_add_u32 s24, s24, s35
    s_lshl_b32 s46, s22, 7
    s_lshr_b32 s33, s20, 1
    s_lshl_b32 s33, s33, 6
    s_add_u32 s46, s46, s33

    v_and_b32 v2, 15, v1
    v_lshrrev_b32 v3, 4, v1
    v_lshrrev_b32 v4, 1, v2
    v_xor_b32 v4, v4, v3
    v_lshlrev_b32 v4, 4, v4
    v_lshl_add_u32 v4, v2, 7, v4
    s_lshr_b32 s33, s20, 1
    s_lshl_b32 s33, s33, 13
    s_add_u32 s33, s33, 2048
    v_add_u32 v13, s33, v4
    v_xor_b32 v14, 64, v13
    s_and_b32 s34, s20, 1
    s_lshl_b32 s33, s34, 8
    s_add_u32 s33, s33, 51200
    s_lshl_b32 s34, s34, 3
    v_lshrrev_b32 v4, 2, v2
    v_and_b32 v5, 3, v1
    v_lshl_add_u32 v6, v3, 3, v4
    v_lshlrev_b32 v6, 9, v6
    v_add_u32 v6, s33, v6
    v_and_b32 v7, 1, v3
    v_lshl_add_u32 v7, v7, 2, v4
    v_lshlrev_b32 v7, 5, v7
    v_lshlrev_b32 v3, 3, v5
    v_add_u32 v3, s34, v3
    v_mul_u32_u24 v9, 80, v5
    v_add_u32 v9, s34, v9
    v_add_u32 v9, 32, v9
    v_min_u32 v9, 240, v9

    v_add_u32 v2, 0, v3
    v_xor_b32 v2, v2, v7
    v_add_u32 v15, v2, v6
    v_add_u32 v16, 49152, v15
    v_add_u32 v2, 40, v3
    v_xor_b32 v2, v2, v7
    v_add_u32 v17, v2, v6
    v_add_u32 v18, 49152, v17
    v_add_u32 v2, 80, v3
    v_xor_b32 v2, v2, v7
    v_add_u32 v19, v2, v6
    v_add_u32 v20, 49152, v19
    v_add_u32 v2, 120, v3
    v_xor_b32 v2, v2, v7
    v_add_u32 v21, v2, v6
    v_add_u32 v22, 49152, v21
    v_add_u32 v2, 160, v3
    v_xor_b32 v2, v2, v7
    v_add_u32 v23, v2, v6
    v_add_u32 v24, 49152, v23
    v_add_u32 v2, 200, v3
    v_xor_b32 v2, v2, v7
    v_add_u32 v25, v2, v6
    v_add_u32 v26, 49152, v25
    v_xor_b32 v2, v9, v7
    v_add_u32 v27, v2, v6
    v_add_u32 v28, 49152, v27
    s_waitcnt lgkmcnt(0)
    s_lshl_b32 s33, s20, 6
    s_add_u32 s33, s33, s2
    s_cmp_ge_u32 s33, 64
    s_cbranch_scc1 L_k1_noflag
    s_lshl_b32 s33, s2, 8
    s_add_u32 s33, s33, 7995392
    v_lshlrev_b32 v2, 2, v1
    v_mov_b32 v3, 0
    buffer_store_dword v3, v2, s[12:15], s33 offen

L_k1_noflag:
    s_barrier
    ds_read_b128 v[48:51], v13 offset:0
    ds_read_b64_tr_b16 v[80:81], v15 offset:0
    ds_read_b64_tr_b16 v[82:83], v15 offset:2048
    ds_read_b64_tr_b16 v[84:85], v17 offset:0
    ds_read_b64_tr_b16 v[86:87], v17 offset:2048
    ds_read_b64_tr_b16 v[88:89], v19 offset:0
    ds_read_b64_tr_b16 v[90:91], v19 offset:2048
    ds_read_b64_tr_b16 v[92:93], v21 offset:0
    ds_read_b64_tr_b16 v[94:95], v21 offset:2048
    ds_read_b64_tr_b16 v[96:97], v23 offset:0
    ds_read_b64_tr_b16 v[98:99], v23 offset:2048
    ds_read_b64_tr_b16 v[100:101], v25 offset:0
    ds_read_b64_tr_b16 v[102:103], v25 offset:2048
    ds_read_b64_tr_b16 v[104:105], v27 offset:0
    ds_read_b64_tr_b16 v[106:107], v27 offset:2048
    ds_read_b128 v[52:55], v13 offset:2048
    ds_read_b128 v[56:59], v13 offset:4096
    ds_read_b128 v[60:63], v13 offset:6144
    s_cmp_lg_u32 s25, 0
    s_cbranch_scc1 L_k1_B
    s_waitcnt lgkmcnt(0)
    v_mfma_f32_16x16x32_bf16 v[136:139], v[80:83], v[48:51], 0
    v_mfma_f32_16x16x32_bf16 v[140:143], v[84:87], v[48:51], 0
    v_mfma_f32_16x16x32_bf16 v[144:147], v[88:91], v[48:51], 0
    v_mfma_f32_16x16x32_bf16 v[148:151], v[92:95], v[48:51], 0
    v_mfma_f32_16x16x32_bf16 v[152:155], v[48:51], v[96:99], 0
    ds_read_b128 v[64:67], v14 offset:0
    v_mfma_f32_16x16x32_bf16 v[156:159], v[48:51], v[100:103], 0
    ds_read_b64_tr_b16 v[108:109], v15 offset:16384
    v_mfma_f32_16x16x32_bf16 v[160:163], v[48:51], v[104:107], 0
    ds_read_b64_tr_b16 v[110:111], v15 offset:18432
    v_mfma_f32_16x16x32_bf16 v[164:167], v[80:83], v[52:55], 0
    ds_read_b64_tr_b16 v[112:113], v17 offset:16384
    v_mfma_f32_16x16x32_bf16 v[168:171], v[84:87], v[52:55], 0
    ds_read_b64_tr_b16 v[114:115], v17 offset:18432
    v_mfma_f32_16x16x32_bf16 v[172:175], v[88:91], v[52:55], 0
    ds_read_b64_tr_b16 v[116:117], v19 offset:16384
    v_mfma_f32_16x16x32_bf16 v[176:179], v[92:95], v[52:55], 0
    ds_read_b64_tr_b16 v[118:119], v19 offset:18432
    v_mfma_f32_16x16x32_bf16 v[180:183], v[52:55], v[96:99], 0
    ds_read_b64_tr_b16 v[120:121], v21 offset:16384
    v_mfma_f32_16x16x32_bf16 v[184:187], v[52:55], v[100:103], 0
    ds_read_b64_tr_b16 v[122:123], v21 offset:18432
    v_mfma_f32_16x16x32_bf16 v[188:191], v[52:55], v[104:107], 0
    ds_read_b64_tr_b16 v[124:125], v23 offset:16384
    v_mfma_f32_16x16x32_bf16 v[192:195], v[80:83], v[56:59], 0
    ds_read_b64_tr_b16 v[126:127], v23 offset:18432
    v_mfma_f32_16x16x32_bf16 v[196:199], v[84:87], v[56:59], 0
    ds_read_b64_tr_b16 v[128:129], v25 offset:16384
    v_mfma_f32_16x16x32_bf16 v[200:203], v[88:91], v[56:59], 0
    ds_read_b64_tr_b16 v[130:131], v25 offset:18432
    v_mfma_f32_16x16x32_bf16 v[204:207], v[92:95], v[56:59], 0
    ds_read_b64_tr_b16 v[132:133], v27 offset:16384
    v_mfma_f32_16x16x32_bf16 v[208:211], v[56:59], v[96:99], 0
    ds_read_b64_tr_b16 v[134:135], v27 offset:18432
    v_mfma_f32_16x16x32_bf16 v[212:215], v[56:59], v[100:103], 0
    ds_read_b128 v[68:71], v14 offset:2048
    v_mfma_f32_16x16x32_bf16 v[216:219], v[56:59], v[104:107], 0
    ds_read_b128 v[72:75], v14 offset:4096
    v_mfma_f32_16x16x32_bf16 v[220:223], v[80:83], v[60:63], 0
    ds_read_b128 v[76:79], v14 offset:6144
    v_mfma_f32_16x16x32_bf16 v[224:227], v[84:87], v[60:63], 0
    v_mfma_f32_16x16x32_bf16 v[228:231], v[88:91], v[60:63], 0
    v_mfma_f32_16x16x32_bf16 v[232:235], v[92:95], v[60:63], 0
    v_mfma_f32_16x16x32_bf16 v[236:239], v[60:63], v[96:99], 0
    v_mfma_f32_16x16x32_bf16 v[240:243], v[60:63], v[100:103], 0
    v_mfma_f32_16x16x32_bf16 v[244:247], v[60:63], v[104:107], 0
    s_waitcnt lgkmcnt(0)
    v_mfma_f32_16x16x32_bf16 v[136:139], v[108:111], v[64:67], v[136:139]
    v_mfma_f32_16x16x32_bf16 v[140:143], v[112:115], v[64:67], v[140:143]
    v_mfma_f32_16x16x32_bf16 v[144:147], v[116:119], v[64:67], v[144:147]
    v_mfma_f32_16x16x32_bf16 v[148:151], v[120:123], v[64:67], v[148:151]
    s_barrier
    v_mfma_f32_16x16x32_bf16 v[152:155], v[64:67], v[124:127], v[152:155]
    ds_read_b128 v[48:51], v13 offset:16384
    v_mfma_f32_16x16x32_bf16 v[156:159], v[64:67], v[128:131], v[156:159]
    ds_read_b64_tr_b16 v[80:81], v15 offset:32768
    v_mfma_f32_16x16x32_bf16 v[160:163], v[64:67], v[132:135], v[160:163]
    ds_read_b64_tr_b16 v[82:83], v15 offset:34816
    v_mfma_f32_16x16x32_bf16 v[164:167], v[108:111], v[68:71], v[164:167]
    ds_read_b64_tr_b16 v[84:85], v17 offset:32768
    v_mfma_f32_16x16x32_bf16 v[168:171], v[112:115], v[68:71], v[168:171]
    ds_read_b64_tr_b16 v[86:87], v17 offset:34816
    v_mfma_f32_16x16x32_bf16 v[172:175], v[116:119], v[68:71], v[172:175]
    ds_read_b64_tr_b16 v[88:89], v19 offset:32768
    v_mfma_f32_16x16x32_bf16 v[176:179], v[120:123], v[68:71], v[176:179]
    ds_read_b64_tr_b16 v[90:91], v19 offset:34816
    v_mfma_f32_16x16x32_bf16 v[180:183], v[68:71], v[124:127], v[180:183]
    ds_read_b64_tr_b16 v[92:93], v21 offset:32768
    v_mfma_f32_16x16x32_bf16 v[184:187], v[68:71], v[128:131], v[184:187]
    ds_read_b64_tr_b16 v[94:95], v21 offset:34816
    v_mfma_f32_16x16x32_bf16 v[188:191], v[68:71], v[132:135], v[188:191]
    ds_read_b64_tr_b16 v[96:97], v23 offset:32768
    v_mfma_f32_16x16x32_bf16 v[192:195], v[108:111], v[72:75], v[192:195]
    ds_read_b64_tr_b16 v[98:99], v23 offset:34816
    v_mfma_f32_16x16x32_bf16 v[196:199], v[112:115], v[72:75], v[196:199]
    ds_read_b64_tr_b16 v[100:101], v25 offset:32768
    v_mfma_f32_16x16x32_bf16 v[200:203], v[116:119], v[72:75], v[200:203]
    ds_read_b64_tr_b16 v[102:103], v25 offset:34816
    v_mfma_f32_16x16x32_bf16 v[204:207], v[120:123], v[72:75], v[204:207]
    ds_read_b64_tr_b16 v[104:105], v27 offset:32768
    v_mfma_f32_16x16x32_bf16 v[208:211], v[72:75], v[124:127], v[208:211]
    ds_read_b64_tr_b16 v[106:107], v27 offset:34816
    v_mfma_f32_16x16x32_bf16 v[212:215], v[72:75], v[128:131], v[212:215]
    ds_read_b128 v[52:55], v13 offset:18432
    v_mfma_f32_16x16x32_bf16 v[216:219], v[72:75], v[132:135], v[216:219]
    ds_read_b128 v[56:59], v13 offset:20480
    v_mfma_f32_16x16x32_bf16 v[220:223], v[108:111], v[76:79], v[220:223]
    ds_read_b128 v[60:63], v13 offset:22528
    v_mfma_f32_16x16x32_bf16 v[224:227], v[112:115], v[76:79], v[224:227]
    v_mfma_f32_16x16x32_bf16 v[228:231], v[116:119], v[76:79], v[228:231]
    v_mfma_f32_16x16x32_bf16 v[232:235], v[120:123], v[76:79], v[232:235]
    v_mfma_f32_16x16x32_bf16 v[236:239], v[76:79], v[124:127], v[236:239]
    v_mfma_f32_16x16x32_bf16 v[240:243], v[76:79], v[128:131], v[240:243]
    v_mfma_f32_16x16x32_bf16 v[244:247], v[76:79], v[132:135], v[244:247]
    s_waitcnt lgkmcnt(0)
    v_mfma_f32_16x16x32_bf16 v[136:139], v[80:83], v[48:51], v[136:139]
    v_mfma_f32_16x16x32_bf16 v[140:143], v[84:87], v[48:51], v[140:143]
    v_mfma_f32_16x16x32_bf16 v[144:147], v[88:91], v[48:51], v[144:147]
    v_mfma_f32_16x16x32_bf16 v[148:151], v[92:95], v[48:51], v[148:151]
    v_mfma_f32_16x16x32_bf16 v[152:155], v[48:51], v[96:99], v[152:155]
    ds_read_b128 v[64:67], v14 offset:16384
    v_mfma_f32_16x16x32_bf16 v[156:159], v[48:51], v[100:103], v[156:159]
    ds_read_b64_tr_b16 v[108:109], v16 offset:0
    v_mfma_f32_16x16x32_bf16 v[160:163], v[48:51], v[104:107], v[160:163]
    ds_read_b64_tr_b16 v[110:111], v16 offset:2048
    v_mfma_f32_16x16x32_bf16 v[164:167], v[80:83], v[52:55], v[164:167]
    ds_read_b64_tr_b16 v[112:113], v18 offset:0
    v_mfma_f32_16x16x32_bf16 v[168:171], v[84:87], v[52:55], v[168:171]
    ds_read_b64_tr_b16 v[114:115], v18 offset:2048
    v_mfma_f32_16x16x32_bf16 v[172:175], v[88:91], v[52:55], v[172:175]
    ds_read_b64_tr_b16 v[116:117], v20 offset:0
    v_mfma_f32_16x16x32_bf16 v[176:179], v[92:95], v[52:55], v[176:179]
    ds_read_b64_tr_b16 v[118:119], v20 offset:2048
    v_mfma_f32_16x16x32_bf16 v[180:183], v[52:55], v[96:99], v[180:183]
    ds_read_b64_tr_b16 v[120:121], v22 offset:0
    v_mfma_f32_16x16x32_bf16 v[184:187], v[52:55], v[100:103], v[184:187]
    ds_read_b64_tr_b16 v[122:123], v22 offset:2048
    v_mfma_f32_16x16x32_bf16 v[188:191], v[52:55], v[104:107], v[188:191]
    ds_read_b64_tr_b16 v[124:125], v24 offset:0
    v_mfma_f32_16x16x32_bf16 v[192:195], v[80:83], v[56:59], v[192:195]
    ds_read_b64_tr_b16 v[126:127], v24 offset:2048
    v_mfma_f32_16x16x32_bf16 v[196:199], v[84:87], v[56:59], v[196:199]
    ds_read_b64_tr_b16 v[128:129], v26 offset:0
    v_mfma_f32_16x16x32_bf16 v[200:203], v[88:91], v[56:59], v[200:203]
    ds_read_b64_tr_b16 v[130:131], v26 offset:2048
    v_mfma_f32_16x16x32_bf16 v[204:207], v[92:95], v[56:59], v[204:207]
    ds_read_b64_tr_b16 v[132:133], v28 offset:0
    v_mfma_f32_16x16x32_bf16 v[208:211], v[56:59], v[96:99], v[208:211]
    ds_read_b64_tr_b16 v[134:135], v28 offset:2048
    v_mfma_f32_16x16x32_bf16 v[212:215], v[56:59], v[100:103], v[212:215]
    ds_read_b128 v[68:71], v14 offset:18432
    v_mfma_f32_16x16x32_bf16 v[216:219], v[56:59], v[104:107], v[216:219]
    ds_read_b128 v[72:75], v14 offset:20480
    v_mfma_f32_16x16x32_bf16 v[220:223], v[80:83], v[60:63], v[220:223]
    ds_read_b128 v[76:79], v14 offset:22528
    v_mfma_f32_16x16x32_bf16 v[224:227], v[84:87], v[60:63], v[224:227]
    v_mfma_f32_16x16x32_bf16 v[228:231], v[88:91], v[60:63], v[228:231]
    v_mfma_f32_16x16x32_bf16 v[232:235], v[92:95], v[60:63], v[232:235]
    v_mfma_f32_16x16x32_bf16 v[236:239], v[60:63], v[96:99], v[236:239]
    v_mfma_f32_16x16x32_bf16 v[240:243], v[60:63], v[100:103], v[240:243]
    v_mfma_f32_16x16x32_bf16 v[244:247], v[60:63], v[104:107], v[244:247]
    s_waitcnt lgkmcnt(0)
    v_mfma_f32_16x16x32_bf16 v[136:139], v[108:111], v[64:67], v[136:139]
    v_mfma_f32_16x16x32_bf16 v[140:143], v[112:115], v[64:67], v[140:143]
    v_mfma_f32_16x16x32_bf16 v[144:147], v[116:119], v[64:67], v[144:147]
    v_mfma_f32_16x16x32_bf16 v[148:151], v[120:123], v[64:67], v[148:151]
    s_barrier
    v_mfma_f32_16x16x32_bf16 v[152:155], v[64:67], v[124:127], v[152:155]
    ds_read_b128 v[48:51], v13 offset:32768
    v_mfma_f32_16x16x32_bf16 v[156:159], v[64:67], v[128:131], v[156:159]
    ds_read_b64_tr_b16 v[80:81], v16 offset:16384
    v_mfma_f32_16x16x32_bf16 v[160:163], v[64:67], v[132:135], v[160:163]
    ds_read_b64_tr_b16 v[82:83], v16 offset:18432
    v_mfma_f32_16x16x32_bf16 v[164:167], v[108:111], v[68:71], v[164:167]
    ds_read_b64_tr_b16 v[84:85], v18 offset:16384
    v_mfma_f32_16x16x32_bf16 v[168:171], v[112:115], v[68:71], v[168:171]
    ds_read_b64_tr_b16 v[86:87], v18 offset:18432
    v_mfma_f32_16x16x32_bf16 v[172:175], v[116:119], v[68:71], v[172:175]
    ds_read_b64_tr_b16 v[88:89], v20 offset:16384
    v_mfma_f32_16x16x32_bf16 v[176:179], v[120:123], v[68:71], v[176:179]
    ds_read_b64_tr_b16 v[90:91], v20 offset:18432
    v_mfma_f32_16x16x32_bf16 v[180:183], v[68:71], v[124:127], v[180:183]
    ds_read_b64_tr_b16 v[92:93], v22 offset:16384
    v_mfma_f32_16x16x32_bf16 v[184:187], v[68:71], v[128:131], v[184:187]
    ds_read_b64_tr_b16 v[94:95], v22 offset:18432
    v_mfma_f32_16x16x32_bf16 v[188:191], v[68:71], v[132:135], v[188:191]
    ds_read_b64_tr_b16 v[96:97], v24 offset:16384
    v_mfma_f32_16x16x32_bf16 v[192:195], v[108:111], v[72:75], v[192:195]
    ds_read_b64_tr_b16 v[98:99], v24 offset:18432
    v_mfma_f32_16x16x32_bf16 v[196:199], v[112:115], v[72:75], v[196:199]
    ds_read_b64_tr_b16 v[100:101], v26 offset:16384
    v_mfma_f32_16x16x32_bf16 v[200:203], v[116:119], v[72:75], v[200:203]
    ds_read_b64_tr_b16 v[102:103], v26 offset:18432
    v_mfma_f32_16x16x32_bf16 v[204:207], v[120:123], v[72:75], v[204:207]
    ds_read_b64_tr_b16 v[104:105], v28 offset:16384
    v_mfma_f32_16x16x32_bf16 v[208:211], v[72:75], v[124:127], v[208:211]
    ds_read_b64_tr_b16 v[106:107], v28 offset:18432
    v_mfma_f32_16x16x32_bf16 v[212:215], v[72:75], v[128:131], v[212:215]
    ds_read_b128 v[52:55], v13 offset:34816
    v_mfma_f32_16x16x32_bf16 v[216:219], v[72:75], v[132:135], v[216:219]
    ds_read_b128 v[56:59], v13 offset:36864
    v_mfma_f32_16x16x32_bf16 v[220:223], v[108:111], v[76:79], v[220:223]
    ds_read_b128 v[60:63], v13 offset:38912
    v_mfma_f32_16x16x32_bf16 v[224:227], v[112:115], v[76:79], v[224:227]
    v_mfma_f32_16x16x32_bf16 v[228:231], v[116:119], v[76:79], v[228:231]
    v_mfma_f32_16x16x32_bf16 v[232:235], v[120:123], v[76:79], v[232:235]
    v_mfma_f32_16x16x32_bf16 v[236:239], v[76:79], v[124:127], v[236:239]
    v_mfma_f32_16x16x32_bf16 v[240:243], v[76:79], v[128:131], v[240:243]
    v_mfma_f32_16x16x32_bf16 v[244:247], v[76:79], v[132:135], v[244:247]
    s_waitcnt lgkmcnt(0)
    v_mfma_f32_16x16x32_bf16 v[136:139], v[80:83], v[48:51], v[136:139]
    v_mfma_f32_16x16x32_bf16 v[140:143], v[84:87], v[48:51], v[140:143]
    v_mfma_f32_16x16x32_bf16 v[144:147], v[88:91], v[48:51], v[144:147]
    v_mfma_f32_16x16x32_bf16 v[148:151], v[92:95], v[48:51], v[148:151]
    v_mfma_f32_16x16x32_bf16 v[152:155], v[48:51], v[96:99], v[152:155]
    ds_read_b128 v[64:67], v14 offset:32768
    v_mfma_f32_16x16x32_bf16 v[156:159], v[48:51], v[100:103], v[156:159]
    ds_read_b64_tr_b16 v[108:109], v16 offset:32768
    v_mfma_f32_16x16x32_bf16 v[160:163], v[48:51], v[104:107], v[160:163]
    ds_read_b64_tr_b16 v[110:111], v16 offset:34816
    v_mfma_f32_16x16x32_bf16 v[164:167], v[80:83], v[52:55], v[164:167]
    ds_read_b64_tr_b16 v[112:113], v18 offset:32768
    v_mfma_f32_16x16x32_bf16 v[168:171], v[84:87], v[52:55], v[168:171]
    ds_read_b64_tr_b16 v[114:115], v18 offset:34816
    v_mfma_f32_16x16x32_bf16 v[172:175], v[88:91], v[52:55], v[172:175]
    ds_read_b64_tr_b16 v[116:117], v20 offset:32768
    v_mfma_f32_16x16x32_bf16 v[176:179], v[92:95], v[52:55], v[176:179]
    ds_read_b64_tr_b16 v[118:119], v20 offset:34816
    v_mfma_f32_16x16x32_bf16 v[180:183], v[52:55], v[96:99], v[180:183]
    ds_read_b64_tr_b16 v[120:121], v22 offset:32768
    v_mfma_f32_16x16x32_bf16 v[184:187], v[52:55], v[100:103], v[184:187]
    ds_read_b64_tr_b16 v[122:123], v22 offset:34816
    v_mfma_f32_16x16x32_bf16 v[188:191], v[52:55], v[104:107], v[188:191]
    ds_read_b64_tr_b16 v[124:125], v24 offset:32768
    v_mfma_f32_16x16x32_bf16 v[192:195], v[80:83], v[56:59], v[192:195]
    ds_read_b64_tr_b16 v[126:127], v24 offset:34816
    v_mfma_f32_16x16x32_bf16 v[196:199], v[84:87], v[56:59], v[196:199]
    ds_read_b64_tr_b16 v[128:129], v26 offset:32768
    v_mfma_f32_16x16x32_bf16 v[200:203], v[88:91], v[56:59], v[200:203]
    ds_read_b64_tr_b16 v[130:131], v26 offset:34816
    v_mfma_f32_16x16x32_bf16 v[204:207], v[92:95], v[56:59], v[204:207]
    ds_read_b64_tr_b16 v[132:133], v28 offset:32768
    v_mfma_f32_16x16x32_bf16 v[208:211], v[56:59], v[96:99], v[208:211]
    ds_read_b64_tr_b16 v[134:135], v28 offset:34816
    v_mfma_f32_16x16x32_bf16 v[212:215], v[56:59], v[100:103], v[212:215]
    ds_read_b128 v[68:71], v14 offset:34816
    v_mfma_f32_16x16x32_bf16 v[216:219], v[56:59], v[104:107], v[216:219]
    ds_read_b128 v[72:75], v14 offset:36864
    v_mfma_f32_16x16x32_bf16 v[220:223], v[80:83], v[60:63], v[220:223]
    ds_read_b128 v[76:79], v14 offset:38912
    v_mfma_f32_16x16x32_bf16 v[224:227], v[84:87], v[60:63], v[224:227]
    v_mfma_f32_16x16x32_bf16 v[228:231], v[88:91], v[60:63], v[228:231]
    v_mfma_f32_16x16x32_bf16 v[232:235], v[92:95], v[60:63], v[232:235]
    v_mfma_f32_16x16x32_bf16 v[236:239], v[60:63], v[96:99], v[236:239]
    v_mfma_f32_16x16x32_bf16 v[240:243], v[60:63], v[100:103], v[240:243]
    v_mfma_f32_16x16x32_bf16 v[244:247], v[60:63], v[104:107], v[244:247]
    s_waitcnt lgkmcnt(0)
    v_mfma_f32_16x16x32_bf16 v[136:139], v[108:111], v[64:67], v[136:139]
    v_mfma_f32_16x16x32_bf16 v[140:143], v[112:115], v[64:67], v[140:143]
    v_mfma_f32_16x16x32_bf16 v[144:147], v[116:119], v[64:67], v[144:147]
    v_mfma_f32_16x16x32_bf16 v[148:151], v[120:123], v[64:67], v[148:151]
    s_barrier
    v_mfma_f32_16x16x32_bf16 v[152:155], v[64:67], v[124:127], v[152:155]
    ds_read_b128 v[48:51], v13 offset:0
    v_mfma_f32_16x16x32_bf16 v[156:159], v[64:67], v[128:131], v[156:159]
    ds_read_b64_tr_b16 v[80:81], v15 offset:0
    v_mfma_f32_16x16x32_bf16 v[160:163], v[64:67], v[132:135], v[160:163]
    ds_read_b64_tr_b16 v[82:83], v15 offset:2048
    v_mfma_f32_16x16x32_bf16 v[164:167], v[108:111], v[68:71], v[164:167]
    ds_read_b64_tr_b16 v[84:85], v17 offset:0
    v_mfma_f32_16x16x32_bf16 v[168:171], v[112:115], v[68:71], v[168:171]
    ds_read_b64_tr_b16 v[86:87], v17 offset:2048
    v_mfma_f32_16x16x32_bf16 v[172:175], v[116:119], v[68:71], v[172:175]
    ds_read_b64_tr_b16 v[88:89], v19 offset:0
    v_mfma_f32_16x16x32_bf16 v[176:179], v[120:123], v[68:71], v[176:179]
    ds_read_b64_tr_b16 v[90:91], v19 offset:2048
    v_mfma_f32_16x16x32_bf16 v[180:183], v[68:71], v[124:127], v[180:183]
    ds_read_b64_tr_b16 v[92:93], v21 offset:0
    v_mfma_f32_16x16x32_bf16 v[184:187], v[68:71], v[128:131], v[184:187]
    ds_read_b64_tr_b16 v[94:95], v21 offset:2048
    v_mfma_f32_16x16x32_bf16 v[188:191], v[68:71], v[132:135], v[188:191]
    ds_read_b64_tr_b16 v[96:97], v23 offset:0
    v_mfma_f32_16x16x32_bf16 v[192:195], v[108:111], v[72:75], v[192:195]
    ds_read_b64_tr_b16 v[98:99], v23 offset:2048
    v_mfma_f32_16x16x32_bf16 v[196:199], v[112:115], v[72:75], v[196:199]
    ds_read_b64_tr_b16 v[100:101], v25 offset:0
    v_mfma_f32_16x16x32_bf16 v[200:203], v[116:119], v[72:75], v[200:203]
    ds_read_b64_tr_b16 v[102:103], v25 offset:2048
    v_mfma_f32_16x16x32_bf16 v[204:207], v[120:123], v[72:75], v[204:207]
    ds_read_b64_tr_b16 v[104:105], v27 offset:0
    v_mfma_f32_16x16x32_bf16 v[208:211], v[72:75], v[124:127], v[208:211]
    ds_read_b64_tr_b16 v[106:107], v27 offset:2048
    v_mfma_f32_16x16x32_bf16 v[212:215], v[72:75], v[128:131], v[212:215]
    ds_read_b128 v[52:55], v13 offset:2048
    v_mfma_f32_16x16x32_bf16 v[216:219], v[72:75], v[132:135], v[216:219]
    ds_read_b128 v[56:59], v13 offset:4096
    v_mfma_f32_16x16x32_bf16 v[220:223], v[108:111], v[76:79], v[220:223]
    ds_read_b128 v[60:63], v13 offset:6144
    v_mfma_f32_16x16x32_bf16 v[224:227], v[112:115], v[76:79], v[224:227]
    v_mfma_f32_16x16x32_bf16 v[228:231], v[116:119], v[76:79], v[228:231]
    v_mfma_f32_16x16x32_bf16 v[232:235], v[120:123], v[76:79], v[232:235]
    v_mfma_f32_16x16x32_bf16 v[236:239], v[76:79], v[124:127], v[236:239]
    v_mfma_f32_16x16x32_bf16 v[240:243], v[76:79], v[128:131], v[240:243]
    v_mfma_f32_16x16x32_bf16 v[244:247], v[76:79], v[132:135], v[244:247]
    s_waitcnt lgkmcnt(0)
    v_mfma_f32_16x16x32_bf16 v[136:139], v[80:83], v[48:51], v[136:139]
    v_mfma_f32_16x16x32_bf16 v[140:143], v[84:87], v[48:51], v[140:143]
    v_mfma_f32_16x16x32_bf16 v[144:147], v[88:91], v[48:51], v[144:147]
    v_mfma_f32_16x16x32_bf16 v[148:151], v[92:95], v[48:51], v[148:151]
    v_mfma_f32_16x16x32_bf16 v[152:155], v[48:51], v[96:99], v[152:155]
    ds_read_b128 v[64:67], v14 offset:0
    v_mfma_f32_16x16x32_bf16 v[156:159], v[48:51], v[100:103], v[156:159]
    ds_read_b64_tr_b16 v[108:109], v15 offset:16384
    v_mfma_f32_16x16x32_bf16 v[160:163], v[48:51], v[104:107], v[160:163]
    ds_read_b64_tr_b16 v[110:111], v15 offset:18432
    v_mfma_f32_16x16x32_bf16 v[164:167], v[80:83], v[52:55], v[164:167]
    ds_read_b64_tr_b16 v[112:113], v17 offset:16384
    v_mfma_f32_16x16x32_bf16 v[168:171], v[84:87], v[52:55], v[168:171]
    ds_read_b64_tr_b16 v[114:115], v17 offset:18432
    v_mfma_f32_16x16x32_bf16 v[172:175], v[88:91], v[52:55], v[172:175]
    ds_read_b64_tr_b16 v[116:117], v19 offset:16384
    v_mfma_f32_16x16x32_bf16 v[176:179], v[92:95], v[52:55], v[176:179]
    ds_read_b64_tr_b16 v[118:119], v19 offset:18432
    v_mfma_f32_16x16x32_bf16 v[180:183], v[52:55], v[96:99], v[180:183]
    ds_read_b64_tr_b16 v[120:121], v21 offset:16384
    v_mfma_f32_16x16x32_bf16 v[184:187], v[52:55], v[100:103], v[184:187]
    ds_read_b64_tr_b16 v[122:123], v21 offset:18432
    v_mfma_f32_16x16x32_bf16 v[188:191], v[52:55], v[104:107], v[188:191]
    ds_read_b64_tr_b16 v[124:125], v23 offset:16384
    v_mfma_f32_16x16x32_bf16 v[192:195], v[80:83], v[56:59], v[192:195]
    ds_read_b64_tr_b16 v[126:127], v23 offset:18432
    v_mfma_f32_16x16x32_bf16 v[196:199], v[84:87], v[56:59], v[196:199]
    ds_read_b64_tr_b16 v[128:129], v25 offset:16384
    v_mfma_f32_16x16x32_bf16 v[200:203], v[88:91], v[56:59], v[200:203]
    ds_read_b64_tr_b16 v[130:131], v25 offset:18432
    v_mfma_f32_16x16x32_bf16 v[204:207], v[92:95], v[56:59], v[204:207]
    ds_read_b64_tr_b16 v[132:133], v27 offset:16384
    v_mfma_f32_16x16x32_bf16 v[208:211], v[56:59], v[96:99], v[208:211]
    ds_read_b64_tr_b16 v[134:135], v27 offset:18432
    v_mfma_f32_16x16x32_bf16 v[212:215], v[56:59], v[100:103], v[212:215]
    ds_read_b128 v[68:71], v14 offset:2048
    v_mfma_f32_16x16x32_bf16 v[216:219], v[56:59], v[104:107], v[216:219]
    ds_read_b128 v[72:75], v14 offset:4096
    v_mfma_f32_16x16x32_bf16 v[220:223], v[80:83], v[60:63], v[220:223]
    ds_read_b128 v[76:79], v14 offset:6144
    v_mfma_f32_16x16x32_bf16 v[224:227], v[84:87], v[60:63], v[224:227]
    v_mfma_f32_16x16x32_bf16 v[228:231], v[88:91], v[60:63], v[228:231]
    v_mfma_f32_16x16x32_bf16 v[232:235], v[92:95], v[60:63], v[232:235]
    v_mfma_f32_16x16x32_bf16 v[236:239], v[60:63], v[96:99], v[236:239]
    v_mfma_f32_16x16x32_bf16 v[240:243], v[60:63], v[100:103], v[240:243]
    v_mfma_f32_16x16x32_bf16 v[244:247], v[60:63], v[104:107], v[244:247]
    s_waitcnt lgkmcnt(0)
    v_mfma_f32_16x16x32_bf16 v[136:139], v[108:111], v[64:67], v[136:139]
    v_mfma_f32_16x16x32_bf16 v[140:143], v[112:115], v[64:67], v[140:143]
    v_mfma_f32_16x16x32_bf16 v[144:147], v[116:119], v[64:67], v[144:147]
    v_mfma_f32_16x16x32_bf16 v[148:151], v[120:123], v[64:67], v[148:151]
    s_barrier
    v_mfma_f32_16x16x32_bf16 v[152:155], v[64:67], v[124:127], v[152:155]
    ds_read_b128 v[48:51], v13 offset:16384
    v_mfma_f32_16x16x32_bf16 v[156:159], v[64:67], v[128:131], v[156:159]
    ds_read_b64_tr_b16 v[80:81], v15 offset:32768
    v_mfma_f32_16x16x32_bf16 v[160:163], v[64:67], v[132:135], v[160:163]
    ds_read_b64_tr_b16 v[82:83], v15 offset:34816
    v_mfma_f32_16x16x32_bf16 v[164:167], v[108:111], v[68:71], v[164:167]
    ds_read_b64_tr_b16 v[84:85], v17 offset:32768
    v_mfma_f32_16x16x32_bf16 v[168:171], v[112:115], v[68:71], v[168:171]
    ds_read_b64_tr_b16 v[86:87], v17 offset:34816
    v_mfma_f32_16x16x32_bf16 v[172:175], v[116:119], v[68:71], v[172:175]
    ds_read_b64_tr_b16 v[88:89], v19 offset:32768
    v_mfma_f32_16x16x32_bf16 v[176:179], v[120:123], v[68:71], v[176:179]
    ds_read_b64_tr_b16 v[90:91], v19 offset:34816
    v_mfma_f32_16x16x32_bf16 v[180:183], v[68:71], v[124:127], v[180:183]
    ds_read_b64_tr_b16 v[92:93], v21 offset:32768
    v_mfma_f32_16x16x32_bf16 v[184:187], v[68:71], v[128:131], v[184:187]
    ds_read_b64_tr_b16 v[94:95], v21 offset:34816
    v_mfma_f32_16x16x32_bf16 v[188:191], v[68:71], v[132:135], v[188:191]
    ds_read_b64_tr_b16 v[96:97], v23 offset:32768
    v_mfma_f32_16x16x32_bf16 v[192:195], v[108:111], v[72:75], v[192:195]
    ds_read_b64_tr_b16 v[98:99], v23 offset:34816
    v_mfma_f32_16x16x32_bf16 v[196:199], v[112:115], v[72:75], v[196:199]
    ds_read_b64_tr_b16 v[100:101], v25 offset:32768
    v_mfma_f32_16x16x32_bf16 v[200:203], v[116:119], v[72:75], v[200:203]
    ds_read_b64_tr_b16 v[102:103], v25 offset:34816
    v_mfma_f32_16x16x32_bf16 v[204:207], v[120:123], v[72:75], v[204:207]
    ds_read_b64_tr_b16 v[104:105], v27 offset:32768
    v_mfma_f32_16x16x32_bf16 v[208:211], v[72:75], v[124:127], v[208:211]
    ds_read_b64_tr_b16 v[106:107], v27 offset:34816
    v_mfma_f32_16x16x32_bf16 v[212:215], v[72:75], v[128:131], v[212:215]
    ds_read_b128 v[52:55], v13 offset:18432
    v_mfma_f32_16x16x32_bf16 v[216:219], v[72:75], v[132:135], v[216:219]
    ds_read_b128 v[56:59], v13 offset:20480
    v_mfma_f32_16x16x32_bf16 v[220:223], v[108:111], v[76:79], v[220:223]
    ds_read_b128 v[60:63], v13 offset:22528
    v_mfma_f32_16x16x32_bf16 v[224:227], v[112:115], v[76:79], v[224:227]
    v_mfma_f32_16x16x32_bf16 v[228:231], v[116:119], v[76:79], v[228:231]
    v_mfma_f32_16x16x32_bf16 v[232:235], v[120:123], v[76:79], v[232:235]
    v_mfma_f32_16x16x32_bf16 v[236:239], v[76:79], v[124:127], v[236:239]
    v_mfma_f32_16x16x32_bf16 v[240:243], v[76:79], v[128:131], v[240:243]
    v_mfma_f32_16x16x32_bf16 v[244:247], v[76:79], v[132:135], v[244:247]
    s_waitcnt lgkmcnt(0)
    v_mfma_f32_16x16x32_bf16 v[136:139], v[80:83], v[48:51], v[136:139]
    v_mfma_f32_16x16x32_bf16 v[140:143], v[84:87], v[48:51], v[140:143]
    v_mfma_f32_16x16x32_bf16 v[144:147], v[88:91], v[48:51], v[144:147]
    v_mfma_f32_16x16x32_bf16 v[148:151], v[92:95], v[48:51], v[148:151]
    v_mfma_f32_16x16x32_bf16 v[152:155], v[48:51], v[96:99], v[152:155]
    ds_read_b128 v[64:67], v14 offset:16384
    v_mfma_f32_16x16x32_bf16 v[156:159], v[48:51], v[100:103], v[156:159]
    ds_read_b64_tr_b16 v[108:109], v16 offset:0
    v_mfma_f32_16x16x32_bf16 v[160:163], v[48:51], v[104:107], v[160:163]
    ds_read_b64_tr_b16 v[110:111], v16 offset:2048
    v_mfma_f32_16x16x32_bf16 v[164:167], v[80:83], v[52:55], v[164:167]
    ds_read_b64_tr_b16 v[112:113], v18 offset:0
    v_mfma_f32_16x16x32_bf16 v[168:171], v[84:87], v[52:55], v[168:171]
    ds_read_b64_tr_b16 v[114:115], v18 offset:2048
    v_mfma_f32_16x16x32_bf16 v[172:175], v[88:91], v[52:55], v[172:175]
    ds_read_b64_tr_b16 v[116:117], v20 offset:0
    v_mfma_f32_16x16x32_bf16 v[176:179], v[92:95], v[52:55], v[176:179]
    ds_read_b64_tr_b16 v[118:119], v20 offset:2048
    v_mfma_f32_16x16x32_bf16 v[180:183], v[52:55], v[96:99], v[180:183]
    ds_read_b64_tr_b16 v[120:121], v22 offset:0
    v_mfma_f32_16x16x32_bf16 v[184:187], v[52:55], v[100:103], v[184:187]
    ds_read_b64_tr_b16 v[122:123], v22 offset:2048
    v_mfma_f32_16x16x32_bf16 v[188:191], v[52:55], v[104:107], v[188:191]
    ds_read_b64_tr_b16 v[124:125], v24 offset:0
    v_mfma_f32_16x16x32_bf16 v[192:195], v[80:83], v[56:59], v[192:195]
    ds_read_b64_tr_b16 v[126:127], v24 offset:2048
    v_mfma_f32_16x16x32_bf16 v[196:199], v[84:87], v[56:59], v[196:199]
    ds_read_b64_tr_b16 v[128:129], v26 offset:0
    v_mfma_f32_16x16x32_bf16 v[200:203], v[88:91], v[56:59], v[200:203]
    ds_read_b64_tr_b16 v[130:131], v26 offset:2048
    v_mfma_f32_16x16x32_bf16 v[204:207], v[92:95], v[56:59], v[204:207]
    ds_read_b64_tr_b16 v[132:133], v28 offset:0
    v_mfma_f32_16x16x32_bf16 v[208:211], v[56:59], v[96:99], v[208:211]
    ds_read_b64_tr_b16 v[134:135], v28 offset:2048
    v_mfma_f32_16x16x32_bf16 v[212:215], v[56:59], v[100:103], v[212:215]
    ds_read_b128 v[68:71], v14 offset:18432
    v_mfma_f32_16x16x32_bf16 v[216:219], v[56:59], v[104:107], v[216:219]
    ds_read_b128 v[72:75], v14 offset:20480
    v_mfma_f32_16x16x32_bf16 v[220:223], v[80:83], v[60:63], v[220:223]
    ds_read_b128 v[76:79], v14 offset:22528
    v_mfma_f32_16x16x32_bf16 v[224:227], v[84:87], v[60:63], v[224:227]
    v_mfma_f32_16x16x32_bf16 v[228:231], v[88:91], v[60:63], v[228:231]
    v_mfma_f32_16x16x32_bf16 v[232:235], v[92:95], v[60:63], v[232:235]
    v_mfma_f32_16x16x32_bf16 v[236:239], v[60:63], v[96:99], v[236:239]
    v_mfma_f32_16x16x32_bf16 v[240:243], v[60:63], v[100:103], v[240:243]
    v_mfma_f32_16x16x32_bf16 v[244:247], v[60:63], v[104:107], v[244:247]
    s_waitcnt lgkmcnt(0)
    v_mfma_f32_16x16x32_bf16 v[136:139], v[108:111], v[64:67], v[136:139]
    v_mfma_f32_16x16x32_bf16 v[140:143], v[112:115], v[64:67], v[140:143]
    v_mfma_f32_16x16x32_bf16 v[144:147], v[116:119], v[64:67], v[144:147]
    v_mfma_f32_16x16x32_bf16 v[148:151], v[120:123], v[64:67], v[148:151]
    s_barrier
    v_mfma_f32_16x16x32_bf16 v[152:155], v[64:67], v[124:127], v[152:155]
    ds_read_b128 v[48:51], v13 offset:32768
    v_mfma_f32_16x16x32_bf16 v[156:159], v[64:67], v[128:131], v[156:159]
    ds_read_b64_tr_b16 v[80:81], v16 offset:16384
    v_mfma_f32_16x16x32_bf16 v[160:163], v[64:67], v[132:135], v[160:163]
    ds_read_b64_tr_b16 v[82:83], v16 offset:18432
    v_mfma_f32_16x16x32_bf16 v[164:167], v[108:111], v[68:71], v[164:167]
    ds_read_b64_tr_b16 v[84:85], v18 offset:16384
    v_mfma_f32_16x16x32_bf16 v[168:171], v[112:115], v[68:71], v[168:171]
    ds_read_b64_tr_b16 v[86:87], v18 offset:18432
    v_mfma_f32_16x16x32_bf16 v[172:175], v[116:119], v[68:71], v[172:175]
    ds_read_b64_tr_b16 v[88:89], v20 offset:16384
    v_mfma_f32_16x16x32_bf16 v[176:179], v[120:123], v[68:71], v[176:179]
    ds_read_b64_tr_b16 v[90:91], v20 offset:18432
    v_mfma_f32_16x16x32_bf16 v[180:183], v[68:71], v[124:127], v[180:183]
    ds_read_b64_tr_b16 v[92:93], v22 offset:16384
    v_mfma_f32_16x16x32_bf16 v[184:187], v[68:71], v[128:131], v[184:187]
    ds_read_b64_tr_b16 v[94:95], v22 offset:18432
    v_mfma_f32_16x16x32_bf16 v[188:191], v[68:71], v[132:135], v[188:191]
    ds_read_b64_tr_b16 v[96:97], v24 offset:16384
    v_mfma_f32_16x16x32_bf16 v[192:195], v[108:111], v[72:75], v[192:195]
    ds_read_b64_tr_b16 v[98:99], v24 offset:18432
    v_mfma_f32_16x16x32_bf16 v[196:199], v[112:115], v[72:75], v[196:199]
    ds_read_b64_tr_b16 v[100:101], v26 offset:16384
    v_mfma_f32_16x16x32_bf16 v[200:203], v[116:119], v[72:75], v[200:203]
    ds_read_b64_tr_b16 v[102:103], v26 offset:18432
    v_mfma_f32_16x16x32_bf16 v[204:207], v[120:123], v[72:75], v[204:207]
    ds_read_b64_tr_b16 v[104:105], v28 offset:16384
    v_mfma_f32_16x16x32_bf16 v[208:211], v[72:75], v[124:127], v[208:211]
    ds_read_b64_tr_b16 v[106:107], v28 offset:18432
    v_mfma_f32_16x16x32_bf16 v[212:215], v[72:75], v[128:131], v[212:215]
    ds_read_b128 v[52:55], v13 offset:34816
    v_mfma_f32_16x16x32_bf16 v[216:219], v[72:75], v[132:135], v[216:219]
    ds_read_b128 v[56:59], v13 offset:36864
    v_mfma_f32_16x16x32_bf16 v[220:223], v[108:111], v[76:79], v[220:223]
    ds_read_b128 v[60:63], v13 offset:38912
    v_mfma_f32_16x16x32_bf16 v[224:227], v[112:115], v[76:79], v[224:227]
    v_mfma_f32_16x16x32_bf16 v[228:231], v[116:119], v[76:79], v[228:231]
    v_mfma_f32_16x16x32_bf16 v[232:235], v[120:123], v[76:79], v[232:235]
    v_mfma_f32_16x16x32_bf16 v[236:239], v[76:79], v[124:127], v[236:239]
    v_mfma_f32_16x16x32_bf16 v[240:243], v[76:79], v[128:131], v[240:243]
    v_mfma_f32_16x16x32_bf16 v[244:247], v[76:79], v[132:135], v[244:247]
    s_waitcnt lgkmcnt(0)
    v_mfma_f32_16x16x32_bf16 v[136:139], v[80:83], v[48:51], v[136:139]
    v_mfma_f32_16x16x32_bf16 v[140:143], v[84:87], v[48:51], v[140:143]
    v_mfma_f32_16x16x32_bf16 v[144:147], v[88:91], v[48:51], v[144:147]
    v_mfma_f32_16x16x32_bf16 v[148:151], v[92:95], v[48:51], v[148:151]
    v_mfma_f32_16x16x32_bf16 v[152:155], v[48:51], v[96:99], v[152:155]
    ds_read_b128 v[64:67], v14 offset:32768
    v_mfma_f32_16x16x32_bf16 v[156:159], v[48:51], v[100:103], v[156:159]
    ds_read_b64_tr_b16 v[108:109], v16 offset:32768
    v_mfma_f32_16x16x32_bf16 v[160:163], v[48:51], v[104:107], v[160:163]
    ds_read_b64_tr_b16 v[110:111], v16 offset:34816
    v_mfma_f32_16x16x32_bf16 v[164:167], v[80:83], v[52:55], v[164:167]
    ds_read_b64_tr_b16 v[112:113], v18 offset:32768
    v_mfma_f32_16x16x32_bf16 v[168:171], v[84:87], v[52:55], v[168:171]
    ds_read_b64_tr_b16 v[114:115], v18 offset:34816
    v_mfma_f32_16x16x32_bf16 v[172:175], v[88:91], v[52:55], v[172:175]
    ds_read_b64_tr_b16 v[116:117], v20 offset:32768
    v_mfma_f32_16x16x32_bf16 v[176:179], v[92:95], v[52:55], v[176:179]
    ds_read_b64_tr_b16 v[118:119], v20 offset:34816
    v_mfma_f32_16x16x32_bf16 v[180:183], v[52:55], v[96:99], v[180:183]
    ds_read_b64_tr_b16 v[120:121], v22 offset:32768
    v_mfma_f32_16x16x32_bf16 v[184:187], v[52:55], v[100:103], v[184:187]
    ds_read_b64_tr_b16 v[122:123], v22 offset:34816
    v_mfma_f32_16x16x32_bf16 v[188:191], v[52:55], v[104:107], v[188:191]
    ds_read_b64_tr_b16 v[124:125], v24 offset:32768
    v_mfma_f32_16x16x32_bf16 v[192:195], v[80:83], v[56:59], v[192:195]
    ds_read_b64_tr_b16 v[126:127], v24 offset:34816
    v_mfma_f32_16x16x32_bf16 v[196:199], v[84:87], v[56:59], v[196:199]
    ds_read_b64_tr_b16 v[128:129], v26 offset:32768
    v_mfma_f32_16x16x32_bf16 v[200:203], v[88:91], v[56:59], v[200:203]
    ds_read_b64_tr_b16 v[130:131], v26 offset:34816
    v_mfma_f32_16x16x32_bf16 v[204:207], v[92:95], v[56:59], v[204:207]
    ds_read_b64_tr_b16 v[132:133], v28 offset:32768
    v_mfma_f32_16x16x32_bf16 v[208:211], v[56:59], v[96:99], v[208:211]
    ds_read_b64_tr_b16 v[134:135], v28 offset:34816
    v_mfma_f32_16x16x32_bf16 v[212:215], v[56:59], v[100:103], v[212:215]
    ds_read_b128 v[68:71], v14 offset:34816
    v_mfma_f32_16x16x32_bf16 v[216:219], v[56:59], v[104:107], v[216:219]
    ds_read_b128 v[72:75], v14 offset:36864
    v_mfma_f32_16x16x32_bf16 v[220:223], v[80:83], v[60:63], v[220:223]
    ds_read_b128 v[76:79], v14 offset:38912
    v_mfma_f32_16x16x32_bf16 v[224:227], v[84:87], v[60:63], v[224:227]
    v_mfma_f32_16x16x32_bf16 v[228:231], v[88:91], v[60:63], v[228:231]
    v_mfma_f32_16x16x32_bf16 v[232:235], v[92:95], v[60:63], v[232:235]
    v_mfma_f32_16x16x32_bf16 v[236:239], v[60:63], v[96:99], v[236:239]
    v_mfma_f32_16x16x32_bf16 v[240:243], v[60:63], v[100:103], v[240:243]
    v_mfma_f32_16x16x32_bf16 v[244:247], v[60:63], v[104:107], v[244:247]
    s_waitcnt lgkmcnt(0)
    v_mfma_f32_16x16x32_bf16 v[136:139], v[108:111], v[64:67], v[136:139]
    v_mfma_f32_16x16x32_bf16 v[140:143], v[112:115], v[64:67], v[140:143]
    v_mfma_f32_16x16x32_bf16 v[144:147], v[116:119], v[64:67], v[144:147]
    v_mfma_f32_16x16x32_bf16 v[148:151], v[120:123], v[64:67], v[148:151]
    s_barrier
    v_mfma_f32_16x16x32_bf16 v[152:155], v[64:67], v[124:127], v[152:155]
    ds_read_b128 v[48:51], v13 offset:0
    v_mfma_f32_16x16x32_bf16 v[156:159], v[64:67], v[128:131], v[156:159]
    ds_read_b64_tr_b16 v[80:81], v15 offset:0
    v_mfma_f32_16x16x32_bf16 v[160:163], v[64:67], v[132:135], v[160:163]
    ds_read_b64_tr_b16 v[82:83], v15 offset:2048
    v_mfma_f32_16x16x32_bf16 v[164:167], v[108:111], v[68:71], v[164:167]
    ds_read_b64_tr_b16 v[84:85], v17 offset:0
    v_mfma_f32_16x16x32_bf16 v[168:171], v[112:115], v[68:71], v[168:171]
    ds_read_b64_tr_b16 v[86:87], v17 offset:2048
    v_mfma_f32_16x16x32_bf16 v[172:175], v[116:119], v[68:71], v[172:175]
    ds_read_b64_tr_b16 v[88:89], v19 offset:0
    v_mfma_f32_16x16x32_bf16 v[176:179], v[120:123], v[68:71], v[176:179]
    ds_read_b64_tr_b16 v[90:91], v19 offset:2048
    v_mfma_f32_16x16x32_bf16 v[180:183], v[68:71], v[124:127], v[180:183]
    ds_read_b64_tr_b16 v[92:93], v21 offset:0
    v_mfma_f32_16x16x32_bf16 v[184:187], v[68:71], v[128:131], v[184:187]
    ds_read_b64_tr_b16 v[94:95], v21 offset:2048
    v_mfma_f32_16x16x32_bf16 v[188:191], v[68:71], v[132:135], v[188:191]
    ds_read_b64_tr_b16 v[96:97], v23 offset:0
    v_mfma_f32_16x16x32_bf16 v[192:195], v[108:111], v[72:75], v[192:195]
    ds_read_b64_tr_b16 v[98:99], v23 offset:2048
    v_mfma_f32_16x16x32_bf16 v[196:199], v[112:115], v[72:75], v[196:199]
    ds_read_b64_tr_b16 v[100:101], v25 offset:0
    v_mfma_f32_16x16x32_bf16 v[200:203], v[116:119], v[72:75], v[200:203]
    ds_read_b64_tr_b16 v[102:103], v25 offset:2048
    v_mfma_f32_16x16x32_bf16 v[204:207], v[120:123], v[72:75], v[204:207]
    ds_read_b64_tr_b16 v[104:105], v27 offset:0
    v_mfma_f32_16x16x32_bf16 v[208:211], v[72:75], v[124:127], v[208:211]
    ds_read_b64_tr_b16 v[106:107], v27 offset:2048
    v_mfma_f32_16x16x32_bf16 v[212:215], v[72:75], v[128:131], v[212:215]
    ds_read_b128 v[52:55], v13 offset:2048
    v_mfma_f32_16x16x32_bf16 v[216:219], v[72:75], v[132:135], v[216:219]
    ds_read_b128 v[56:59], v13 offset:4096
    v_mfma_f32_16x16x32_bf16 v[220:223], v[108:111], v[76:79], v[220:223]
    ds_read_b128 v[60:63], v13 offset:6144
    v_mfma_f32_16x16x32_bf16 v[224:227], v[112:115], v[76:79], v[224:227]
    v_mfma_f32_16x16x32_bf16 v[228:231], v[116:119], v[76:79], v[228:231]
    v_mfma_f32_16x16x32_bf16 v[232:235], v[120:123], v[76:79], v[232:235]
    v_mfma_f32_16x16x32_bf16 v[236:239], v[76:79], v[124:127], v[236:239]
    v_mfma_f32_16x16x32_bf16 v[240:243], v[76:79], v[128:131], v[240:243]
    v_mfma_f32_16x16x32_bf16 v[244:247], v[76:79], v[132:135], v[244:247]
    s_waitcnt lgkmcnt(0)
    v_mfma_f32_16x16x32_bf16 v[136:139], v[80:83], v[48:51], v[136:139]
    v_mfma_f32_16x16x32_bf16 v[140:143], v[84:87], v[48:51], v[140:143]
    v_mfma_f32_16x16x32_bf16 v[144:147], v[88:91], v[48:51], v[144:147]
    v_mfma_f32_16x16x32_bf16 v[148:151], v[92:95], v[48:51], v[148:151]
    v_mfma_f32_16x16x32_bf16 v[152:155], v[48:51], v[96:99], v[152:155]
    ds_read_b128 v[64:67], v14 offset:0
    v_mfma_f32_16x16x32_bf16 v[156:159], v[48:51], v[100:103], v[156:159]
    ds_read_b64_tr_b16 v[108:109], v15 offset:16384
    v_mfma_f32_16x16x32_bf16 v[160:163], v[48:51], v[104:107], v[160:163]
    ds_read_b64_tr_b16 v[110:111], v15 offset:18432
    v_mfma_f32_16x16x32_bf16 v[164:167], v[80:83], v[52:55], v[164:167]
    ds_read_b64_tr_b16 v[112:113], v17 offset:16384
    v_mfma_f32_16x16x32_bf16 v[168:171], v[84:87], v[52:55], v[168:171]
    ds_read_b64_tr_b16 v[114:115], v17 offset:18432
    v_mfma_f32_16x16x32_bf16 v[172:175], v[88:91], v[52:55], v[172:175]
    ds_read_b64_tr_b16 v[116:117], v19 offset:16384
    v_mfma_f32_16x16x32_bf16 v[176:179], v[92:95], v[52:55], v[176:179]
    ds_read_b64_tr_b16 v[118:119], v19 offset:18432
    v_mfma_f32_16x16x32_bf16 v[180:183], v[52:55], v[96:99], v[180:183]
    ds_read_b64_tr_b16 v[120:121], v21 offset:16384
    v_mfma_f32_16x16x32_bf16 v[184:187], v[52:55], v[100:103], v[184:187]
    ds_read_b64_tr_b16 v[122:123], v21 offset:18432
    v_mfma_f32_16x16x32_bf16 v[188:191], v[52:55], v[104:107], v[188:191]
    ds_read_b64_tr_b16 v[124:125], v23 offset:16384
    v_mfma_f32_16x16x32_bf16 v[192:195], v[80:83], v[56:59], v[192:195]
    ds_read_b64_tr_b16 v[126:127], v23 offset:18432
    v_mfma_f32_16x16x32_bf16 v[196:199], v[84:87], v[56:59], v[196:199]
    ds_read_b64_tr_b16 v[128:129], v25 offset:16384
    v_mfma_f32_16x16x32_bf16 v[200:203], v[88:91], v[56:59], v[200:203]
    ds_read_b64_tr_b16 v[130:131], v25 offset:18432
    v_mfma_f32_16x16x32_bf16 v[204:207], v[92:95], v[56:59], v[204:207]
    ds_read_b64_tr_b16 v[132:133], v27 offset:16384
    v_mfma_f32_16x16x32_bf16 v[208:211], v[56:59], v[96:99], v[208:211]
    ds_read_b64_tr_b16 v[134:135], v27 offset:18432
    v_mfma_f32_16x16x32_bf16 v[212:215], v[56:59], v[100:103], v[212:215]
    ds_read_b128 v[68:71], v14 offset:2048
    v_mfma_f32_16x16x32_bf16 v[216:219], v[56:59], v[104:107], v[216:219]
    ds_read_b128 v[72:75], v14 offset:4096
    v_mfma_f32_16x16x32_bf16 v[220:223], v[80:83], v[60:63], v[220:223]
    ds_read_b128 v[76:79], v14 offset:6144
    v_mfma_f32_16x16x32_bf16 v[224:227], v[84:87], v[60:63], v[224:227]
    v_mfma_f32_16x16x32_bf16 v[228:231], v[88:91], v[60:63], v[228:231]
    v_mfma_f32_16x16x32_bf16 v[232:235], v[92:95], v[60:63], v[232:235]
    v_mfma_f32_16x16x32_bf16 v[236:239], v[60:63], v[96:99], v[236:239]
    v_mfma_f32_16x16x32_bf16 v[240:243], v[60:63], v[100:103], v[240:243]
    v_mfma_f32_16x16x32_bf16 v[244:247], v[60:63], v[104:107], v[244:247]
    s_waitcnt lgkmcnt(0)
    v_mfma_f32_16x16x32_bf16 v[136:139], v[108:111], v[64:67], v[136:139]
    v_mfma_f32_16x16x32_bf16 v[140:143], v[112:115], v[64:67], v[140:143]
    v_mfma_f32_16x16x32_bf16 v[144:147], v[116:119], v[64:67], v[144:147]
    v_mfma_f32_16x16x32_bf16 v[148:151], v[120:123], v[64:67], v[148:151]
    s_barrier
    v_mfma_f32_16x16x32_bf16 v[152:155], v[64:67], v[124:127], v[152:155]
    ds_read_b128 v[48:51], v13 offset:16384
    v_mfma_f32_16x16x32_bf16 v[156:159], v[64:67], v[128:131], v[156:159]
    ds_read_b64_tr_b16 v[80:81], v15 offset:32768
    v_mfma_f32_16x16x32_bf16 v[160:163], v[64:67], v[132:135], v[160:163]
    ds_read_b64_tr_b16 v[82:83], v15 offset:34816
    v_mfma_f32_16x16x32_bf16 v[164:167], v[108:111], v[68:71], v[164:167]
    ds_read_b64_tr_b16 v[84:85], v17 offset:32768
    v_mfma_f32_16x16x32_bf16 v[168:171], v[112:115], v[68:71], v[168:171]
    ds_read_b64_tr_b16 v[86:87], v17 offset:34816
    v_mfma_f32_16x16x32_bf16 v[172:175], v[116:119], v[68:71], v[172:175]
    ds_read_b64_tr_b16 v[88:89], v19 offset:32768
    v_mfma_f32_16x16x32_bf16 v[176:179], v[120:123], v[68:71], v[176:179]
    ds_read_b64_tr_b16 v[90:91], v19 offset:34816
    v_mfma_f32_16x16x32_bf16 v[180:183], v[68:71], v[124:127], v[180:183]
    ds_read_b64_tr_b16 v[92:93], v21 offset:32768
    v_mfma_f32_16x16x32_bf16 v[184:187], v[68:71], v[128:131], v[184:187]
    ds_read_b64_tr_b16 v[94:95], v21 offset:34816
    v_mfma_f32_16x16x32_bf16 v[188:191], v[68:71], v[132:135], v[188:191]
    ds_read_b64_tr_b16 v[96:97], v23 offset:32768
    v_mfma_f32_16x16x32_bf16 v[192:195], v[108:111], v[72:75], v[192:195]
    ds_read_b64_tr_b16 v[98:99], v23 offset:34816
    v_mfma_f32_16x16x32_bf16 v[196:199], v[112:115], v[72:75], v[196:199]
    ds_read_b64_tr_b16 v[100:101], v25 offset:32768
    v_mfma_f32_16x16x32_bf16 v[200:203], v[116:119], v[72:75], v[200:203]
    ds_read_b64_tr_b16 v[102:103], v25 offset:34816
    v_mfma_f32_16x16x32_bf16 v[204:207], v[120:123], v[72:75], v[204:207]
    ds_read_b64_tr_b16 v[104:105], v27 offset:32768
    v_mfma_f32_16x16x32_bf16 v[208:211], v[72:75], v[124:127], v[208:211]
    ds_read_b64_tr_b16 v[106:107], v27 offset:34816
    v_mfma_f32_16x16x32_bf16 v[212:215], v[72:75], v[128:131], v[212:215]
    ds_read_b128 v[52:55], v13 offset:18432
    v_mfma_f32_16x16x32_bf16 v[216:219], v[72:75], v[132:135], v[216:219]
    ds_read_b128 v[56:59], v13 offset:20480
    v_mfma_f32_16x16x32_bf16 v[220:223], v[108:111], v[76:79], v[220:223]
    ds_read_b128 v[60:63], v13 offset:22528
    v_mfma_f32_16x16x32_bf16 v[224:227], v[112:115], v[76:79], v[224:227]
    v_mfma_f32_16x16x32_bf16 v[228:231], v[116:119], v[76:79], v[228:231]
    v_mfma_f32_16x16x32_bf16 v[232:235], v[120:123], v[76:79], v[232:235]
    v_mfma_f32_16x16x32_bf16 v[236:239], v[76:79], v[124:127], v[236:239]
    v_mfma_f32_16x16x32_bf16 v[240:243], v[76:79], v[128:131], v[240:243]
    v_mfma_f32_16x16x32_bf16 v[244:247], v[76:79], v[132:135], v[244:247]
    s_waitcnt lgkmcnt(0)
    v_mfma_f32_16x16x32_bf16 v[136:139], v[80:83], v[48:51], v[136:139]
    v_mfma_f32_16x16x32_bf16 v[140:143], v[84:87], v[48:51], v[140:143]
    v_mfma_f32_16x16x32_bf16 v[144:147], v[88:91], v[48:51], v[144:147]
    v_mfma_f32_16x16x32_bf16 v[148:151], v[92:95], v[48:51], v[148:151]
    v_mfma_f32_16x16x32_bf16 v[152:155], v[48:51], v[96:99], v[152:155]
    ds_read_b128 v[64:67], v14 offset:16384
    v_mfma_f32_16x16x32_bf16 v[156:159], v[48:51], v[100:103], v[156:159]
    ds_read_b64_tr_b16 v[108:109], v16 offset:0
    v_mfma_f32_16x16x32_bf16 v[160:163], v[48:51], v[104:107], v[160:163]
    ds_read_b64_tr_b16 v[110:111], v16 offset:2048
    v_mfma_f32_16x16x32_bf16 v[164:167], v[80:83], v[52:55], v[164:167]
    ds_read_b64_tr_b16 v[112:113], v18 offset:0
    v_mfma_f32_16x16x32_bf16 v[168:171], v[84:87], v[52:55], v[168:171]
    ds_read_b64_tr_b16 v[114:115], v18 offset:2048
    v_mfma_f32_16x16x32_bf16 v[172:175], v[88:91], v[52:55], v[172:175]
    ds_read_b64_tr_b16 v[116:117], v20 offset:0
    v_mfma_f32_16x16x32_bf16 v[176:179], v[92:95], v[52:55], v[176:179]
    ds_read_b64_tr_b16 v[118:119], v20 offset:2048
    v_mfma_f32_16x16x32_bf16 v[180:183], v[52:55], v[96:99], v[180:183]
    ds_read_b64_tr_b16 v[120:121], v22 offset:0
    v_mfma_f32_16x16x32_bf16 v[184:187], v[52:55], v[100:103], v[184:187]
    ds_read_b64_tr_b16 v[122:123], v22 offset:2048
    v_mfma_f32_16x16x32_bf16 v[188:191], v[52:55], v[104:107], v[188:191]
    ds_read_b64_tr_b16 v[124:125], v24 offset:0
    v_mfma_f32_16x16x32_bf16 v[192:195], v[80:83], v[56:59], v[192:195]
    ds_read_b64_tr_b16 v[126:127], v24 offset:2048
    v_mfma_f32_16x16x32_bf16 v[196:199], v[84:87], v[56:59], v[196:199]
    ds_read_b64_tr_b16 v[128:129], v26 offset:0
    v_mfma_f32_16x16x32_bf16 v[200:203], v[88:91], v[56:59], v[200:203]
    ds_read_b64_tr_b16 v[130:131], v26 offset:2048
    v_mfma_f32_16x16x32_bf16 v[204:207], v[92:95], v[56:59], v[204:207]
    ds_read_b64_tr_b16 v[132:133], v28 offset:0
    v_mfma_f32_16x16x32_bf16 v[208:211], v[56:59], v[96:99], v[208:211]
    ds_read_b64_tr_b16 v[134:135], v28 offset:2048
    v_mfma_f32_16x16x32_bf16 v[212:215], v[56:59], v[100:103], v[212:215]
    ds_read_b128 v[68:71], v14 offset:18432
    v_mfma_f32_16x16x32_bf16 v[216:219], v[56:59], v[104:107], v[216:219]
    ds_read_b128 v[72:75], v14 offset:20480
    v_mfma_f32_16x16x32_bf16 v[220:223], v[80:83], v[60:63], v[220:223]
    ds_read_b128 v[76:79], v14 offset:22528
    v_mfma_f32_16x16x32_bf16 v[224:227], v[84:87], v[60:63], v[224:227]
    v_mfma_f32_16x16x32_bf16 v[228:231], v[88:91], v[60:63], v[228:231]
    v_mfma_f32_16x16x32_bf16 v[232:235], v[92:95], v[60:63], v[232:235]
    v_mfma_f32_16x16x32_bf16 v[236:239], v[60:63], v[96:99], v[236:239]
    v_mfma_f32_16x16x32_bf16 v[240:243], v[60:63], v[100:103], v[240:243]
    v_mfma_f32_16x16x32_bf16 v[244:247], v[60:63], v[104:107], v[244:247]
    s_waitcnt lgkmcnt(0)
    v_mfma_f32_16x16x32_bf16 v[136:139], v[108:111], v[64:67], v[136:139]
    v_mfma_f32_16x16x32_bf16 v[140:143], v[112:115], v[64:67], v[140:143]
    v_mfma_f32_16x16x32_bf16 v[144:147], v[116:119], v[64:67], v[144:147]
    v_mfma_f32_16x16x32_bf16 v[148:151], v[120:123], v[64:67], v[148:151]
    s_barrier
    v_mfma_f32_16x16x32_bf16 v[152:155], v[64:67], v[124:127], v[152:155]
    ds_read_b128 v[48:51], v13 offset:32768
    v_mfma_f32_16x16x32_bf16 v[156:159], v[64:67], v[128:131], v[156:159]
    ds_read_b64_tr_b16 v[80:81], v16 offset:16384
    v_mfma_f32_16x16x32_bf16 v[160:163], v[64:67], v[132:135], v[160:163]
    ds_read_b64_tr_b16 v[82:83], v16 offset:18432
    v_mfma_f32_16x16x32_bf16 v[164:167], v[108:111], v[68:71], v[164:167]
    ds_read_b64_tr_b16 v[84:85], v18 offset:16384
    v_mfma_f32_16x16x32_bf16 v[168:171], v[112:115], v[68:71], v[168:171]
    ds_read_b64_tr_b16 v[86:87], v18 offset:18432
    v_mfma_f32_16x16x32_bf16 v[172:175], v[116:119], v[68:71], v[172:175]
    ds_read_b64_tr_b16 v[88:89], v20 offset:16384
    v_mfma_f32_16x16x32_bf16 v[176:179], v[120:123], v[68:71], v[176:179]
    ds_read_b64_tr_b16 v[90:91], v20 offset:18432
    v_mfma_f32_16x16x32_bf16 v[180:183], v[68:71], v[124:127], v[180:183]
    ds_read_b64_tr_b16 v[92:93], v22 offset:16384
    v_mfma_f32_16x16x32_bf16 v[184:187], v[68:71], v[128:131], v[184:187]
    ds_read_b64_tr_b16 v[94:95], v22 offset:18432
    v_mfma_f32_16x16x32_bf16 v[188:191], v[68:71], v[132:135], v[188:191]
    ds_read_b64_tr_b16 v[96:97], v24 offset:16384
    v_mfma_f32_16x16x32_bf16 v[192:195], v[108:111], v[72:75], v[192:195]
    ds_read_b64_tr_b16 v[98:99], v24 offset:18432
    v_mfma_f32_16x16x32_bf16 v[196:199], v[112:115], v[72:75], v[196:199]
    ds_read_b64_tr_b16 v[100:101], v26 offset:16384
    v_mfma_f32_16x16x32_bf16 v[200:203], v[116:119], v[72:75], v[200:203]
    ds_read_b64_tr_b16 v[102:103], v26 offset:18432
    v_mfma_f32_16x16x32_bf16 v[204:207], v[120:123], v[72:75], v[204:207]
    ds_read_b64_tr_b16 v[104:105], v28 offset:16384
    v_mfma_f32_16x16x32_bf16 v[208:211], v[72:75], v[124:127], v[208:211]
    ds_read_b64_tr_b16 v[106:107], v28 offset:18432
    v_mfma_f32_16x16x32_bf16 v[212:215], v[72:75], v[128:131], v[212:215]
    ds_read_b128 v[52:55], v13 offset:34816
    v_mfma_f32_16x16x32_bf16 v[216:219], v[72:75], v[132:135], v[216:219]
    ds_read_b128 v[56:59], v13 offset:36864
    v_mfma_f32_16x16x32_bf16 v[220:223], v[108:111], v[76:79], v[220:223]
    ds_read_b128 v[60:63], v13 offset:38912
    v_mfma_f32_16x16x32_bf16 v[224:227], v[112:115], v[76:79], v[224:227]
    v_mfma_f32_16x16x32_bf16 v[228:231], v[116:119], v[76:79], v[228:231]
    v_mfma_f32_16x16x32_bf16 v[232:235], v[120:123], v[76:79], v[232:235]
    v_mfma_f32_16x16x32_bf16 v[236:239], v[76:79], v[124:127], v[236:239]
    v_mfma_f32_16x16x32_bf16 v[240:243], v[76:79], v[128:131], v[240:243]
    v_mfma_f32_16x16x32_bf16 v[244:247], v[76:79], v[132:135], v[244:247]
    s_waitcnt lgkmcnt(0)
    v_mfma_f32_16x16x32_bf16 v[136:139], v[80:83], v[48:51], v[136:139]
    v_mfma_f32_16x16x32_bf16 v[140:143], v[84:87], v[48:51], v[140:143]
    v_mfma_f32_16x16x32_bf16 v[144:147], v[88:91], v[48:51], v[144:147]
    v_mfma_f32_16x16x32_bf16 v[148:151], v[92:95], v[48:51], v[148:151]
    v_mfma_f32_16x16x32_bf16 v[152:155], v[48:51], v[96:99], v[152:155]
    ds_read_b128 v[64:67], v14 offset:32768
    v_mfma_f32_16x16x32_bf16 v[156:159], v[48:51], v[100:103], v[156:159]
    ds_read_b64_tr_b16 v[108:109], v16 offset:32768
    v_mfma_f32_16x16x32_bf16 v[160:163], v[48:51], v[104:107], v[160:163]
    ds_read_b64_tr_b16 v[110:111], v16 offset:34816
    v_mfma_f32_16x16x32_bf16 v[164:167], v[80:83], v[52:55], v[164:167]
    ds_read_b64_tr_b16 v[112:113], v18 offset:32768
    v_mfma_f32_16x16x32_bf16 v[168:171], v[84:87], v[52:55], v[168:171]
    ds_read_b64_tr_b16 v[114:115], v18 offset:34816
    v_mfma_f32_16x16x32_bf16 v[172:175], v[88:91], v[52:55], v[172:175]
    ds_read_b64_tr_b16 v[116:117], v20 offset:32768
    v_mfma_f32_16x16x32_bf16 v[176:179], v[92:95], v[52:55], v[176:179]
    ds_read_b64_tr_b16 v[118:119], v20 offset:34816
    v_mfma_f32_16x16x32_bf16 v[180:183], v[52:55], v[96:99], v[180:183]
    ds_read_b64_tr_b16 v[120:121], v22 offset:32768
    v_mfma_f32_16x16x32_bf16 v[184:187], v[52:55], v[100:103], v[184:187]
    ds_read_b64_tr_b16 v[122:123], v22 offset:34816
    v_mfma_f32_16x16x32_bf16 v[188:191], v[52:55], v[104:107], v[188:191]
    ds_read_b64_tr_b16 v[124:125], v24 offset:32768
    v_mfma_f32_16x16x32_bf16 v[192:195], v[80:83], v[56:59], v[192:195]
    ds_read_b64_tr_b16 v[126:127], v24 offset:34816
    v_mfma_f32_16x16x32_bf16 v[196:199], v[84:87], v[56:59], v[196:199]
    ds_read_b64_tr_b16 v[128:129], v26 offset:32768
    v_mfma_f32_16x16x32_bf16 v[200:203], v[88:91], v[56:59], v[200:203]
    ds_read_b64_tr_b16 v[130:131], v26 offset:34816
    v_mfma_f32_16x16x32_bf16 v[204:207], v[92:95], v[56:59], v[204:207]
    ds_read_b64_tr_b16 v[132:133], v28 offset:32768
    v_mfma_f32_16x16x32_bf16 v[208:211], v[56:59], v[96:99], v[208:211]
    ds_read_b64_tr_b16 v[134:135], v28 offset:34816
    v_mfma_f32_16x16x32_bf16 v[212:215], v[56:59], v[100:103], v[212:215]
    ds_read_b128 v[68:71], v14 offset:34816
    v_mfma_f32_16x16x32_bf16 v[216:219], v[56:59], v[104:107], v[216:219]
    ds_read_b128 v[72:75], v14 offset:36864
    v_mfma_f32_16x16x32_bf16 v[220:223], v[80:83], v[60:63], v[220:223]
    ds_read_b128 v[76:79], v14 offset:38912
    v_mfma_f32_16x16x32_bf16 v[224:227], v[84:87], v[60:63], v[224:227]
    v_mfma_f32_16x16x32_bf16 v[228:231], v[88:91], v[60:63], v[228:231]
    v_mfma_f32_16x16x32_bf16 v[232:235], v[92:95], v[60:63], v[232:235]
    v_mfma_f32_16x16x32_bf16 v[236:239], v[60:63], v[96:99], v[236:239]
    v_mfma_f32_16x16x32_bf16 v[240:243], v[60:63], v[100:103], v[240:243]
    v_mfma_f32_16x16x32_bf16 v[244:247], v[60:63], v[104:107], v[244:247]
    s_waitcnt lgkmcnt(0)
    v_mfma_f32_16x16x32_bf16 v[160:163], v[64:67], v[132:135], v[160:163]
    v_mfma_f32_16x16x32_bf16 v[188:191], v[68:71], v[132:135], v[188:191]
    v_mfma_f32_16x16x32_bf16 v[216:219], v[72:75], v[132:135], v[216:219]
    v_mfma_f32_16x16x32_bf16 v[244:247], v[76:79], v[132:135], v[244:247]
    v_mfma_f32_16x16x32_bf16 v[144:147], v[116:119], v[64:67], v[144:147]
    s_mov_b32 s42, 0x3eae1a93
    s_mov_b32 s43, 0x3eae1a93
    v_mfma_f32_16x16x32_bf16 v[172:175], v[116:119], v[68:71], v[172:175]
    v_lshlrev_b32 v2, 4, v1
    v_bfe_u32 v3, v1, 2, 2
    v_mfma_f32_16x16x32_bf16 v[200:203], v[116:119], v[72:75], v[200:203]
    v_lshlrev_b32 v3, 18, v3
    v_bfe_u32 v4, v1, 1, 1
    v_mfma_f32_16x16x32_bf16 v[228:231], v[116:119], v[76:79], v[228:231]
    v_lshl_add_u32 v3, v4, 13, v3
    v_lshrrev_b32 v4, 4, v1
    v_mfma_f32_16x16x32_bf16 v[148:151], v[120:123], v[64:67], v[148:151]
    v_lshlrev_b32 v8, 4, v4
    v_add_u32 v3, v8, v3
    v_mfma_f32_16x16x32_bf16 v[176:179], v[120:123], v[68:71], v[176:179]
    s_lshl_b32 s33, s24, 17
    s_lshl_b32 s35, s46, 5
    v_mfma_f32_16x16x32_bf16 v[204:207], v[120:123], v[72:75], v[204:207]
    s_add_u32 s33, s33, s35
    s_lshl_b32 s40, s24, 14
    v_mfma_f32_16x16x32_bf16 v[232:235], v[120:123], v[76:79], v[232:235]
    s_lshl_b32 s35, s46, 2
    s_add_u32 s40, s40, s35
    v_mfma_f32_16x16x32_bf16 v[136:139], v[108:111], v[64:67], v[136:139]
    v_lshrrev_b32 v4, 5, v1
    v_mul_u32_u24 v5, 73728, v4
    v_mfma_f32_16x16x32_bf16 v[164:167], v[108:111], v[68:71], v[164:167]
    v_bfe_u32 v4, v1, 4, 1
    v_mul_u32_u24 v4, 288, v4
    v_mfma_f32_16x16x32_bf16 v[192:195], v[108:111], v[72:75], v[192:195]
    v_add_u32 v5, v5, v4
    v_and_b32 v6, 15, v1
    v_mfma_f32_16x16x32_bf16 v[220:223], v[108:111], v[76:79], v[220:223]
    v_lshl_add_u32 v5, v6, 4, v5
    v_bfe_u32 v6, v1, 1, 1
    v_mfma_f32_16x16x32_bf16 v[140:143], v[112:115], v[64:67], v[140:143]
    v_mul_u32_u24 v6, 73728, v6
    v_add_u32 v6, v6, v4
    v_mfma_f32_16x16x32_bf16 v[168:171], v[112:115], v[68:71], v[168:171]
    v_and_b32 v4, 1, v1
    v_lshl_add_u32 v6, v4, 4, v6
    v_mfma_f32_16x16x32_bf16 v[196:199], v[112:115], v[72:75], v[196:199]
    v_lshrrev_b32 v4, 5, v1
    v_lshl_add_u32 v6, v4, 3, v6
    v_mfma_f32_16x16x32_bf16 v[224:227], v[112:115], v[76:79], v[224:227]
    v_add_u32 v6, 256, v6

    v_mfma_f32_16x16x32_bf16 v[152:155], v[64:67], v[124:127], v[152:155]
    v_mov_b32 v10, 0
    v_mov_b32 v11, 0
    v_mfma_f32_16x16x32_bf16 v[180:183], v[68:71], v[124:127], v[180:183]
    v_mov_b32 v12, 0
    v_mov_b32 v13, 0
    v_mfma_f32_16x16x32_bf16 v[208:211], v[72:75], v[124:127], v[208:211]
    v_mov_b32 v14, 0
    v_mov_b32 v15, 0
    v_mfma_f32_16x16x32_bf16 v[236:239], v[76:79], v[124:127], v[236:239]
    v_mov_b32 v16, 0
    v_mov_b32 v17, 0
    v_mfma_f32_16x16x32_bf16 v[156:159], v[64:67], v[128:131], v[156:159]
    v_mov_b32 v18, 0
    v_mov_b32 v19, 0
    v_mfma_f32_16x16x32_bf16 v[184:187], v[68:71], v[128:131], v[184:187]
    v_mov_b32 v20, 0
    v_mov_b32 v21, 0
    v_mfma_f32_16x16x32_bf16 v[212:215], v[72:75], v[128:131], v[212:215]
    v_mov_b32 v22, 0
    v_mov_b32 v23, 0
    v_mfma_f32_16x16x32_bf16 v[240:243], v[76:79], v[128:131], v[240:243]
    v_mov_b32 v24, 0
    v_mov_b32 v25, 0
    s_waitcnt vmcnt(0)
    s_nop 3
    s_lshl_b32 s34, s20, 10
    s_add_u32 s34, s34, 2048
    v_bfe_u32 v9, v1, 1, 2
    v_lshlrev_b32 v9, 8, v9
    v_add3_u32 v9, v9, v8, s34

    v_mov_b32 v7, 1.0
    s_mov_b32 exec_lo, 0x000f000f
    s_mov_b32 exec_hi, 0x000f000f
    v_mov_b32 v7, s42
    s_mov_b64 exec, -1
    s_add_u32 s35, s40, 6291456
    v_mul_f32 v96, v7, v160
    v_mul_f32 v97, v7, v161
    v_mul_f32 v98, v7, v162
    v_mul_f32 v99, v7, v163
    s_nop 1
    v_mov_b32_dpp v92, v96 quad_perm:[1,0,3,2] row_mask:0xf bank_mask:0xf
    v_mov_b32_dpp v93, v97 quad_perm:[1,0,3,2] row_mask:0xf bank_mask:0xf
    v_mov_b32_dpp v94, v98 quad_perm:[1,0,3,2] row_mask:0xf bank_mask:0xf
    v_mov_b32_dpp v95, v99 quad_perm:[1,0,3,2] row_mask:0xf bank_mask:0xf
    v_cvt_pk_bf16_f32 v88, v96, v92
    v_cvt_pk_bf16_f32 v89, v97, v93
    v_cvt_pk_bf16_f32 v90, v98, v94
    v_cvt_pk_bf16_f32 v91, v99, v95
    s_mov_b32 exec_lo, 0x00550055
    s_mov_b32 exec_hi, 0x00550055
    ds_write_b128 v9, v[88:91] offset:0
    s_mov_b32 exec_lo, 0x00500050
    s_mov_b32 exec_hi, 0x00500050
    buffer_store_dwordx4 v[88:91], v3, s[12:15], s35 offen offset:0
    s_mov_b64 exec, -1
    v_mul_f32 v108, v7, v188
    v_mul_f32 v109, v7, v189
    v_mul_f32 v110, v7, v190
    v_mul_f32 v111, v7, v191
    s_nop 1
    v_mov_b32_dpp v104, v108 quad_perm:[1,0,3,2] row_mask:0xf bank_mask:0xf
    v_mov_b32_dpp v105, v109 quad_perm:[1,0,3,2] row_mask:0xf bank_mask:0xf
    v_mov_b32_dpp v106, v110 quad_perm:[1,0,3,2] row_mask:0xf bank_mask:0xf
    v_mov_b32_dpp v107, v111 quad_perm:[1,0,3,2] row_mask:0xf bank_mask:0xf
    v_cvt_pk_bf16_f32 v100, v108, v104
    v_cvt_pk_bf16_f32 v101, v109, v105
    v_cvt_pk_bf16_f32 v102, v110, v106
    v_cvt_pk_bf16_f32 v103, v111, v107
    s_mov_b32 exec_lo, 0x00550055
    s_mov_b32 exec_hi, 0x00550055
    ds_write_b128 v9, v[100:103] offset:64
    s_mov_b32 exec_lo, 0x00500050
    s_mov_b32 exec_hi, 0x00500050
    buffer_store_dwordx4 v[100:103], v3, s[12:15], s35 offen offset:64
    s_mov_b64 exec, -1
    v_mul_f32 v120, v7, v216
    v_mul_f32 v121, v7, v217
    v_mul_f32 v122, v7, v218
    v_mul_f32 v123, v7, v219
    s_nop 1
    v_mov_b32_dpp v116, v120 quad_perm:[1,0,3,2] row_mask:0xf bank_mask:0xf
    v_mov_b32_dpp v117, v121 quad_perm:[1,0,3,2] row_mask:0xf bank_mask:0xf
    v_mov_b32_dpp v118, v122 quad_perm:[1,0,3,2] row_mask:0xf bank_mask:0xf
    v_mov_b32_dpp v119, v123 quad_perm:[1,0,3,2] row_mask:0xf bank_mask:0xf
    v_cvt_pk_bf16_f32 v112, v120, v116
    v_cvt_pk_bf16_f32 v113, v121, v117
    v_cvt_pk_bf16_f32 v114, v122, v118
    v_cvt_pk_bf16_f32 v115, v123, v119
    s_mov_b32 exec_lo, 0x00550055
    s_mov_b32 exec_hi, 0x00550055
    ds_write_b128 v9, v[112:115] offset:128
    s_mov_b32 exec_lo, 0x00500050
    s_mov_b32 exec_hi, 0x00500050
    buffer_store_dwordx4 v[112:115], v3, s[12:15], s35 offen offset:128
    s_mov_b64 exec, -1
    v_mul_f32 v132, v7, v244
    v_mul_f32 v133, v7, v245
    v_mul_f32 v134, v7, v246
    v_mul_f32 v135, v7, v247
    s_nop 1
    v_mov_b32_dpp v128, v132 quad_perm:[1,0,3,2] row_mask:0xf bank_mask:0xf
    v_mov_b32_dpp v129, v133 quad_perm:[1,0,3,2] row_mask:0xf bank_mask:0xf
    v_mov_b32_dpp v130, v134 quad_perm:[1,0,3,2] row_mask:0xf bank_mask:0xf
    v_mov_b32_dpp v131, v135 quad_perm:[1,0,3,2] row_mask:0xf bank_mask:0xf
    v_cvt_pk_bf16_f32 v124, v132, v128
    v_cvt_pk_bf16_f32 v125, v133, v129
    v_cvt_pk_bf16_f32 v126, v134, v130
    v_cvt_pk_bf16_f32 v127, v135, v131
    s_mov_b32 exec_lo, 0x00550055
    s_mov_b32 exec_hi, 0x00550055
    ds_write_b128 v9, v[124:127] offset:192
    s_mov_b32 exec_lo, 0x00500050
    s_mov_b32 exec_hi, 0x00500050
    buffer_store_dwordx4 v[124:127], v3, s[12:15], s35 offen offset:192
    s_mov_b64 exec, -1
    v_lshlrev_b32 v9, 2, v1
    v_add_u32 v9, s34, v9
    s_waitcnt lgkmcnt(0)
    s_mov_b32 exec_lo, 0xffffffff
    s_mov_b32 exec_hi, 0x00000000
    ds_read_b32 v10, v9 offset:0
    ds_read_b32 v12, v9 offset:128
    ds_read_b32 v14, v9 offset:256
    ds_read_b32 v16, v9 offset:384
    ds_read_b32 v18, v9 offset:512
    ds_read_b32 v20, v9 offset:640
    ds_read_b32 v22, v9 offset:768
    ds_read_b32 v24, v9 offset:896
    s_mov_b64 exec, -1
    s_cmp_eq_u32 s3, 0
    s_cbranch_scc1 L_k1_A_nogate
    s_lshl_b32 s35, s46, 2
    s_add_u32 s35, s35, 7077888
    s_mov_b32 exec_lo, 0x10001000
    s_mov_b32 exec_hi, 0x10001000
    buffer_store_dwordx4 v[160:163], v8, s[12:15], s35 offen offset:0
    buffer_store_dwordx4 v[188:191], v8, s[12:15], s35 offen offset:64
    buffer_store_dwordx4 v[216:219], v8, s[12:15], s35 offen offset:128
    buffer_store_dwordx4 v[244:247], v8, s[12:15], s35 offen offset:192
    s_mov_b64 exec, -1
L_k1_A_nogate:
    v_cvt_pk_bf16_f32 v48, v144, v145
    v_cvt_pk_bf16_f32 v49, v146, v147
    v_cvt_pk_bf16_f32 v50, v172, v173
    v_cvt_pk_bf16_f32 v51, v174, v175
    s_add_u32 s35, s33, 2097152
    s_nop 0
    v_permlane16_swap_b32 v48, v50
    v_permlane16_swap_b32 v49, v51
    buffer_store_dwordx4 v[48:51], v2, s[12:15], s35 offen offset:0
    v_cvt_pk_bf16_f32 v52, v200, v201
    v_cvt_pk_bf16_f32 v53, v202, v203
    v_cvt_pk_bf16_f32 v54, v228, v229
    v_cvt_pk_bf16_f32 v55, v230, v231
    s_nop 0
    s_nop 0
    v_permlane16_swap_b32 v52, v54
    v_permlane16_swap_b32 v53, v55
    buffer_store_dwordx4 v[52:55], v2, s[12:15], s35 offen offset:1024
    v_cvt_pk_bf16_f32 v56, v148, v149
    v_cvt_pk_bf16_f32 v57, v150, v151
    v_cvt_pk_bf16_f32 v58, v176, v177
    v_cvt_pk_bf16_f32 v59, v178, v179
    s_add_u32 s35, s33, 2162688
    s_nop 0
    v_permlane16_swap_b32 v56, v58
    v_permlane16_swap_b32 v57, v59
    buffer_store_dwordx4 v[56:59], v2, s[12:15], s35 offen offset:0
    v_cvt_pk_bf16_f32 v60, v204, v205
    v_cvt_pk_bf16_f32 v61, v206, v207
    v_cvt_pk_bf16_f32 v62, v232, v233
    v_cvt_pk_bf16_f32 v63, v234, v235
    s_nop 0
    s_nop 0
    v_permlane16_swap_b32 v60, v62
    v_permlane16_swap_b32 v61, v63
    buffer_store_dwordx4 v[60:63], v2, s[12:15], s35 offen offset:1024
    v_pk_mul_f32 v[136:137], v[136:137], s[42:43]
    v_pk_mul_f32 v[138:139], v[138:139], s[42:43]
    v_pk_mul_f32 v[164:165], v[164:165], s[42:43]
    v_pk_mul_f32 v[166:167], v[166:167], s[42:43]
    v_cvt_pk_bf16_f32 v64, v136, v137
    v_cvt_pk_bf16_f32 v65, v138, v139
    v_cvt_pk_bf16_f32 v66, v164, v165
    v_cvt_pk_bf16_f32 v67, v166, v167
    s_add_u32 s35, s33, 0
    s_nop 0
    v_permlane16_swap_b32 v64, v66
    v_permlane16_swap_b32 v65, v67
    buffer_store_dwordx4 v[64:67], v2, s[12:15], s35 offen offset:0
    v_pk_mul_f32 v[192:193], v[192:193], s[42:43]
    v_pk_mul_f32 v[194:195], v[194:195], s[42:43]
    v_pk_mul_f32 v[220:221], v[220:221], s[42:43]
    v_pk_mul_f32 v[222:223], v[222:223], s[42:43]
    v_cvt_pk_bf16_f32 v68, v192, v193
    v_cvt_pk_bf16_f32 v69, v194, v195
    v_cvt_pk_bf16_f32 v70, v220, v221
    v_cvt_pk_bf16_f32 v71, v222, v223
    s_nop 0
    s_nop 0
    v_permlane16_swap_b32 v68, v70
    v_permlane16_swap_b32 v69, v71
    buffer_store_dwordx4 v[68:71], v2, s[12:15], s35 offen offset:1024
    v_pk_mul_f32 v[140:141], v[140:141], s[42:43]
    v_pk_mul_f32 v[142:143], v[142:143], s[42:43]
    v_pk_mul_f32 v[168:169], v[168:169], s[42:43]
    v_pk_mul_f32 v[170:171], v[170:171], s[42:43]
    v_cvt_pk_bf16_f32 v72, v140, v141
    v_cvt_pk_bf16_f32 v73, v142, v143
    v_cvt_pk_bf16_f32 v74, v168, v169
    v_cvt_pk_bf16_f32 v75, v170, v171
    s_add_u32 s35, s33, 65536
    s_nop 0
    v_permlane16_swap_b32 v72, v74
    v_permlane16_swap_b32 v73, v75
    buffer_store_dwordx4 v[72:75], v2, s[12:15], s35 offen offset:0
    v_pk_mul_f32 v[196:197], v[196:197], s[42:43]
    v_pk_mul_f32 v[198:199], v[198:199], s[42:43]
    v_pk_mul_f32 v[224:225], v[224:225], s[42:43]
    v_pk_mul_f32 v[226:227], v[226:227], s[42:43]
    v_cvt_pk_bf16_f32 v76, v196, v197
    v_cvt_pk_bf16_f32 v77, v198, v199
    v_cvt_pk_bf16_f32 v78, v224, v225
    v_cvt_pk_bf16_f32 v79, v226, v227
    s_nop 0
    s_nop 0
    v_permlane16_swap_b32 v76, v78
    v_permlane16_swap_b32 v77, v79
    buffer_store_dwordx4 v[76:79], v2, s[12:15], s35 offen offset:1024
    s_waitcnt lgkmcnt(0)
    v_mfma_f32_32x32x16_bf16 v[136:151], v[48:51], v[64:67], 0
    v_mfma_f32_32x32x8_bf16 v[136:151], v[18:19], v[10:11], v[136:151]
    v_mfma_f32_32x32x16_bf16 v[164:179], v[52:55], v[68:71], 0
    v_mfma_f32_32x32x8_bf16 v[164:179], v[20:21], v[12:13], v[164:179]
    v_mfma_f32_32x32x16_bf16 v[192:207], v[56:59], v[72:75], 0
    v_mfma_f32_32x32x8_bf16 v[192:207], v[22:23], v[14:15], v[192:207]
    v_mfma_f32_32x32x16_bf16 v[220:235], v[60:63], v[76:79], 0
    v_mfma_f32_32x32x8_bf16 v[220:235], v[24:25], v[16:17], v[220:235]
    s_mul_i32 s33, s24, 147456
    s_mul_i32 s34, s46, 36
    s_add_u32 s33, s33, s34
    s_add_u32 s33, s33, 8388608
    v_cvt_pk_bf16_f32 v80, v152, v153
    v_cvt_pk_bf16_f32 v81, v154, v155
    v_cvt_pk_bf16_f32 v82, v156, v157
    v_cvt_pk_bf16_f32 v83, v158, v159
    v_cvt_pk_bf16_f32 v84, v160, v161
    v_cvt_pk_bf16_f32 v85, v162, v163
    v_permlane32_swap_b32 v80, v82
    v_permlane32_swap_b32 v81, v83
    buffer_store_dwordx4 v[80:83], v5, s[12:15], s33 offen offset:0
    s_mov_b32 exec_lo, 0x0f000f00
    s_mov_b32 exec_hi, 0x0f000f00
    buffer_store_dwordx2 v[84:85], v6, s[12:15], s33 offen offset:0
    s_mov_b64 exec, -1
    v_cvt_pk_bf16_f32 v86, v180, v181
    v_cvt_pk_bf16_f32 v87, v182, v183
    v_cvt_pk_bf16_f32 v88, v184, v185
    v_cvt_pk_bf16_f32 v89, v186, v187
    v_cvt_pk_bf16_f32 v90, v188, v189
    v_cvt_pk_bf16_f32 v91, v190, v191
    v_permlane32_swap_b32 v86, v88
    v_permlane32_swap_b32 v87, v89
    buffer_store_dwordx4 v[86:89], v5, s[12:15], s33 offen offset:576
    s_mov_b32 exec_lo, 0x0f000f00
    s_mov_b32 exec_hi, 0x0f000f00
    buffer_store_dwordx2 v[90:91], v6, s[12:15], s33 offen offset:576
    s_mov_b64 exec, -1
    v_cvt_pk_bf16_f32 v92, v208, v209
    v_cvt_pk_bf16_f32 v93, v210, v211
    v_cvt_pk_bf16_f32 v94, v212, v213
    v_cvt_pk_bf16_f32 v95, v214, v215
    v_cvt_pk_bf16_f32 v96, v216, v217
    v_cvt_pk_bf16_f32 v97, v218, v219
    v_permlane32_swap_b32 v92, v94
    v_permlane32_swap_b32 v93, v95
    buffer_store_dwordx4 v[92:95], v5, s[12:15], s33 offen offset:1152
    s_mov_b32 exec_lo, 0x0f000f00
    s_mov_b32 exec_hi, 0x0f000f00
    buffer_store_dwordx2 v[96:97], v6, s[12:15], s33 offen offset:1152
    s_mov_b64 exec, -1
    v_cvt_pk_bf16_f32 v98, v236, v237
    v_cvt_pk_bf16_f32 v99, v238, v239
    v_cvt_pk_bf16_f32 v100, v240, v241
    v_cvt_pk_bf16_f32 v101, v242, v243
    v_cvt_pk_bf16_f32 v102, v244, v245
    v_cvt_pk_bf16_f32 v103, v246, v247
    v_permlane32_swap_b32 v98, v100
    v_permlane32_swap_b32 v99, v101
    buffer_store_dwordx4 v[98:101], v5, s[12:15], s33 offen offset:1728
    s_mov_b32 exec_lo, 0x0f000f00
    s_mov_b32 exec_hi, 0x0f000f00
    buffer_store_dwordx2 v[102:103], v6, s[12:15], s33 offen offset:1728
    s_mov_b64 exec, -1
    v_max3_f32 v26, v136, v137, v138
    v_max3_f32 v27, v164, v165, v166
    v_max3_f32 v28, v192, v193, v194
    v_max3_f32 v29, v220, v221, v222
    v_max3_f32 v26, v26, v139, v140
    v_max3_f32 v27, v27, v167, v168
    v_max3_f32 v28, v28, v195, v196
    v_max3_f32 v29, v29, v223, v224
    v_max3_f32 v26, v26, v141, v142
    v_max3_f32 v27, v27, v169, v170
    v_max3_f32 v28, v28, v197, v198
    v_max3_f32 v29, v29, v225, v226
    v_max3_f32 v26, v26, v143, v144
    v_max3_f32 v27, v27, v171, v172
    v_max3_f32 v28, v28, v199, v200
    v_max3_f32 v29, v29, v227, v228
    v_max3_f32 v26, v26, v145, v146
    v_max3_f32 v27, v27, v173, v174
    v_max3_f32 v28, v28, v201, v202
    v_max3_f32 v29, v29, v229, v230
    v_max3_f32 v26, v26, v147, v148
    v_max3_f32 v27, v27, v175, v176
    v_max3_f32 v28, v28, v203, v204
    v_max3_f32 v29, v29, v231, v232
    v_max3_f32 v26, v26, v149, v150
    v_max3_f32 v27, v27, v177, v178
    v_max3_f32 v28, v28, v205, v206
    v_max3_f32 v29, v29, v233, v234
    v_max_f32 v26, v26, v151
    v_max_f32 v27, v27, v179
    v_max_f32 v28, v28, v207
    v_max_f32 v29, v29, v235
    v_mov_b32 v30, v26
    v_mov_b32 v31, v27
    v_mov_b32 v32, v28
    v_mov_b32 v33, v29
    v_lshlrev_b32 v9, 3, v1
    v_permlane32_swap_b32 v30, v26
    v_permlane32_swap_b32 v31, v27
    v_permlane32_swap_b32 v32, v28
    v_permlane32_swap_b32 v33, v29
    v_max_f32 v26, v26, v30
    v_max_f32 v27, v27, v31
    v_max_f32 v28, v28, v32
    v_max_f32 v29, v29, v33
    v_cvt_pk_bf16_f32 v30, -v26, -v26
    v_cvt_pk_bf16_f32 v31, -v27, -v27
    v_cvt_pk_bf16_f32 v32, -v28, -v28
    v_cvt_pk_bf16_f32 v33, -v29, -v29
    v_lshlrev_b32 v30, 16, v30
    v_lshlrev_b32 v31, 16, v31
    v_lshlrev_b32 v32, 16, v32
    v_lshlrev_b32 v33, 16, v33
    v_add_f32 v34, v26, v30
    v_add_f32 v35, v27, v31
    v_add_f32 v36, v28, v32
    v_add_f32 v37, v29, v33
    v_cvt_pk_bf16_f32 v11, v30, -v34
    v_cvt_pk_bf16_f32 v13, v31, -v35
    v_cvt_pk_bf16_f32 v15, v32, -v36
    v_cvt_pk_bf16_f32 v17, v33, -v37
    s_lshl_b32 s35, s40, 1
    s_add_u32 s35, s35, 11010048
    s_add_u32 s34, s35, 16384
    s_mov_b32 exec_lo, 0xffffffff
    s_mov_b32 exec_hi, 0x00000000
    buffer_store_dwordx2 v[10:11], v9, s[12:15], s35 offen offset:0
    buffer_store_dwordx2 v[12:13], v9, s[12:15], s35 offen offset:256
    buffer_store_dwordx2 v[14:15], v9, s[12:15], s34 offen offset:0
    buffer_store_dwordx2 v[16:17], v9, s[12:15], s34 offen offset:256
    s_mov_b64 exec, -1
    s_endpgm
L_k1_B:
    s_waitcnt lgkmcnt(0)
    v_mfma_f32_16x16x32_bf16 v[136:139], v[80:83], v[48:51], 0
    v_mfma_f32_16x16x32_bf16 v[140:143], v[84:87], v[48:51], 0
    v_mfma_f32_16x16x32_bf16 v[144:147], v[48:51], v[88:91], 0
    v_mfma_f32_16x16x32_bf16 v[148:151], v[48:51], v[92:95], 0
    v_mfma_f32_16x16x32_bf16 v[152:155], v[48:51], v[96:99], 0
    ds_read_b128 v[64:67], v14 offset:0
    v_mfma_f32_16x16x32_bf16 v[156:159], v[48:51], v[100:103], 0
    ds_read_b64_tr_b16 v[108:109], v15 offset:16384
    v_mfma_f32_16x16x32_bf16 v[160:163], v[48:51], v[104:107], 0
    ds_read_b64_tr_b16 v[110:111], v15 offset:18432
    v_mfma_f32_16x16x32_bf16 v[164:167], v[80:83], v[52:55], 0
    ds_read_b64_tr_b16 v[112:113], v17 offset:16384
    v_mfma_f32_16x16x32_bf16 v[168:171], v[84:87], v[52:55], 0
    ds_read_b64_tr_b16 v[114:115], v17 offset:18432
    v_mfma_f32_16x16x32_bf16 v[172:175], v[52:55], v[88:91], 0
    ds_read_b64_tr_b16 v[116:117], v19 offset:16384
    v_mfma_f32_16x16x32_bf16 v[176:179], v[52:55], v[92:95], 0
    ds_read_b64_tr_b16 v[118:119], v19 offset:18432
    v_mfma_f32_16x16x32_bf16 v[180:183], v[52:55], v[96:99], 0
    ds_read_b64_tr_b16 v[120:121], v21 offset:16384
    v_mfma_f32_16x16x32_bf16 v[184:187], v[52:55], v[100:103], 0
    ds_read_b64_tr_b16 v[122:123], v21 offset:18432
    v_mfma_f32_16x16x32_bf16 v[188:191], v[52:55], v[104:107], 0
    ds_read_b64_tr_b16 v[124:125], v23 offset:16384
    v_mfma_f32_16x16x32_bf16 v[192:195], v[80:83], v[56:59], 0
    ds_read_b64_tr_b16 v[126:127], v23 offset:18432
    v_mfma_f32_16x16x32_bf16 v[196:199], v[84:87], v[56:59], 0
    ds_read_b64_tr_b16 v[128:129], v25 offset:16384
    v_mfma_f32_16x16x32_bf16 v[200:203], v[56:59], v[88:91], 0
    ds_read_b64_tr_b16 v[130:131], v25 offset:18432
    v_mfma_f32_16x16x32_bf16 v[204:207], v[56:59], v[92:95], 0
    ds_read_b64_tr_b16 v[132:133], v27 offset:16384
    v_mfma_f32_16x16x32_bf16 v[208:211], v[56:59], v[96:99], 0
    ds_read_b64_tr_b16 v[134:135], v27 offset:18432
    v_mfma_f32_16x16x32_bf16 v[212:215], v[56:59], v[100:103], 0
    ds_read_b128 v[68:71], v14 offset:2048
    v_mfma_f32_16x16x32_bf16 v[216:219], v[56:59], v[104:107], 0
    ds_read_b128 v[72:75], v14 offset:4096
    v_mfma_f32_16x16x32_bf16 v[220:223], v[80:83], v[60:63], 0
    ds_read_b128 v[76:79], v14 offset:6144
    v_mfma_f32_16x16x32_bf16 v[224:227], v[84:87], v[60:63], 0
    v_mfma_f32_16x16x32_bf16 v[228:231], v[60:63], v[88:91], 0
    v_mfma_f32_16x16x32_bf16 v[232:235], v[60:63], v[92:95], 0
    v_mfma_f32_16x16x32_bf16 v[236:239], v[60:63], v[96:99], 0
    v_mfma_f32_16x16x32_bf16 v[240:243], v[60:63], v[100:103], 0
    v_mfma_f32_16x16x32_bf16 v[244:247], v[60:63], v[104:107], 0
    s_waitcnt lgkmcnt(0)
    v_mfma_f32_16x16x32_bf16 v[136:139], v[108:111], v[64:67], v[136:139]
    v_mfma_f32_16x16x32_bf16 v[140:143], v[112:115], v[64:67], v[140:143]
    v_mfma_f32_16x16x32_bf16 v[144:147], v[64:67], v[116:119], v[144:147]
    v_mfma_f32_16x16x32_bf16 v[148:151], v[64:67], v[120:123], v[148:151]
    s_barrier
    v_mfma_f32_16x16x32_bf16 v[152:155], v[64:67], v[124:127], v[152:155]
    ds_read_b128 v[48:51], v13 offset:16384
    v_mfma_f32_16x16x32_bf16 v[156:159], v[64:67], v[128:131], v[156:159]
    ds_read_b64_tr_b16 v[80:81], v15 offset:32768
    v_mfma_f32_16x16x32_bf16 v[160:163], v[64:67], v[132:135], v[160:163]
    ds_read_b64_tr_b16 v[82:83], v15 offset:34816
    v_mfma_f32_16x16x32_bf16 v[164:167], v[108:111], v[68:71], v[164:167]
    ds_read_b64_tr_b16 v[84:85], v17 offset:32768
    v_mfma_f32_16x16x32_bf16 v[168:171], v[112:115], v[68:71], v[168:171]
    ds_read_b64_tr_b16 v[86:87], v17 offset:34816
    v_mfma_f32_16x16x32_bf16 v[172:175], v[68:71], v[116:119], v[172:175]
    ds_read_b64_tr_b16 v[88:89], v19 offset:32768
    v_mfma_f32_16x16x32_bf16 v[176:179], v[68:71], v[120:123], v[176:179]
    ds_read_b64_tr_b16 v[90:91], v19 offset:34816
    v_mfma_f32_16x16x32_bf16 v[180:183], v[68:71], v[124:127], v[180:183]
    ds_read_b64_tr_b16 v[92:93], v21 offset:32768
    v_mfma_f32_16x16x32_bf16 v[184:187], v[68:71], v[128:131], v[184:187]
    ds_read_b64_tr_b16 v[94:95], v21 offset:34816
    v_mfma_f32_16x16x32_bf16 v[188:191], v[68:71], v[132:135], v[188:191]
    ds_read_b64_tr_b16 v[96:97], v23 offset:32768
    v_mfma_f32_16x16x32_bf16 v[192:195], v[108:111], v[72:75], v[192:195]
    ds_read_b64_tr_b16 v[98:99], v23 offset:34816
    v_mfma_f32_16x16x32_bf16 v[196:199], v[112:115], v[72:75], v[196:199]
    ds_read_b64_tr_b16 v[100:101], v25 offset:32768
    v_mfma_f32_16x16x32_bf16 v[200:203], v[72:75], v[116:119], v[200:203]
    ds_read_b64_tr_b16 v[102:103], v25 offset:34816
    v_mfma_f32_16x16x32_bf16 v[204:207], v[72:75], v[120:123], v[204:207]
    ds_read_b64_tr_b16 v[104:105], v27 offset:32768
    v_mfma_f32_16x16x32_bf16 v[208:211], v[72:75], v[124:127], v[208:211]
    ds_read_b64_tr_b16 v[106:107], v27 offset:34816
    v_mfma_f32_16x16x32_bf16 v[212:215], v[72:75], v[128:131], v[212:215]
    ds_read_b128 v[52:55], v13 offset:18432
    v_mfma_f32_16x16x32_bf16 v[216:219], v[72:75], v[132:135], v[216:219]
    ds_read_b128 v[56:59], v13 offset:20480
    v_mfma_f32_16x16x32_bf16 v[220:223], v[108:111], v[76:79], v[220:223]
    ds_read_b128 v[60:63], v13 offset:22528
    v_mfma_f32_16x16x32_bf16 v[224:227], v[112:115], v[76:79], v[224:227]
    v_mfma_f32_16x16x32_bf16 v[228:231], v[76:79], v[116:119], v[228:231]
    v_mfma_f32_16x16x32_bf16 v[232:235], v[76:79], v[120:123], v[232:235]
    v_mfma_f32_16x16x32_bf16 v[236:239], v[76:79], v[124:127], v[236:239]
    v_mfma_f32_16x16x32_bf16 v[240:243], v[76:79], v[128:131], v[240:243]
    v_mfma_f32_16x16x32_bf16 v[244:247], v[76:79], v[132:135], v[244:247]
    s_waitcnt lgkmcnt(0)
    v_mfma_f32_16x16x32_bf16 v[136:139], v[80:83], v[48:51], v[136:139]
    v_mfma_f32_16x16x32_bf16 v[140:143], v[84:87], v[48:51], v[140:143]
    v_mfma_f32_16x16x32_bf16 v[144:147], v[48:51], v[88:91], v[144:147]
    v_mfma_f32_16x16x32_bf16 v[148:151], v[48:51], v[92:95], v[148:151]
    v_mfma_f32_16x16x32_bf16 v[152:155], v[48:51], v[96:99], v[152:155]
    ds_read_b128 v[64:67], v14 offset:16384
    v_mfma_f32_16x16x32_bf16 v[156:159], v[48:51], v[100:103], v[156:159]
    ds_read_b64_tr_b16 v[108:109], v16 offset:0
    v_mfma_f32_16x16x32_bf16 v[160:163], v[48:51], v[104:107], v[160:163]
    ds_read_b64_tr_b16 v[110:111], v16 offset:2048
    v_mfma_f32_16x16x32_bf16 v[164:167], v[80:83], v[52:55], v[164:167]
    ds_read_b64_tr_b16 v[112:113], v18 offset:0
    v_mfma_f32_16x16x32_bf16 v[168:171], v[84:87], v[52:55], v[168:171]
    ds_read_b64_tr_b16 v[114:115], v18 offset:2048
    v_mfma_f32_16x16x32_bf16 v[172:175], v[52:55], v[88:91], v[172:175]
    ds_read_b64_tr_b16 v[116:117], v20 offset:0
    v_mfma_f32_16x16x32_bf16 v[176:179], v[52:55], v[92:95], v[176:179]
    ds_read_b64_tr_b16 v[118:119], v20 offset:2048
    v_mfma_f32_16x16x32_bf16 v[180:183], v[52:55], v[96:99], v[180:183]
    ds_read_b64_tr_b16 v[120:121], v22 offset:0
    v_mfma_f32_16x16x32_bf16 v[184:187], v[52:55], v[100:103], v[184:187]
    ds_read_b64_tr_b16 v[122:123], v22 offset:2048
    v_mfma_f32_16x16x32_bf16 v[188:191], v[52:55], v[104:107], v[188:191]
    ds_read_b64_tr_b16 v[124:125], v24 offset:0
    v_mfma_f32_16x16x32_bf16 v[192:195], v[80:83], v[56:59], v[192:195]
    ds_read_b64_tr_b16 v[126:127], v24 offset:2048
    v_mfma_f32_16x16x32_bf16 v[196:199], v[84:87], v[56:59], v[196:199]
    ds_read_b64_tr_b16 v[128:129], v26 offset:0
    v_mfma_f32_16x16x32_bf16 v[200:203], v[56:59], v[88:91], v[200:203]
    ds_read_b64_tr_b16 v[130:131], v26 offset:2048
    v_mfma_f32_16x16x32_bf16 v[204:207], v[56:59], v[92:95], v[204:207]
    ds_read_b64_tr_b16 v[132:133], v28 offset:0
    v_mfma_f32_16x16x32_bf16 v[208:211], v[56:59], v[96:99], v[208:211]
    ds_read_b64_tr_b16 v[134:135], v28 offset:2048
    v_mfma_f32_16x16x32_bf16 v[212:215], v[56:59], v[100:103], v[212:215]
    ds_read_b128 v[68:71], v14 offset:18432
    v_mfma_f32_16x16x32_bf16 v[216:219], v[56:59], v[104:107], v[216:219]
    ds_read_b128 v[72:75], v14 offset:20480
    v_mfma_f32_16x16x32_bf16 v[220:223], v[80:83], v[60:63], v[220:223]
    ds_read_b128 v[76:79], v14 offset:22528
    v_mfma_f32_16x16x32_bf16 v[224:227], v[84:87], v[60:63], v[224:227]
    v_mfma_f32_16x16x32_bf16 v[228:231], v[60:63], v[88:91], v[228:231]
    v_mfma_f32_16x16x32_bf16 v[232:235], v[60:63], v[92:95], v[232:235]
    v_mfma_f32_16x16x32_bf16 v[236:239], v[60:63], v[96:99], v[236:239]
    v_mfma_f32_16x16x32_bf16 v[240:243], v[60:63], v[100:103], v[240:243]
    v_mfma_f32_16x16x32_bf16 v[244:247], v[60:63], v[104:107], v[244:247]
    s_waitcnt lgkmcnt(0)
    v_mfma_f32_16x16x32_bf16 v[136:139], v[108:111], v[64:67], v[136:139]
    v_mfma_f32_16x16x32_bf16 v[140:143], v[112:115], v[64:67], v[140:143]
    v_mfma_f32_16x16x32_bf16 v[144:147], v[64:67], v[116:119], v[144:147]
    v_mfma_f32_16x16x32_bf16 v[148:151], v[64:67], v[120:123], v[148:151]
    s_barrier
    v_mfma_f32_16x16x32_bf16 v[152:155], v[64:67], v[124:127], v[152:155]
    ds_read_b128 v[48:51], v13 offset:32768
    v_mfma_f32_16x16x32_bf16 v[156:159], v[64:67], v[128:131], v[156:159]
    ds_read_b64_tr_b16 v[80:81], v16 offset:16384
    v_mfma_f32_16x16x32_bf16 v[160:163], v[64:67], v[132:135], v[160:163]
    ds_read_b64_tr_b16 v[82:83], v16 offset:18432
    v_mfma_f32_16x16x32_bf16 v[164:167], v[108:111], v[68:71], v[164:167]
    ds_read_b64_tr_b16 v[84:85], v18 offset:16384
    v_mfma_f32_16x16x32_bf16 v[168:171], v[112:115], v[68:71], v[168:171]
    ds_read_b64_tr_b16 v[86:87], v18 offset:18432
    v_mfma_f32_16x16x32_bf16 v[172:175], v[68:71], v[116:119], v[172:175]
    ds_read_b64_tr_b16 v[88:89], v20 offset:16384
    v_mfma_f32_16x16x32_bf16 v[176:179], v[68:71], v[120:123], v[176:179]
    ds_read_b64_tr_b16 v[90:91], v20 offset:18432
    v_mfma_f32_16x16x32_bf16 v[180:183], v[68:71], v[124:127], v[180:183]
    ds_read_b64_tr_b16 v[92:93], v22 offset:16384
    v_mfma_f32_16x16x32_bf16 v[184:187], v[68:71], v[128:131], v[184:187]
    ds_read_b64_tr_b16 v[94:95], v22 offset:18432
    v_mfma_f32_16x16x32_bf16 v[188:191], v[68:71], v[132:135], v[188:191]
    ds_read_b64_tr_b16 v[96:97], v24 offset:16384
    v_mfma_f32_16x16x32_bf16 v[192:195], v[108:111], v[72:75], v[192:195]
    ds_read_b64_tr_b16 v[98:99], v24 offset:18432
    v_mfma_f32_16x16x32_bf16 v[196:199], v[112:115], v[72:75], v[196:199]
    ds_read_b64_tr_b16 v[100:101], v26 offset:16384
    v_mfma_f32_16x16x32_bf16 v[200:203], v[72:75], v[116:119], v[200:203]
    ds_read_b64_tr_b16 v[102:103], v26 offset:18432
    v_mfma_f32_16x16x32_bf16 v[204:207], v[72:75], v[120:123], v[204:207]
    ds_read_b64_tr_b16 v[104:105], v28 offset:16384
    v_mfma_f32_16x16x32_bf16 v[208:211], v[72:75], v[124:127], v[208:211]
    ds_read_b64_tr_b16 v[106:107], v28 offset:18432
    v_mfma_f32_16x16x32_bf16 v[212:215], v[72:75], v[128:131], v[212:215]
    ds_read_b128 v[52:55], v13 offset:34816
    v_mfma_f32_16x16x32_bf16 v[216:219], v[72:75], v[132:135], v[216:219]
    ds_read_b128 v[56:59], v13 offset:36864
    v_mfma_f32_16x16x32_bf16 v[220:223], v[108:111], v[76:79], v[220:223]
    ds_read_b128 v[60:63], v13 offset:38912
    v_mfma_f32_16x16x32_bf16 v[224:227], v[112:115], v[76:79], v[224:227]
    v_mfma_f32_16x16x32_bf16 v[228:231], v[76:79], v[116:119], v[228:231]
    v_mfma_f32_16x16x32_bf16 v[232:235], v[76:79], v[120:123], v[232:235]
    v_mfma_f32_16x16x32_bf16 v[236:239], v[76:79], v[124:127], v[236:239]
    v_mfma_f32_16x16x32_bf16 v[240:243], v[76:79], v[128:131], v[240:243]
    v_mfma_f32_16x16x32_bf16 v[244:247], v[76:79], v[132:135], v[244:247]
    s_waitcnt lgkmcnt(0)
    v_mfma_f32_16x16x32_bf16 v[136:139], v[80:83], v[48:51], v[136:139]
    v_mfma_f32_16x16x32_bf16 v[140:143], v[84:87], v[48:51], v[140:143]
    v_mfma_f32_16x16x32_bf16 v[144:147], v[48:51], v[88:91], v[144:147]
    v_mfma_f32_16x16x32_bf16 v[148:151], v[48:51], v[92:95], v[148:151]
    v_mfma_f32_16x16x32_bf16 v[152:155], v[48:51], v[96:99], v[152:155]
    ds_read_b128 v[64:67], v14 offset:32768
    v_mfma_f32_16x16x32_bf16 v[156:159], v[48:51], v[100:103], v[156:159]
    ds_read_b64_tr_b16 v[108:109], v16 offset:32768
    v_mfma_f32_16x16x32_bf16 v[160:163], v[48:51], v[104:107], v[160:163]
    ds_read_b64_tr_b16 v[110:111], v16 offset:34816
    v_mfma_f32_16x16x32_bf16 v[164:167], v[80:83], v[52:55], v[164:167]
    ds_read_b64_tr_b16 v[112:113], v18 offset:32768
    v_mfma_f32_16x16x32_bf16 v[168:171], v[84:87], v[52:55], v[168:171]
    ds_read_b64_tr_b16 v[114:115], v18 offset:34816
    v_mfma_f32_16x16x32_bf16 v[172:175], v[52:55], v[88:91], v[172:175]
    ds_read_b64_tr_b16 v[116:117], v20 offset:32768
    v_mfma_f32_16x16x32_bf16 v[176:179], v[52:55], v[92:95], v[176:179]
    ds_read_b64_tr_b16 v[118:119], v20 offset:34816
    v_mfma_f32_16x16x32_bf16 v[180:183], v[52:55], v[96:99], v[180:183]
    ds_read_b64_tr_b16 v[120:121], v22 offset:32768
    v_mfma_f32_16x16x32_bf16 v[184:187], v[52:55], v[100:103], v[184:187]
    ds_read_b64_tr_b16 v[122:123], v22 offset:34816
    v_mfma_f32_16x16x32_bf16 v[188:191], v[52:55], v[104:107], v[188:191]
    ds_read_b64_tr_b16 v[124:125], v24 offset:32768
    v_mfma_f32_16x16x32_bf16 v[192:195], v[80:83], v[56:59], v[192:195]
    ds_read_b64_tr_b16 v[126:127], v24 offset:34816
    v_mfma_f32_16x16x32_bf16 v[196:199], v[84:87], v[56:59], v[196:199]
    ds_read_b64_tr_b16 v[128:129], v26 offset:32768
    v_mfma_f32_16x16x32_bf16 v[200:203], v[56:59], v[88:91], v[200:203]
    ds_read_b64_tr_b16 v[130:131], v26 offset:34816
    v_mfma_f32_16x16x32_bf16 v[204:207], v[56:59], v[92:95], v[204:207]
    ds_read_b64_tr_b16 v[132:133], v28 offset:32768
    v_mfma_f32_16x16x32_bf16 v[208:211], v[56:59], v[96:99], v[208:211]
    ds_read_b64_tr_b16 v[134:135], v28 offset:34816
    v_mfma_f32_16x16x32_bf16 v[212:215], v[56:59], v[100:103], v[212:215]
    ds_read_b128 v[68:71], v14 offset:34816
    v_mfma_f32_16x16x32_bf16 v[216:219], v[56:59], v[104:107], v[216:219]
    ds_read_b128 v[72:75], v14 offset:36864
    v_mfma_f32_16x16x32_bf16 v[220:223], v[80:83], v[60:63], v[220:223]
    ds_read_b128 v[76:79], v14 offset:38912
    v_mfma_f32_16x16x32_bf16 v[224:227], v[84:87], v[60:63], v[224:227]
    v_mfma_f32_16x16x32_bf16 v[228:231], v[60:63], v[88:91], v[228:231]
    v_mfma_f32_16x16x32_bf16 v[232:235], v[60:63], v[92:95], v[232:235]
    v_mfma_f32_16x16x32_bf16 v[236:239], v[60:63], v[96:99], v[236:239]
    v_mfma_f32_16x16x32_bf16 v[240:243], v[60:63], v[100:103], v[240:243]
    v_mfma_f32_16x16x32_bf16 v[244:247], v[60:63], v[104:107], v[244:247]
    s_waitcnt lgkmcnt(0)
    v_mfma_f32_16x16x32_bf16 v[136:139], v[108:111], v[64:67], v[136:139]
    v_mfma_f32_16x16x32_bf16 v[140:143], v[112:115], v[64:67], v[140:143]
    v_mfma_f32_16x16x32_bf16 v[144:147], v[64:67], v[116:119], v[144:147]
    v_mfma_f32_16x16x32_bf16 v[148:151], v[64:67], v[120:123], v[148:151]
    s_barrier
    v_mfma_f32_16x16x32_bf16 v[152:155], v[64:67], v[124:127], v[152:155]
    ds_read_b128 v[48:51], v13 offset:0
    v_mfma_f32_16x16x32_bf16 v[156:159], v[64:67], v[128:131], v[156:159]
    ds_read_b64_tr_b16 v[80:81], v15 offset:0
    v_mfma_f32_16x16x32_bf16 v[160:163], v[64:67], v[132:135], v[160:163]
    ds_read_b64_tr_b16 v[82:83], v15 offset:2048
    v_mfma_f32_16x16x32_bf16 v[164:167], v[108:111], v[68:71], v[164:167]
    ds_read_b64_tr_b16 v[84:85], v17 offset:0
    v_mfma_f32_16x16x32_bf16 v[168:171], v[112:115], v[68:71], v[168:171]
    ds_read_b64_tr_b16 v[86:87], v17 offset:2048
    v_mfma_f32_16x16x32_bf16 v[172:175], v[68:71], v[116:119], v[172:175]
    ds_read_b64_tr_b16 v[88:89], v19 offset:0
    v_mfma_f32_16x16x32_bf16 v[176:179], v[68:71], v[120:123], v[176:179]
    ds_read_b64_tr_b16 v[90:91], v19 offset:2048
    v_mfma_f32_16x16x32_bf16 v[180:183], v[68:71], v[124:127], v[180:183]
    ds_read_b64_tr_b16 v[92:93], v21 offset:0
    v_mfma_f32_16x16x32_bf16 v[184:187], v[68:71], v[128:131], v[184:187]
    ds_read_b64_tr_b16 v[94:95], v21 offset:2048
    v_mfma_f32_16x16x32_bf16 v[188:191], v[68:71], v[132:135], v[188:191]
    ds_read_b64_tr_b16 v[96:97], v23 offset:0
    v_mfma_f32_16x16x32_bf16 v[192:195], v[108:111], v[72:75], v[192:195]
    ds_read_b64_tr_b16 v[98:99], v23 offset:2048
    v_mfma_f32_16x16x32_bf16 v[196:199], v[112:115], v[72:75], v[196:199]
    ds_read_b64_tr_b16 v[100:101], v25 offset:0
    v_mfma_f32_16x16x32_bf16 v[200:203], v[72:75], v[116:119], v[200:203]
    ds_read_b64_tr_b16 v[102:103], v25 offset:2048
    v_mfma_f32_16x16x32_bf16 v[204:207], v[72:75], v[120:123], v[204:207]
    ds_read_b64_tr_b16 v[104:105], v27 offset:0
    v_mfma_f32_16x16x32_bf16 v[208:211], v[72:75], v[124:127], v[208:211]
    ds_read_b64_tr_b16 v[106:107], v27 offset:2048
    v_mfma_f32_16x16x32_bf16 v[212:215], v[72:75], v[128:131], v[212:215]
    ds_read_b128 v[52:55], v13 offset:2048
    v_mfma_f32_16x16x32_bf16 v[216:219], v[72:75], v[132:135], v[216:219]
    ds_read_b128 v[56:59], v13 offset:4096
    v_mfma_f32_16x16x32_bf16 v[220:223], v[108:111], v[76:79], v[220:223]
    ds_read_b128 v[60:63], v13 offset:6144
    v_mfma_f32_16x16x32_bf16 v[224:227], v[112:115], v[76:79], v[224:227]
    v_mfma_f32_16x16x32_bf16 v[228:231], v[76:79], v[116:119], v[228:231]
    v_mfma_f32_16x16x32_bf16 v[232:235], v[76:79], v[120:123], v[232:235]
    v_mfma_f32_16x16x32_bf16 v[236:239], v[76:79], v[124:127], v[236:239]
    v_mfma_f32_16x16x32_bf16 v[240:243], v[76:79], v[128:131], v[240:243]
    v_mfma_f32_16x16x32_bf16 v[244:247], v[76:79], v[132:135], v[244:247]
    s_waitcnt lgkmcnt(0)
    v_mfma_f32_16x16x32_bf16 v[136:139], v[80:83], v[48:51], v[136:139]
    v_mfma_f32_16x16x32_bf16 v[140:143], v[84:87], v[48:51], v[140:143]
    v_mfma_f32_16x16x32_bf16 v[144:147], v[48:51], v[88:91], v[144:147]
    v_mfma_f32_16x16x32_bf16 v[148:151], v[48:51], v[92:95], v[148:151]
    v_mfma_f32_16x16x32_bf16 v[152:155], v[48:51], v[96:99], v[152:155]
    ds_read_b128 v[64:67], v14 offset:0
    v_mfma_f32_16x16x32_bf16 v[156:159], v[48:51], v[100:103], v[156:159]
    ds_read_b64_tr_b16 v[108:109], v15 offset:16384
    v_mfma_f32_16x16x32_bf16 v[160:163], v[48:51], v[104:107], v[160:163]
    ds_read_b64_tr_b16 v[110:111], v15 offset:18432
    v_mfma_f32_16x16x32_bf16 v[164:167], v[80:83], v[52:55], v[164:167]
    ds_read_b64_tr_b16 v[112:113], v17 offset:16384
    v_mfma_f32_16x16x32_bf16 v[168:171], v[84:87], v[52:55], v[168:171]
    ds_read_b64_tr_b16 v[114:115], v17 offset:18432
    v_mfma_f32_16x16x32_bf16 v[172:175], v[52:55], v[88:91], v[172:175]
    ds_read_b64_tr_b16 v[116:117], v19 offset:16384
    v_mfma_f32_16x16x32_bf16 v[176:179], v[52:55], v[92:95], v[176:179]
    ds_read_b64_tr_b16 v[118:119], v19 offset:18432
    v_mfma_f32_16x16x32_bf16 v[180:183], v[52:55], v[96:99], v[180:183]
    ds_read_b64_tr_b16 v[120:121], v21 offset:16384
    v_mfma_f32_16x16x32_bf16 v[184:187], v[52:55], v[100:103], v[184:187]
    ds_read_b64_tr_b16 v[122:123], v21 offset:18432
    v_mfma_f32_16x16x32_bf16 v[188:191], v[52:55], v[104:107], v[188:191]
    ds_read_b64_tr_b16 v[124:125], v23 offset:16384
    v_mfma_f32_16x16x32_bf16 v[192:195], v[80:83], v[56:59], v[192:195]
    ds_read_b64_tr_b16 v[126:127], v23 offset:18432
    v_mfma_f32_16x16x32_bf16 v[196:199], v[84:87], v[56:59], v[196:199]
    ds_read_b64_tr_b16 v[128:129], v25 offset:16384
    v_mfma_f32_16x16x32_bf16 v[200:203], v[56:59], v[88:91], v[200:203]
    ds_read_b64_tr_b16 v[130:131], v25 offset:18432
    v_mfma_f32_16x16x32_bf16 v[204:207], v[56:59], v[92:95], v[204:207]
    ds_read_b64_tr_b16 v[132:133], v27 offset:16384
    v_mfma_f32_16x16x32_bf16 v[208:211], v[56:59], v[96:99], v[208:211]
    ds_read_b64_tr_b16 v[134:135], v27 offset:18432
    v_mfma_f32_16x16x32_bf16 v[212:215], v[56:59], v[100:103], v[212:215]
    ds_read_b128 v[68:71], v14 offset:2048
    v_mfma_f32_16x16x32_bf16 v[216:219], v[56:59], v[104:107], v[216:219]
    ds_read_b128 v[72:75], v14 offset:4096
    v_mfma_f32_16x16x32_bf16 v[220:223], v[80:83], v[60:63], v[220:223]
    ds_read_b128 v[76:79], v14 offset:6144
    v_mfma_f32_16x16x32_bf16 v[224:227], v[84:87], v[60:63], v[224:227]
    v_mfma_f32_16x16x32_bf16 v[228:231], v[60:63], v[88:91], v[228:231]
    v_mfma_f32_16x16x32_bf16 v[232:235], v[60:63], v[92:95], v[232:235]
    v_mfma_f32_16x16x32_bf16 v[236:239], v[60:63], v[96:99], v[236:239]
    v_mfma_f32_16x16x32_bf16 v[240:243], v[60:63], v[100:103], v[240:243]
    v_mfma_f32_16x16x32_bf16 v[244:247], v[60:63], v[104:107], v[244:247]
    s_waitcnt lgkmcnt(0)
    v_mfma_f32_16x16x32_bf16 v[136:139], v[108:111], v[64:67], v[136:139]
    v_mfma_f32_16x16x32_bf16 v[140:143], v[112:115], v[64:67], v[140:143]
    v_mfma_f32_16x16x32_bf16 v[144:147], v[64:67], v[116:119], v[144:147]
    v_mfma_f32_16x16x32_bf16 v[148:151], v[64:67], v[120:123], v[148:151]
    s_barrier
    v_mfma_f32_16x16x32_bf16 v[152:155], v[64:67], v[124:127], v[152:155]
    ds_read_b128 v[48:51], v13 offset:16384
    v_mfma_f32_16x16x32_bf16 v[156:159], v[64:67], v[128:131], v[156:159]
    ds_read_b64_tr_b16 v[80:81], v15 offset:32768
    v_mfma_f32_16x16x32_bf16 v[160:163], v[64:67], v[132:135], v[160:163]
    ds_read_b64_tr_b16 v[82:83], v15 offset:34816
    v_mfma_f32_16x16x32_bf16 v[164:167], v[108:111], v[68:71], v[164:167]
    ds_read_b64_tr_b16 v[84:85], v17 offset:32768
    v_mfma_f32_16x16x32_bf16 v[168:171], v[112:115], v[68:71], v[168:171]
    ds_read_b64_tr_b16 v[86:87], v17 offset:34816
    v_mfma_f32_16x16x32_bf16 v[172:175], v[68:71], v[116:119], v[172:175]
    ds_read_b64_tr_b16 v[88:89], v19 offset:32768
    v_mfma_f32_16x16x32_bf16 v[176:179], v[68:71], v[120:123], v[176:179]
    ds_read_b64_tr_b16 v[90:91], v19 offset:34816
    v_mfma_f32_16x16x32_bf16 v[180:183], v[68:71], v[124:127], v[180:183]
    ds_read_b64_tr_b16 v[92:93], v21 offset:32768
    v_mfma_f32_16x16x32_bf16 v[184:187], v[68:71], v[128:131], v[184:187]
    ds_read_b64_tr_b16 v[94:95], v21 offset:34816
    v_mfma_f32_16x16x32_bf16 v[188:191], v[68:71], v[132:135], v[188:191]
    ds_read_b64_tr_b16 v[96:97], v23 offset:32768
    v_mfma_f32_16x16x32_bf16 v[192:195], v[108:111], v[72:75], v[192:195]
    ds_read_b64_tr_b16 v[98:99], v23 offset:34816
    v_mfma_f32_16x16x32_bf16 v[196:199], v[112:115], v[72:75], v[196:199]
    ds_read_b64_tr_b16 v[100:101], v25 offset:32768
    v_mfma_f32_16x16x32_bf16 v[200:203], v[72:75], v[116:119], v[200:203]
    ds_read_b64_tr_b16 v[102:103], v25 offset:34816
    v_mfma_f32_16x16x32_bf16 v[204:207], v[72:75], v[120:123], v[204:207]
    ds_read_b64_tr_b16 v[104:105], v27 offset:32768
    v_mfma_f32_16x16x32_bf16 v[208:211], v[72:75], v[124:127], v[208:211]
    ds_read_b64_tr_b16 v[106:107], v27 offset:34816
    v_mfma_f32_16x16x32_bf16 v[212:215], v[72:75], v[128:131], v[212:215]
    ds_read_b128 v[52:55], v13 offset:18432
    v_mfma_f32_16x16x32_bf16 v[216:219], v[72:75], v[132:135], v[216:219]
    ds_read_b128 v[56:59], v13 offset:20480
    v_mfma_f32_16x16x32_bf16 v[220:223], v[108:111], v[76:79], v[220:223]
    ds_read_b128 v[60:63], v13 offset:22528
    v_mfma_f32_16x16x32_bf16 v[224:227], v[112:115], v[76:79], v[224:227]
    v_mfma_f32_16x16x32_bf16 v[228:231], v[76:79], v[116:119], v[228:231]
    v_mfma_f32_16x16x32_bf16 v[232:235], v[76:79], v[120:123], v[232:235]
    v_mfma_f32_16x16x32_bf16 v[236:239], v[76:79], v[124:127], v[236:239]
    v_mfma_f32_16x16x32_bf16 v[240:243], v[76:79], v[128:131], v[240:243]
    v_mfma_f32_16x16x32_bf16 v[244:247], v[76:79], v[132:135], v[244:247]
    s_waitcnt lgkmcnt(0)
    v_mfma_f32_16x16x32_bf16 v[136:139], v[80:83], v[48:51], v[136:139]
    v_mfma_f32_16x16x32_bf16 v[140:143], v[84:87], v[48:51], v[140:143]
    v_mfma_f32_16x16x32_bf16 v[144:147], v[48:51], v[88:91], v[144:147]
    v_mfma_f32_16x16x32_bf16 v[148:151], v[48:51], v[92:95], v[148:151]
    v_mfma_f32_16x16x32_bf16 v[152:155], v[48:51], v[96:99], v[152:155]
    ds_read_b128 v[64:67], v14 offset:16384
    v_mfma_f32_16x16x32_bf16 v[156:159], v[48:51], v[100:103], v[156:159]
    ds_read_b64_tr_b16 v[108:109], v16 offset:0
    v_mfma_f32_16x16x32_bf16 v[160:163], v[48:51], v[104:107], v[160:163]
    ds_read_b64_tr_b16 v[110:111], v16 offset:2048
    v_mfma_f32_16x16x32_bf16 v[164:167], v[80:83], v[52:55], v[164:167]
    ds_read_b64_tr_b16 v[112:113], v18 offset:0
    v_mfma_f32_16x16x32_bf16 v[168:171], v[84:87], v[52:55], v[168:171]
    ds_read_b64_tr_b16 v[114:115], v18 offset:2048
    v_mfma_f32_16x16x32_bf16 v[172:175], v[52:55], v[88:91], v[172:175]
    ds_read_b64_tr_b16 v[116:117], v20 offset:0
    v_mfma_f32_16x16x32_bf16 v[176:179], v[52:55], v[92:95], v[176:179]
    ds_read_b64_tr_b16 v[118:119], v20 offset:2048
    v_mfma_f32_16x16x32_bf16 v[180:183], v[52:55], v[96:99], v[180:183]
    ds_read_b64_tr_b16 v[120:121], v22 offset:0
    v_mfma_f32_16x16x32_bf16 v[184:187], v[52:55], v[100:103], v[184:187]
    ds_read_b64_tr_b16 v[122:123], v22 offset:2048
    v_mfma_f32_16x16x32_bf16 v[188:191], v[52:55], v[104:107], v[188:191]
    ds_read_b64_tr_b16 v[124:125], v24 offset:0
    v_mfma_f32_16x16x32_bf16 v[192:195], v[80:83], v[56:59], v[192:195]
    ds_read_b64_tr_b16 v[126:127], v24 offset:2048
    v_mfma_f32_16x16x32_bf16 v[196:199], v[84:87], v[56:59], v[196:199]
    ds_read_b64_tr_b16 v[128:129], v26 offset:0
    v_mfma_f32_16x16x32_bf16 v[200:203], v[56:59], v[88:91], v[200:203]
    ds_read_b64_tr_b16 v[130:131], v26 offset:2048
    v_mfma_f32_16x16x32_bf16 v[204:207], v[56:59], v[92:95], v[204:207]
    ds_read_b64_tr_b16 v[132:133], v28 offset:0
    v_mfma_f32_16x16x32_bf16 v[208:211], v[56:59], v[96:99], v[208:211]
    ds_read_b64_tr_b16 v[134:135], v28 offset:2048
    v_mfma_f32_16x16x32_bf16 v[212:215], v[56:59], v[100:103], v[212:215]
    ds_read_b128 v[68:71], v14 offset:18432
    v_mfma_f32_16x16x32_bf16 v[216:219], v[56:59], v[104:107], v[216:219]
    ds_read_b128 v[72:75], v14 offset:20480
    v_mfma_f32_16x16x32_bf16 v[220:223], v[80:83], v[60:63], v[220:223]
    ds_read_b128 v[76:79], v14 offset:22528
    v_mfma_f32_16x16x32_bf16 v[224:227], v[84:87], v[60:63], v[224:227]
    v_mfma_f32_16x16x32_bf16 v[228:231], v[60:63], v[88:91], v[228:231]
    v_mfma_f32_16x16x32_bf16 v[232:235], v[60:63], v[92:95], v[232:235]
    v_mfma_f32_16x16x32_bf16 v[236:239], v[60:63], v[96:99], v[236:239]
    v_mfma_f32_16x16x32_bf16 v[240:243], v[60:63], v[100:103], v[240:243]
    v_mfma_f32_16x16x32_bf16 v[244:247], v[60:63], v[104:107], v[244:247]
    s_waitcnt lgkmcnt(0)
    v_mfma_f32_16x16x32_bf16 v[136:139], v[108:111], v[64:67], v[136:139]
    v_mfma_f32_16x16x32_bf16 v[140:143], v[112:115], v[64:67], v[140:143]
    v_mfma_f32_16x16x32_bf16 v[144:147], v[64:67], v[116:119], v[144:147]
    v_mfma_f32_16x16x32_bf16 v[148:151], v[64:67], v[120:123], v[148:151]
    s_barrier
    v_mfma_f32_16x16x32_bf16 v[152:155], v[64:67], v[124:127], v[152:155]
    ds_read_b128 v[48:51], v13 offset:32768
    v_mfma_f32_16x16x32_bf16 v[156:159], v[64:67], v[128:131], v[156:159]
    ds_read_b64_tr_b16 v[80:81], v16 offset:16384
    v_mfma_f32_16x16x32_bf16 v[160:163], v[64:67], v[132:135], v[160:163]
    ds_read_b64_tr_b16 v[82:83], v16 offset:18432
    v_mfma_f32_16x16x32_bf16 v[164:167], v[108:111], v[68:71], v[164:167]
    ds_read_b64_tr_b16 v[84:85], v18 offset:16384
    v_mfma_f32_16x16x32_bf16 v[168:171], v[112:115], v[68:71], v[168:171]
    ds_read_b64_tr_b16 v[86:87], v18 offset:18432
    v_mfma_f32_16x16x32_bf16 v[172:175], v[68:71], v[116:119], v[172:175]
    ds_read_b64_tr_b16 v[88:89], v20 offset:16384
    v_mfma_f32_16x16x32_bf16 v[176:179], v[68:71], v[120:123], v[176:179]
    ds_read_b64_tr_b16 v[90:91], v20 offset:18432
    v_mfma_f32_16x16x32_bf16 v[180:183], v[68:71], v[124:127], v[180:183]
    ds_read_b64_tr_b16 v[92:93], v22 offset:16384
    v_mfma_f32_16x16x32_bf16 v[184:187], v[68:71], v[128:131], v[184:187]
    ds_read_b64_tr_b16 v[94:95], v22 offset:18432
    v_mfma_f32_16x16x32_bf16 v[188:191], v[68:71], v[132:135], v[188:191]
    ds_read_b64_tr_b16 v[96:97], v24 offset:16384
    v_mfma_f32_16x16x32_bf16 v[192:195], v[108:111], v[72:75], v[192:195]
    ds_read_b64_tr_b16 v[98:99], v24 offset:18432
    v_mfma_f32_16x16x32_bf16 v[196:199], v[112:115], v[72:75], v[196:199]
    ds_read_b64_tr_b16 v[100:101], v26 offset:16384
    v_mfma_f32_16x16x32_bf16 v[200:203], v[72:75], v[116:119], v[200:203]
    ds_read_b64_tr_b16 v[102:103], v26 offset:18432
    v_mfma_f32_16x16x32_bf16 v[204:207], v[72:75], v[120:123], v[204:207]
    ds_read_b64_tr_b16 v[104:105], v28 offset:16384
    v_mfma_f32_16x16x32_bf16 v[208:211], v[72:75], v[124:127], v[208:211]
    ds_read_b64_tr_b16 v[106:107], v28 offset:18432
    v_mfma_f32_16x16x32_bf16 v[212:215], v[72:75], v[128:131], v[212:215]
    ds_read_b128 v[52:55], v13 offset:34816
    v_mfma_f32_16x16x32_bf16 v[216:219], v[72:75], v[132:135], v[216:219]
    ds_read_b128 v[56:59], v13 offset:36864
    v_mfma_f32_16x16x32_bf16 v[220:223], v[108:111], v[76:79], v[220:223]
    ds_read_b128 v[60:63], v13 offset:38912
    v_mfma_f32_16x16x32_bf16 v[224:227], v[112:115], v[76:79], v[224:227]
    v_mfma_f32_16x16x32_bf16 v[228:231], v[76:79], v[116:119], v[228:231]
    v_mfma_f32_16x16x32_bf16 v[232:235], v[76:79], v[120:123], v[232:235]
    v_mfma_f32_16x16x32_bf16 v[236:239], v[76:79], v[124:127], v[236:239]
    v_mfma_f32_16x16x32_bf16 v[240:243], v[76:79], v[128:131], v[240:243]
    v_mfma_f32_16x16x32_bf16 v[244:247], v[76:79], v[132:135], v[244:247]
    s_waitcnt lgkmcnt(0)
    v_mfma_f32_16x16x32_bf16 v[136:139], v[80:83], v[48:51], v[136:139]
    v_mfma_f32_16x16x32_bf16 v[140:143], v[84:87], v[48:51], v[140:143]
    v_mfma_f32_16x16x32_bf16 v[144:147], v[48:51], v[88:91], v[144:147]
    v_mfma_f32_16x16x32_bf16 v[148:151], v[48:51], v[92:95], v[148:151]
    v_mfma_f32_16x16x32_bf16 v[152:155], v[48:51], v[96:99], v[152:155]
    ds_read_b128 v[64:67], v14 offset:32768
    v_mfma_f32_16x16x32_bf16 v[156:159], v[48:51], v[100:103], v[156:159]
    ds_read_b64_tr_b16 v[108:109], v16 offset:32768
    v_mfma_f32_16x16x32_bf16 v[160:163], v[48:51], v[104:107], v[160:163]
    ds_read_b64_tr_b16 v[110:111], v16 offset:34816
    v_mfma_f32_16x16x32_bf16 v[164:167], v[80:83], v[52:55], v[164:167]
    ds_read_b64_tr_b16 v[112:113], v18 offset:32768
    v_mfma_f32_16x16x32_bf16 v[168:171], v[84:87], v[52:55], v[168:171]
    ds_read_b64_tr_b16 v[114:115], v18 offset:34816
    v_mfma_f32_16x16x32_bf16 v[172:175], v[52:55], v[88:91], v[172:175]
    ds_read_b64_tr_b16 v[116:117], v20 offset:32768
    v_mfma_f32_16x16x32_bf16 v[176:179], v[52:55], v[92:95], v[176:179]
    ds_read_b64_tr_b16 v[118:119], v20 offset:34816
    v_mfma_f32_16x16x32_bf16 v[180:183], v[52:55], v[96:99], v[180:183]
    ds_read_b64_tr_b16 v[120:121], v22 offset:32768
    v_mfma_f32_16x16x32_bf16 v[184:187], v[52:55], v[100:103], v[184:187]
    ds_read_b64_tr_b16 v[122:123], v22 offset:34816
    v_mfma_f32_16x16x32_bf16 v[188:191], v[52:55], v[104:107], v[188:191]
    ds_read_b64_tr_b16 v[124:125], v24 offset:32768
    v_mfma_f32_16x16x32_bf16 v[192:195], v[80:83], v[56:59], v[192:195]
    ds_read_b64_tr_b16 v[126:127], v24 offset:34816
    v_mfma_f32_16x16x32_bf16 v[196:199], v[84:87], v[56:59], v[196:199]
    ds_read_b64_tr_b16 v[128:129], v26 offset:32768
    v_mfma_f32_16x16x32_bf16 v[200:203], v[56:59], v[88:91], v[200:203]
    ds_read_b64_tr_b16 v[130:131], v26 offset:34816
    v_mfma_f32_16x16x32_bf16 v[204:207], v[56:59], v[92:95], v[204:207]
    ds_read_b64_tr_b16 v[132:133], v28 offset:32768
    v_mfma_f32_16x16x32_bf16 v[208:211], v[56:59], v[96:99], v[208:211]
    ds_read_b64_tr_b16 v[134:135], v28 offset:34816
    v_mfma_f32_16x16x32_bf16 v[212:215], v[56:59], v[100:103], v[212:215]
    ds_read_b128 v[68:71], v14 offset:34816
    v_mfma_f32_16x16x32_bf16 v[216:219], v[56:59], v[104:107], v[216:219]
    ds_read_b128 v[72:75], v14 offset:36864
    v_mfma_f32_16x16x32_bf16 v[220:223], v[80:83], v[60:63], v[220:223]
    ds_read_b128 v[76:79], v14 offset:38912
    v_mfma_f32_16x16x32_bf16 v[224:227], v[84:87], v[60:63], v[224:227]
    v_mfma_f32_16x16x32_bf16 v[228:231], v[60:63], v[88:91], v[228:231]
    v_mfma_f32_16x16x32_bf16 v[232:235], v[60:63], v[92:95], v[232:235]
    v_mfma_f32_16x16x32_bf16 v[236:239], v[60:63], v[96:99], v[236:239]
    v_mfma_f32_16x16x32_bf16 v[240:243], v[60:63], v[100:103], v[240:243]
    v_mfma_f32_16x16x32_bf16 v[244:247], v[60:63], v[104:107], v[244:247]
    s_waitcnt lgkmcnt(0)
    v_mfma_f32_16x16x32_bf16 v[136:139], v[108:111], v[64:67], v[136:139]
    v_mfma_f32_16x16x32_bf16 v[140:143], v[112:115], v[64:67], v[140:143]
    v_mfma_f32_16x16x32_bf16 v[144:147], v[64:67], v[116:119], v[144:147]
    v_mfma_f32_16x16x32_bf16 v[148:151], v[64:67], v[120:123], v[148:151]
    s_barrier
    v_mfma_f32_16x16x32_bf16 v[152:155], v[64:67], v[124:127], v[152:155]
    ds_read_b128 v[48:51], v13 offset:0
    v_mfma_f32_16x16x32_bf16 v[156:159], v[64:67], v[128:131], v[156:159]
    ds_read_b64_tr_b16 v[80:81], v15 offset:0
    v_mfma_f32_16x16x32_bf16 v[160:163], v[64:67], v[132:135], v[160:163]
    ds_read_b64_tr_b16 v[82:83], v15 offset:2048
    v_mfma_f32_16x16x32_bf16 v[164:167], v[108:111], v[68:71], v[164:167]
    ds_read_b64_tr_b16 v[84:85], v17 offset:0
    v_mfma_f32_16x16x32_bf16 v[168:171], v[112:115], v[68:71], v[168:171]
    ds_read_b64_tr_b16 v[86:87], v17 offset:2048
    v_mfma_f32_16x16x32_bf16 v[172:175], v[68:71], v[116:119], v[172:175]
    ds_read_b64_tr_b16 v[88:89], v19 offset:0
    v_mfma_f32_16x16x32_bf16 v[176:179], v[68:71], v[120:123], v[176:179]
    ds_read_b64_tr_b16 v[90:91], v19 offset:2048
    v_mfma_f32_16x16x32_bf16 v[180:183], v[68:71], v[124:127], v[180:183]
    ds_read_b64_tr_b16 v[92:93], v21 offset:0
    v_mfma_f32_16x16x32_bf16 v[184:187], v[68:71], v[128:131], v[184:187]
    ds_read_b64_tr_b16 v[94:95], v21 offset:2048
    v_mfma_f32_16x16x32_bf16 v[188:191], v[68:71], v[132:135], v[188:191]
    ds_read_b64_tr_b16 v[96:97], v23 offset:0
    v_mfma_f32_16x16x32_bf16 v[192:195], v[108:111], v[72:75], v[192:195]
    ds_read_b64_tr_b16 v[98:99], v23 offset:2048
    v_mfma_f32_16x16x32_bf16 v[196:199], v[112:115], v[72:75], v[196:199]
    ds_read_b64_tr_b16 v[100:101], v25 offset:0
    v_mfma_f32_16x16x32_bf16 v[200:203], v[72:75], v[116:119], v[200:203]
    ds_read_b64_tr_b16 v[102:103], v25 offset:2048
    v_mfma_f32_16x16x32_bf16 v[204:207], v[72:75], v[120:123], v[204:207]
    ds_read_b64_tr_b16 v[104:105], v27 offset:0
    v_mfma_f32_16x16x32_bf16 v[208:211], v[72:75], v[124:127], v[208:211]
    ds_read_b64_tr_b16 v[106:107], v27 offset:2048
    v_mfma_f32_16x16x32_bf16 v[212:215], v[72:75], v[128:131], v[212:215]
    ds_read_b128 v[52:55], v13 offset:2048
    v_mfma_f32_16x16x32_bf16 v[216:219], v[72:75], v[132:135], v[216:219]
    ds_read_b128 v[56:59], v13 offset:4096
    v_mfma_f32_16x16x32_bf16 v[220:223], v[108:111], v[76:79], v[220:223]
    ds_read_b128 v[60:63], v13 offset:6144
    v_mfma_f32_16x16x32_bf16 v[224:227], v[112:115], v[76:79], v[224:227]
    v_mfma_f32_16x16x32_bf16 v[228:231], v[76:79], v[116:119], v[228:231]
    v_mfma_f32_16x16x32_bf16 v[232:235], v[76:79], v[120:123], v[232:235]
    v_mfma_f32_16x16x32_bf16 v[236:239], v[76:79], v[124:127], v[236:239]
    v_mfma_f32_16x16x32_bf16 v[240:243], v[76:79], v[128:131], v[240:243]
    v_mfma_f32_16x16x32_bf16 v[244:247], v[76:79], v[132:135], v[244:247]
    s_waitcnt lgkmcnt(0)
    v_mfma_f32_16x16x32_bf16 v[136:139], v[80:83], v[48:51], v[136:139]
    v_mfma_f32_16x16x32_bf16 v[140:143], v[84:87], v[48:51], v[140:143]
    v_mfma_f32_16x16x32_bf16 v[144:147], v[48:51], v[88:91], v[144:147]
    v_mfma_f32_16x16x32_bf16 v[148:151], v[48:51], v[92:95], v[148:151]
    v_mfma_f32_16x16x32_bf16 v[152:155], v[48:51], v[96:99], v[152:155]
    ds_read_b128 v[64:67], v14 offset:0
    v_mfma_f32_16x16x32_bf16 v[156:159], v[48:51], v[100:103], v[156:159]
    ds_read_b64_tr_b16 v[108:109], v15 offset:16384
    v_mfma_f32_16x16x32_bf16 v[160:163], v[48:51], v[104:107], v[160:163]
    ds_read_b64_tr_b16 v[110:111], v15 offset:18432
    v_mfma_f32_16x16x32_bf16 v[164:167], v[80:83], v[52:55], v[164:167]
    ds_read_b64_tr_b16 v[112:113], v17 offset:16384
    v_mfma_f32_16x16x32_bf16 v[168:171], v[84:87], v[52:55], v[168:171]
    ds_read_b64_tr_b16 v[114:115], v17 offset:18432
    v_mfma_f32_16x16x32_bf16 v[172:175], v[52:55], v[88:91], v[172:175]
    ds_read_b64_tr_b16 v[116:117], v19 offset:16384
    v_mfma_f32_16x16x32_bf16 v[176:179], v[52:55], v[92:95], v[176:179]
    ds_read_b64_tr_b16 v[118:119], v19 offset:18432
    v_mfma_f32_16x16x32_bf16 v[180:183], v[52:55], v[96:99], v[180:183]
    ds_read_b64_tr_b16 v[120:121], v21 offset:16384
    v_mfma_f32_16x16x32_bf16 v[184:187], v[52:55], v[100:103], v[184:187]
    ds_read_b64_tr_b16 v[122:123], v21 offset:18432
    v_mfma_f32_16x16x32_bf16 v[188:191], v[52:55], v[104:107], v[188:191]
    ds_read_b64_tr_b16 v[124:125], v23 offset:16384
    v_mfma_f32_16x16x32_bf16 v[192:195], v[80:83], v[56:59], v[192:195]
    ds_read_b64_tr_b16 v[126:127], v23 offset:18432
    v_mfma_f32_16x16x32_bf16 v[196:199], v[84:87], v[56:59], v[196:199]
    ds_read_b64_tr_b16 v[128:129], v25 offset:16384
    v_mfma_f32_16x16x32_bf16 v[200:203], v[56:59], v[88:91], v[200:203]
    ds_read_b64_tr_b16 v[130:131], v25 offset:18432
    v_mfma_f32_16x16x32_bf16 v[204:207], v[56:59], v[92:95], v[204:207]
    ds_read_b64_tr_b16 v[132:133], v27 offset:16384
    v_mfma_f32_16x16x32_bf16 v[208:211], v[56:59], v[96:99], v[208:211]
    ds_read_b64_tr_b16 v[134:135], v27 offset:18432
    v_mfma_f32_16x16x32_bf16 v[212:215], v[56:59], v[100:103], v[212:215]
    ds_read_b128 v[68:71], v14 offset:2048
    v_mfma_f32_16x16x32_bf16 v[216:219], v[56:59], v[104:107], v[216:219]
    ds_read_b128 v[72:75], v14 offset:4096
    v_mfma_f32_16x16x32_bf16 v[220:223], v[80:83], v[60:63], v[220:223]
    ds_read_b128 v[76:79], v14 offset:6144
    v_mfma_f32_16x16x32_bf16 v[224:227], v[84:87], v[60:63], v[224:227]
    v_mfma_f32_16x16x32_bf16 v[228:231], v[60:63], v[88:91], v[228:231]
    v_mfma_f32_16x16x32_bf16 v[232:235], v[60:63], v[92:95], v[232:235]
    v_mfma_f32_16x16x32_bf16 v[236:239], v[60:63], v[96:99], v[236:239]
    v_mfma_f32_16x16x32_bf16 v[240:243], v[60:63], v[100:103], v[240:243]
    v_mfma_f32_16x16x32_bf16 v[244:247], v[60:63], v[104:107], v[244:247]
    s_waitcnt lgkmcnt(0)
    v_mfma_f32_16x16x32_bf16 v[136:139], v[108:111], v[64:67], v[136:139]
    v_mfma_f32_16x16x32_bf16 v[140:143], v[112:115], v[64:67], v[140:143]
    v_mfma_f32_16x16x32_bf16 v[144:147], v[64:67], v[116:119], v[144:147]
    v_mfma_f32_16x16x32_bf16 v[148:151], v[64:67], v[120:123], v[148:151]
    s_barrier
    v_mfma_f32_16x16x32_bf16 v[152:155], v[64:67], v[124:127], v[152:155]
    ds_read_b128 v[48:51], v13 offset:16384
    v_mfma_f32_16x16x32_bf16 v[156:159], v[64:67], v[128:131], v[156:159]
    ds_read_b64_tr_b16 v[80:81], v15 offset:32768
    v_mfma_f32_16x16x32_bf16 v[160:163], v[64:67], v[132:135], v[160:163]
    ds_read_b64_tr_b16 v[82:83], v15 offset:34816
    v_mfma_f32_16x16x32_bf16 v[164:167], v[108:111], v[68:71], v[164:167]
    ds_read_b64_tr_b16 v[84:85], v17 offset:32768
    v_mfma_f32_16x16x32_bf16 v[168:171], v[112:115], v[68:71], v[168:171]
    ds_read_b64_tr_b16 v[86:87], v17 offset:34816
    v_mfma_f32_16x16x32_bf16 v[172:175], v[68:71], v[116:119], v[172:175]
    ds_read_b64_tr_b16 v[88:89], v19 offset:32768
    v_mfma_f32_16x16x32_bf16 v[176:179], v[68:71], v[120:123], v[176:179]
    ds_read_b64_tr_b16 v[90:91], v19 offset:34816
    v_mfma_f32_16x16x32_bf16 v[180:183], v[68:71], v[124:127], v[180:183]
    ds_read_b64_tr_b16 v[92:93], v21 offset:32768
    v_mfma_f32_16x16x32_bf16 v[184:187], v[68:71], v[128:131], v[184:187]
    ds_read_b64_tr_b16 v[94:95], v21 offset:34816
    v_mfma_f32_16x16x32_bf16 v[188:191], v[68:71], v[132:135], v[188:191]
    ds_read_b64_tr_b16 v[96:97], v23 offset:32768
    v_mfma_f32_16x16x32_bf16 v[192:195], v[108:111], v[72:75], v[192:195]
    ds_read_b64_tr_b16 v[98:99], v23 offset:34816
    v_mfma_f32_16x16x32_bf16 v[196:199], v[112:115], v[72:75], v[196:199]
    ds_read_b64_tr_b16 v[100:101], v25 offset:32768
    v_mfma_f32_16x16x32_bf16 v[200:203], v[72:75], v[116:119], v[200:203]
    ds_read_b64_tr_b16 v[102:103], v25 offset:34816
    v_mfma_f32_16x16x32_bf16 v[204:207], v[72:75], v[120:123], v[204:207]
    ds_read_b64_tr_b16 v[104:105], v27 offset:32768
    v_mfma_f32_16x16x32_bf16 v[208:211], v[72:75], v[124:127], v[208:211]
    ds_read_b64_tr_b16 v[106:107], v27 offset:34816
    v_mfma_f32_16x16x32_bf16 v[212:215], v[72:75], v[128:131], v[212:215]
    ds_read_b128 v[52:55], v13 offset:18432
    v_mfma_f32_16x16x32_bf16 v[216:219], v[72:75], v[132:135], v[216:219]
    ds_read_b128 v[56:59], v13 offset:20480
    v_mfma_f32_16x16x32_bf16 v[220:223], v[108:111], v[76:79], v[220:223]
    ds_read_b128 v[60:63], v13 offset:22528
    v_mfma_f32_16x16x32_bf16 v[224:227], v[112:115], v[76:79], v[224:227]
    v_mfma_f32_16x16x32_bf16 v[228:231], v[76:79], v[116:119], v[228:231]
    v_mfma_f32_16x16x32_bf16 v[232:235], v[76:79], v[120:123], v[232:235]
    v_mfma_f32_16x16x32_bf16 v[236:239], v[76:79], v[124:127], v[236:239]
    v_mfma_f32_16x16x32_bf16 v[240:243], v[76:79], v[128:131], v[240:243]
    v_mfma_f32_16x16x32_bf16 v[244:247], v[76:79], v[132:135], v[244:247]
    s_waitcnt lgkmcnt(0)
    v_mfma_f32_16x16x32_bf16 v[136:139], v[80:83], v[48:51], v[136:139]
    v_mfma_f32_16x16x32_bf16 v[140:143], v[84:87], v[48:51], v[140:143]
    v_mfma_f32_16x16x32_bf16 v[144:147], v[48:51], v[88:91], v[144:147]
    v_mfma_f32_16x16x32_bf16 v[148:151], v[48:51], v[92:95], v[148:151]
    v_mfma_f32_16x16x32_bf16 v[152:155], v[48:51], v[96:99], v[152:155]
    ds_read_b128 v[64:67], v14 offset:16384
    v_mfma_f32_16x16x32_bf16 v[156:159], v[48:51], v[100:103], v[156:159]
    ds_read_b64_tr_b16 v[108:109], v16 offset:0
    v_mfma_f32_16x16x32_bf16 v[160:163], v[48:51], v[104:107], v[160:163]
    ds_read_b64_tr_b16 v[110:111], v16 offset:2048
    v_mfma_f32_16x16x32_bf16 v[164:167], v[80:83], v[52:55], v[164:167]
    ds_read_b64_tr_b16 v[112:113], v18 offset:0
    v_mfma_f32_16x16x32_bf16 v[168:171], v[84:87], v[52:55], v[168:171]
    ds_read_b64_tr_b16 v[114:115], v18 offset:2048
    v_mfma_f32_16x16x32_bf16 v[172:175], v[52:55], v[88:91], v[172:175]
    ds_read_b64_tr_b16 v[116:117], v20 offset:0
    v_mfma_f32_16x16x32_bf16 v[176:179], v[52:55], v[92:95], v[176:179]
    ds_read_b64_tr_b16 v[118:119], v20 offset:2048
    v_mfma_f32_16x16x32_bf16 v[180:183], v[52:55], v[96:99], v[180:183]
    ds_read_b64_tr_b16 v[120:121], v22 offset:0
    v_mfma_f32_16x16x32_bf16 v[184:187], v[52:55], v[100:103], v[184:187]
    ds_read_b64_tr_b16 v[122:123], v22 offset:2048
    v_mfma_f32_16x16x32_bf16 v[188:191], v[52:55], v[104:107], v[188:191]
    ds_read_b64_tr_b16 v[124:125], v24 offset:0
    v_mfma_f32_16x16x32_bf16 v[192:195], v[80:83], v[56:59], v[192:195]
    ds_read_b64_tr_b16 v[126:127], v24 offset:2048
    v_mfma_f32_16x16x32_bf16 v[196:199], v[84:87], v[56:59], v[196:199]
    ds_read_b64_tr_b16 v[128:129], v26 offset:0
    v_mfma_f32_16x16x32_bf16 v[200:203], v[56:59], v[88:91], v[200:203]
    ds_read_b64_tr_b16 v[130:131], v26 offset:2048
    v_mfma_f32_16x16x32_bf16 v[204:207], v[56:59], v[92:95], v[204:207]
    ds_read_b64_tr_b16 v[132:133], v28 offset:0
    v_mfma_f32_16x16x32_bf16 v[208:211], v[56:59], v[96:99], v[208:211]
    ds_read_b64_tr_b16 v[134:135], v28 offset:2048
    v_mfma_f32_16x16x32_bf16 v[212:215], v[56:59], v[100:103], v[212:215]
    ds_read_b128 v[68:71], v14 offset:18432
    v_mfma_f32_16x16x32_bf16 v[216:219], v[56:59], v[104:107], v[216:219]
    ds_read_b128 v[72:75], v14 offset:20480
    v_mfma_f32_16x16x32_bf16 v[220:223], v[80:83], v[60:63], v[220:223]
    ds_read_b128 v[76:79], v14 offset:22528
    v_mfma_f32_16x16x32_bf16 v[224:227], v[84:87], v[60:63], v[224:227]
    v_mfma_f32_16x16x32_bf16 v[228:231], v[60:63], v[88:91], v[228:231]
    v_mfma_f32_16x16x32_bf16 v[232:235], v[60:63], v[92:95], v[232:235]
    v_mfma_f32_16x16x32_bf16 v[236:239], v[60:63], v[96:99], v[236:239]
    v_mfma_f32_16x16x32_bf16 v[240:243], v[60:63], v[100:103], v[240:243]
    v_mfma_f32_16x16x32_bf16 v[244:247], v[60:63], v[104:107], v[244:247]
    s_waitcnt lgkmcnt(0)
    v_mfma_f32_16x16x32_bf16 v[136:139], v[108:111], v[64:67], v[136:139]
    v_mfma_f32_16x16x32_bf16 v[140:143], v[112:115], v[64:67], v[140:143]
    v_mfma_f32_16x16x32_bf16 v[144:147], v[64:67], v[116:119], v[144:147]
    v_mfma_f32_16x16x32_bf16 v[148:151], v[64:67], v[120:123], v[148:151]
    s_barrier
    v_mfma_f32_16x16x32_bf16 v[152:155], v[64:67], v[124:127], v[152:155]
    ds_read_b128 v[48:51], v13 offset:32768
    v_mfma_f32_16x16x32_bf16 v[156:159], v[64:67], v[128:131], v[156:159]
    ds_read_b64_tr_b16 v[80:81], v16 offset:16384
    v_mfma_f32_16x16x32_bf16 v[160:163], v[64:67], v[132:135], v[160:163]
    ds_read_b64_tr_b16 v[82:83], v16 offset:18432
    v_mfma_f32_16x16x32_bf16 v[164:167], v[108:111], v[68:71], v[164:167]
    ds_read_b64_tr_b16 v[84:85], v18 offset:16384
    v_mfma_f32_16x16x32_bf16 v[168:171], v[112:115], v[68:71], v[168:171]
    ds_read_b64_tr_b16 v[86:87], v18 offset:18432
    v_mfma_f32_16x16x32_bf16 v[172:175], v[68:71], v[116:119], v[172:175]
    ds_read_b64_tr_b16 v[88:89], v20 offset:16384
    v_mfma_f32_16x16x32_bf16 v[176:179], v[68:71], v[120:123], v[176:179]
    ds_read_b64_tr_b16 v[90:91], v20 offset:18432
    v_mfma_f32_16x16x32_bf16 v[180:183], v[68:71], v[124:127], v[180:183]
    ds_read_b64_tr_b16 v[92:93], v22 offset:16384
    v_mfma_f32_16x16x32_bf16 v[184:187], v[68:71], v[128:131], v[184:187]
    ds_read_b64_tr_b16 v[94:95], v22 offset:18432
    v_mfma_f32_16x16x32_bf16 v[188:191], v[68:71], v[132:135], v[188:191]
    ds_read_b64_tr_b16 v[96:97], v24 offset:16384
    v_mfma_f32_16x16x32_bf16 v[192:195], v[108:111], v[72:75], v[192:195]
    ds_read_b64_tr_b16 v[98:99], v24 offset:18432
    v_mfma_f32_16x16x32_bf16 v[196:199], v[112:115], v[72:75], v[196:199]
    ds_read_b64_tr_b16 v[100:101], v26 offset:16384
    v_mfma_f32_16x16x32_bf16 v[200:203], v[72:75], v[116:119], v[200:203]
    ds_read_b64_tr_b16 v[102:103], v26 offset:18432
    v_mfma_f32_16x16x32_bf16 v[204:207], v[72:75], v[120:123], v[204:207]
    ds_read_b64_tr_b16 v[104:105], v28 offset:16384
    v_mfma_f32_16x16x32_bf16 v[208:211], v[72:75], v[124:127], v[208:211]
    ds_read_b64_tr_b16 v[106:107], v28 offset:18432
    v_mfma_f32_16x16x32_bf16 v[212:215], v[72:75], v[128:131], v[212:215]
    ds_read_b128 v[52:55], v13 offset:34816
    v_mfma_f32_16x16x32_bf16 v[216:219], v[72:75], v[132:135], v[216:219]
    ds_read_b128 v[56:59], v13 offset:36864
    v_mfma_f32_16x16x32_bf16 v[220:223], v[108:111], v[76:79], v[220:223]
    ds_read_b128 v[60:63], v13 offset:38912
    v_mfma_f32_16x16x32_bf16 v[224:227], v[112:115], v[76:79], v[224:227]
    v_mfma_f32_16x16x32_bf16 v[228:231], v[76:79], v[116:119], v[228:231]
    v_mfma_f32_16x16x32_bf16 v[232:235], v[76:79], v[120:123], v[232:235]
    v_mfma_f32_16x16x32_bf16 v[236:239], v[76:79], v[124:127], v[236:239]
    v_mfma_f32_16x16x32_bf16 v[240:243], v[76:79], v[128:131], v[240:243]
    v_mfma_f32_16x16x32_bf16 v[244:247], v[76:79], v[132:135], v[244:247]
    s_waitcnt lgkmcnt(0)
    v_mfma_f32_16x16x32_bf16 v[136:139], v[80:83], v[48:51], v[136:139]
    v_mfma_f32_16x16x32_bf16 v[140:143], v[84:87], v[48:51], v[140:143]
    v_mfma_f32_16x16x32_bf16 v[144:147], v[48:51], v[88:91], v[144:147]
    v_mfma_f32_16x16x32_bf16 v[148:151], v[48:51], v[92:95], v[148:151]
    v_mfma_f32_16x16x32_bf16 v[152:155], v[48:51], v[96:99], v[152:155]
    ds_read_b128 v[64:67], v14 offset:32768
    v_mfma_f32_16x16x32_bf16 v[156:159], v[48:51], v[100:103], v[156:159]
    ds_read_b64_tr_b16 v[108:109], v16 offset:32768
    v_mfma_f32_16x16x32_bf16 v[160:163], v[48:51], v[104:107], v[160:163]
    ds_read_b64_tr_b16 v[110:111], v16 offset:34816
    v_mfma_f32_16x16x32_bf16 v[164:167], v[80:83], v[52:55], v[164:167]
    ds_read_b64_tr_b16 v[112:113], v18 offset:32768
    v_mfma_f32_16x16x32_bf16 v[168:171], v[84:87], v[52:55], v[168:171]
    ds_read_b64_tr_b16 v[114:115], v18 offset:34816
    v_mfma_f32_16x16x32_bf16 v[172:175], v[52:55], v[88:91], v[172:175]
    ds_read_b64_tr_b16 v[116:117], v20 offset:32768
    v_mfma_f32_16x16x32_bf16 v[176:179], v[52:55], v[92:95], v[176:179]
    ds_read_b64_tr_b16 v[118:119], v20 offset:34816
    v_mfma_f32_16x16x32_bf16 v[180:183], v[52:55], v[96:99], v[180:183]
    ds_read_b64_tr_b16 v[120:121], v22 offset:32768
    v_mfma_f32_16x16x32_bf16 v[184:187], v[52:55], v[100:103], v[184:187]
    ds_read_b64_tr_b16 v[122:123], v22 offset:34816
    v_mfma_f32_16x16x32_bf16 v[188:191], v[52:55], v[104:107], v[188:191]
    ds_read_b64_tr_b16 v[124:125], v24 offset:32768
    v_mfma_f32_16x16x32_bf16 v[192:195], v[80:83], v[56:59], v[192:195]
    ds_read_b64_tr_b16 v[126:127], v24 offset:34816
    v_mfma_f32_16x16x32_bf16 v[196:199], v[84:87], v[56:59], v[196:199]
    ds_read_b64_tr_b16 v[128:129], v26 offset:32768
    v_mfma_f32_16x16x32_bf16 v[200:203], v[56:59], v[88:91], v[200:203]
    ds_read_b64_tr_b16 v[130:131], v26 offset:34816
    v_mfma_f32_16x16x32_bf16 v[204:207], v[56:59], v[92:95], v[204:207]
    ds_read_b64_tr_b16 v[132:133], v28 offset:32768
    v_mfma_f32_16x16x32_bf16 v[208:211], v[56:59], v[96:99], v[208:211]
    ds_read_b64_tr_b16 v[134:135], v28 offset:34816
    v_mfma_f32_16x16x32_bf16 v[212:215], v[56:59], v[100:103], v[212:215]
    ds_read_b128 v[68:71], v14 offset:34816
    v_mfma_f32_16x16x32_bf16 v[216:219], v[56:59], v[104:107], v[216:219]
    ds_read_b128 v[72:75], v14 offset:36864
    v_mfma_f32_16x16x32_bf16 v[220:223], v[80:83], v[60:63], v[220:223]
    ds_read_b128 v[76:79], v14 offset:38912
    v_mfma_f32_16x16x32_bf16 v[224:227], v[84:87], v[60:63], v[224:227]
    v_mfma_f32_16x16x32_bf16 v[228:231], v[60:63], v[88:91], v[228:231]
    v_mfma_f32_16x16x32_bf16 v[232:235], v[60:63], v[92:95], v[232:235]
    v_mfma_f32_16x16x32_bf16 v[236:239], v[60:63], v[96:99], v[236:239]
    v_mfma_f32_16x16x32_bf16 v[240:243], v[60:63], v[100:103], v[240:243]
    v_mfma_f32_16x16x32_bf16 v[244:247], v[60:63], v[104:107], v[244:247]
    s_waitcnt lgkmcnt(0)
    v_mfma_f32_16x16x32_bf16 v[144:147], v[64:67], v[116:119], v[144:147]
    v_mfma_f32_16x16x32_bf16 v[172:175], v[68:71], v[116:119], v[172:175]
    v_mfma_f32_16x16x32_bf16 v[200:203], v[72:75], v[116:119], v[200:203]
    v_mfma_f32_16x16x32_bf16 v[228:231], v[76:79], v[116:119], v[228:231]
    v_mfma_f32_16x16x32_bf16 v[148:151], v[64:67], v[120:123], v[148:151]
    s_mov_b32 s42, 0x3fb8aa3b
    s_mov_b32 s43, 0x3fb8aa3b
    v_mfma_f32_16x16x32_bf16 v[176:179], v[68:71], v[120:123], v[176:179]
    s_mov_b32 s44, 0x358637bd
    s_mov_b32 s45, 0x358637bd
    v_mfma_f32_16x16x32_bf16 v[204:207], v[72:75], v[120:123], v[204:207]
    v_lshlrev_b32 v2, 4, v1
    v_bfe_u32 v3, v1, 2, 2
    v_mfma_f32_16x16x32_bf16 v[232:235], v[76:79], v[120:123], v[232:235]
    v_lshlrev_b32 v3, 18, v3
    v_bfe_u32 v4, v1, 1, 1
    v_mfma_f32_16x16x32_bf16 v[160:163], v[64:67], v[132:135], v[160:163]
    v_lshl_add_u32 v3, v4, 13, v3
    v_lshrrev_b32 v4, 4, v1
    v_mfma_f32_16x16x32_bf16 v[188:191], v[68:71], v[132:135], v[188:191]
    v_lshlrev_b32 v8, 4, v4
    v_add_u32 v3, v8, v3
    v_mfma_f32_16x16x32_bf16 v[216:219], v[72:75], v[132:135], v[216:219]
    s_lshl_b32 s33, s24, 17
    s_lshl_b32 s35, s46, 5
    v_mfma_f32_16x16x32_bf16 v[244:247], v[76:79], v[132:135], v[244:247]
    s_add_u32 s33, s33, s35
    s_lshl_b32 s40, s24, 14
    v_mfma_f32_16x16x32_bf16 v[136:139], v[108:111], v[64:67], v[136:139]
    s_lshl_b32 s35, s46, 2
    s_add_u32 s40, s40, s35
    v_mfma_f32_16x16x32_bf16 v[164:167], v[108:111], v[68:71], v[164:167]
    v_min_f32 v30, 0, v144
    v_min_f32 v31, 0, v145
    v_mfma_f32_16x16x32_bf16 v[192:195], v[108:111], v[72:75], v[192:195]
    v_pk_mul_f32 v[32:33], v[30:31], s[42:43]
    v_pk_add_f32 v[144:145], v[144:145], v[30:31] neg_lo:[0,1] neg_hi:[0,1]
    v_mfma_f32_16x16x32_bf16 v[220:223], v[108:111], v[76:79], v[220:223]
    v_exp_f32 v32, v32
    v_exp_f32 v33, v33
    v_mfma_f32_16x16x32_bf16 v[140:143], v[112:115], v[64:67], v[140:143]
    v_pk_add_f32 v[144:145], v[144:145], s[44:45]
    v_pk_add_f32 v[144:145], v[144:145], v[32:33]
    v_mfma_f32_16x16x32_bf16 v[168:171], v[112:115], v[68:71], v[168:171]
    v_min_f32 v34, 0, v146
    v_min_f32 v35, 0, v147
    v_mfma_f32_16x16x32_bf16 v[196:199], v[112:115], v[72:75], v[196:199]
    v_pk_mul_f32 v[36:37], v[34:35], s[42:43]
    v_pk_add_f32 v[146:147], v[146:147], v[34:35] neg_lo:[0,1] neg_hi:[0,1]
    v_mfma_f32_16x16x32_bf16 v[224:227], v[112:115], v[76:79], v[224:227]
    v_exp_f32 v36, v36
    v_exp_f32 v37, v37
    v_mfma_f32_16x16x32_bf16 v[152:155], v[64:67], v[124:127], v[152:155]
    v_pk_add_f32 v[146:147], v[146:147], s[44:45]
    v_pk_add_f32 v[146:147], v[146:147], v[36:37]
    v_mfma_f32_16x16x32_bf16 v[180:183], v[68:71], v[124:127], v[180:183]
    v_min_f32 v30, 0, v172
    v_min_f32 v31, 0, v173
    v_mfma_f32_16x16x32_bf16 v[208:211], v[72:75], v[124:127], v[208:211]
    v_pk_mul_f32 v[32:33], v[30:31], s[42:43]
    v_pk_add_f32 v[172:173], v[172:173], v[30:31] neg_lo:[0,1] neg_hi:[0,1]
    v_mfma_f32_16x16x32_bf16 v[236:239], v[76:79], v[124:127], v[236:239]
    v_exp_f32 v32, v32
    v_exp_f32 v33, v33
    v_mfma_f32_16x16x32_bf16 v[156:159], v[64:67], v[128:131], v[156:159]
    v_pk_add_f32 v[172:173], v[172:173], s[44:45]
    v_pk_add_f32 v[172:173], v[172:173], v[32:33]
    v_mfma_f32_16x16x32_bf16 v[184:187], v[68:71], v[128:131], v[184:187]
    v_min_f32 v34, 0, v174
    v_min_f32 v35, 0, v175
    v_mfma_f32_16x16x32_bf16 v[212:215], v[72:75], v[128:131], v[212:215]
    v_pk_mul_f32 v[36:37], v[34:35], s[42:43]
    v_pk_add_f32 v[174:175], v[174:175], v[34:35] neg_lo:[0,1] neg_hi:[0,1]
    v_mfma_f32_16x16x32_bf16 v[240:243], v[76:79], v[128:131], v[240:243]
    v_exp_f32 v36, v36
    v_exp_f32 v37, v37
    v_pk_add_f32 v[174:175], v[174:175], s[44:45]
    v_pk_add_f32 v[174:175], v[174:175], v[36:37]
    s_waitcnt vmcnt(0)
    v_cvt_pk_bf16_f32 v48, v136, v137
    v_cvt_pk_bf16_f32 v49, v138, v139
    v_cvt_pk_bf16_f32 v50, v164, v165
    v_cvt_pk_bf16_f32 v51, v166, v167
    s_add_u32 s35, s33, 4194304
    s_nop 0
    v_permlane16_swap_b32 v48, v50
    v_permlane16_swap_b32 v49, v51
    buffer_store_dwordx4 v[48:51], v2, s[12:15], s35 offen offset:0
    v_cvt_pk_bf16_f32 v52, v192, v193
    v_cvt_pk_bf16_f32 v53, v194, v195
    v_cvt_pk_bf16_f32 v54, v220, v221
    v_cvt_pk_bf16_f32 v55, v222, v223
    s_nop 0
    s_nop 0
    v_permlane16_swap_b32 v52, v54
    v_permlane16_swap_b32 v53, v55
    buffer_store_dwordx4 v[52:55], v2, s[12:15], s35 offen offset:1024
    v_cvt_pk_bf16_f32 v56, v140, v141
    v_cvt_pk_bf16_f32 v57, v142, v143
    v_cvt_pk_bf16_f32 v58, v168, v169
    v_cvt_pk_bf16_f32 v59, v170, v171
    s_add_u32 s35, s33, 4259840
    s_nop 0
    v_permlane16_swap_b32 v56, v58
    v_permlane16_swap_b32 v57, v59
    buffer_store_dwordx4 v[56:59], v2, s[12:15], s35 offen offset:0
    v_cvt_pk_bf16_f32 v60, v196, v197
    v_cvt_pk_bf16_f32 v61, v198, v199
    v_cvt_pk_bf16_f32 v62, v224, v225
    v_cvt_pk_bf16_f32 v63, v226, v227
    s_nop 0
    s_nop 0
    v_permlane16_swap_b32 v60, v62
    v_permlane16_swap_b32 v61, v63
    buffer_store_dwordx4 v[60:63], v2, s[12:15], s35 offen offset:1024
    s_add_u32 s35, s40, 6815744
    v_mov_b32_dpp v84, v160 quad_perm:[1,0,3,2] row_mask:0xf bank_mask:0xf
    v_mov_b32_dpp v85, v161 quad_perm:[1,0,3,2] row_mask:0xf bank_mask:0xf
    v_mov_b32_dpp v86, v162 quad_perm:[1,0,3,2] row_mask:0xf bank_mask:0xf
    v_mov_b32_dpp v87, v163 quad_perm:[1,0,3,2] row_mask:0xf bank_mask:0xf
    v_cvt_pk_bf16_f32 v80, v160, v84
    v_cvt_pk_bf16_f32 v81, v161, v85
    v_cvt_pk_bf16_f32 v82, v162, v86
    v_cvt_pk_bf16_f32 v83, v163, v87
    s_mov_b32 exec_lo, 0x00050005
    s_mov_b32 exec_hi, 0x00050005
    buffer_store_dwordx4 v[80:83], v3, s[12:15], s35 offen offset:0
    s_mov_b64 exec, -1
    v_mov_b32_dpp v96, v188 quad_perm:[1,0,3,2] row_mask:0xf bank_mask:0xf
    v_mov_b32_dpp v97, v189 quad_perm:[1,0,3,2] row_mask:0xf bank_mask:0xf
    v_mov_b32_dpp v98, v190 quad_perm:[1,0,3,2] row_mask:0xf bank_mask:0xf
    v_mov_b32_dpp v99, v191 quad_perm:[1,0,3,2] row_mask:0xf bank_mask:0xf
    v_cvt_pk_bf16_f32 v92, v188, v96
    v_cvt_pk_bf16_f32 v93, v189, v97
    v_cvt_pk_bf16_f32 v94, v190, v98
    v_cvt_pk_bf16_f32 v95, v191, v99
    s_mov_b32 exec_lo, 0x00050005
    s_mov_b32 exec_hi, 0x00050005
    buffer_store_dwordx4 v[92:95], v3, s[12:15], s35 offen offset:64
    s_mov_b64 exec, -1
    v_mov_b32_dpp v108, v216 quad_perm:[1,0,3,2] row_mask:0xf bank_mask:0xf
    v_mov_b32_dpp v109, v217 quad_perm:[1,0,3,2] row_mask:0xf bank_mask:0xf
    v_mov_b32_dpp v110, v218 quad_perm:[1,0,3,2] row_mask:0xf bank_mask:0xf
    v_mov_b32_dpp v111, v219 quad_perm:[1,0,3,2] row_mask:0xf bank_mask:0xf
    v_cvt_pk_bf16_f32 v104, v216, v108
    v_cvt_pk_bf16_f32 v105, v217, v109
    v_cvt_pk_bf16_f32 v106, v218, v110
    v_cvt_pk_bf16_f32 v107, v219, v111
    s_mov_b32 exec_lo, 0x00050005
    s_mov_b32 exec_hi, 0x00050005
    buffer_store_dwordx4 v[104:107], v3, s[12:15], s35 offen offset:128
    s_mov_b64 exec, -1
    v_mov_b32_dpp v120, v244 quad_perm:[1,0,3,2] row_mask:0xf bank_mask:0xf
    v_mov_b32_dpp v121, v245 quad_perm:[1,0,3,2] row_mask:0xf bank_mask:0xf
    v_mov_b32_dpp v122, v246 quad_perm:[1,0,3,2] row_mask:0xf bank_mask:0xf
    v_mov_b32_dpp v123, v247 quad_perm:[1,0,3,2] row_mask:0xf bank_mask:0xf
    v_cvt_pk_bf16_f32 v116, v244, v120
    v_cvt_pk_bf16_f32 v117, v245, v121
    v_cvt_pk_bf16_f32 v118, v246, v122
    v_cvt_pk_bf16_f32 v119, v247, v123
    s_mov_b32 exec_lo, 0x00050005
    s_mov_b32 exec_hi, 0x00050005
    buffer_store_dwordx4 v[116:119], v3, s[12:15], s35 offen offset:192
    s_mov_b64 exec, -1
    v_min_f32 v64, 0, v200
    v_min_f32 v65, 0, v201
    v_pk_mul_f32 v[66:67], v[64:65], s[42:43]
    v_pk_add_f32 v[200:201], v[200:201], v[64:65] neg_lo:[0,1] neg_hi:[0,1]
    v_exp_f32 v66, v66
    v_exp_f32 v67, v67
    v_pk_add_f32 v[200:201], v[200:201], s[44:45]
    v_pk_add_f32 v[200:201], v[200:201], v[66:67]
    v_min_f32 v68, 0, v202
    v_min_f32 v69, 0, v203
    v_pk_mul_f32 v[70:71], v[68:69], s[42:43]
    v_pk_add_f32 v[202:203], v[202:203], v[68:69] neg_lo:[0,1] neg_hi:[0,1]
    v_exp_f32 v70, v70
    v_exp_f32 v71, v71
    v_pk_add_f32 v[202:203], v[202:203], s[44:45]
    v_pk_add_f32 v[202:203], v[202:203], v[70:71]
    v_min_f32 v64, 0, v228
    v_min_f32 v65, 0, v229
    v_pk_mul_f32 v[66:67], v[64:65], s[42:43]
    v_pk_add_f32 v[228:229], v[228:229], v[64:65] neg_lo:[0,1] neg_hi:[0,1]
    v_exp_f32 v66, v66
    v_exp_f32 v67, v67
    v_pk_add_f32 v[228:229], v[228:229], s[44:45]
    v_pk_add_f32 v[228:229], v[228:229], v[66:67]
    v_min_f32 v68, 0, v230
    v_min_f32 v69, 0, v231
    v_pk_mul_f32 v[70:71], v[68:69], s[42:43]
    v_pk_add_f32 v[230:231], v[230:231], v[68:69] neg_lo:[0,1] neg_hi:[0,1]
    v_exp_f32 v70, v70
    v_exp_f32 v71, v71
    v_pk_add_f32 v[230:231], v[230:231], s[44:45]
    v_pk_add_f32 v[230:231], v[230:231], v[70:71]
    v_min_f32 v64, 0, v148
    v_min_f32 v65, 0, v149
    v_pk_mul_f32 v[66:67], v[64:65], s[42:43]
    v_pk_add_f32 v[148:149], v[148:149], v[64:65] neg_lo:[0,1] neg_hi:[0,1]
    v_exp_f32 v66, v66
    v_exp_f32 v67, v67
    v_pk_add_f32 v[148:149], v[148:149], s[44:45]
    v_pk_add_f32 v[148:149], v[148:149], v[66:67]
    v_min_f32 v68, 0, v150
    v_min_f32 v69, 0, v151
    v_pk_mul_f32 v[70:71], v[68:69], s[42:43]
    v_pk_add_f32 v[150:151], v[150:151], v[68:69] neg_lo:[0,1] neg_hi:[0,1]
    v_exp_f32 v70, v70
    v_exp_f32 v71, v71
    v_pk_add_f32 v[150:151], v[150:151], s[44:45]
    v_pk_add_f32 v[150:151], v[150:151], v[70:71]
    v_min_f32 v64, 0, v176
    v_min_f32 v65, 0, v177
    v_pk_mul_f32 v[66:67], v[64:65], s[42:43]
    v_pk_add_f32 v[176:177], v[176:177], v[64:65] neg_lo:[0,1] neg_hi:[0,1]
    v_exp_f32 v66, v66
    v_exp_f32 v67, v67
    v_pk_add_f32 v[176:177], v[176:177], s[44:45]
    v_pk_add_f32 v[176:177], v[176:177], v[66:67]
    v_min_f32 v68, 0, v178
    v_min_f32 v69, 0, v179
    v_pk_mul_f32 v[70:71], v[68:69], s[42:43]
    v_pk_add_f32 v[178:179], v[178:179], v[68:69] neg_lo:[0,1] neg_hi:[0,1]
    v_exp_f32 v70, v70
    v_exp_f32 v71, v71
    v_pk_add_f32 v[178:179], v[178:179], s[44:45]
    v_pk_add_f32 v[178:179], v[178:179], v[70:71]
    v_min_f32 v64, 0, v204
    v_min_f32 v65, 0, v205
    v_pk_mul_f32 v[66:67], v[64:65], s[42:43]
    v_pk_add_f32 v[204:205], v[204:205], v[64:65] neg_lo:[0,1] neg_hi:[0,1]
    v_exp_f32 v66, v66
    v_exp_f32 v67, v67
    v_pk_add_f32 v[204:205], v[204:205], s[44:45]
    v_pk_add_f32 v[204:205], v[204:205], v[66:67]
    v_min_f32 v68, 0, v206
    v_min_f32 v69, 0, v207
    v_pk_mul_f32 v[70:71], v[68:69], s[42:43]
    v_pk_add_f32 v[206:207], v[206:207], v[68:69] neg_lo:[0,1] neg_hi:[0,1]
    v_exp_f32 v70, v70
    v_exp_f32 v71, v71
    v_pk_add_f32 v[206:207], v[206:207], s[44:45]
    v_pk_add_f32 v[206:207], v[206:207], v[70:71]
    v_min_f32 v64, 0, v232
    v_min_f32 v65, 0, v233
    v_pk_mul_f32 v[66:67], v[64:65], s[42:43]
    v_pk_add_f32 v[232:233], v[232:233], v[64:65] neg_lo:[0,1] neg_hi:[0,1]
    v_exp_f32 v66, v66
    v_exp_f32 v67, v67
    v_pk_add_f32 v[232:233], v[232:233], s[44:45]
    v_pk_add_f32 v[232:233], v[232:233], v[66:67]
    v_min_f32 v68, 0, v234
    v_min_f32 v69, 0, v235
    v_pk_mul_f32 v[70:71], v[68:69], s[42:43]
    v_pk_add_f32 v[234:235], v[234:235], v[68:69] neg_lo:[0,1] neg_hi:[0,1]
    v_exp_f32 v70, v70
    v_exp_f32 v71, v71
    v_pk_add_f32 v[234:235], v[234:235], s[44:45]
    v_pk_add_f32 v[234:235], v[234:235], v[70:71]
    s_mov_b32 exec_lo, 0x00f000f0
    s_mov_b32 exec_hi, 0x00f000f0
    v_min_f32 v64, 0, v160
    v_min_f32 v65, 0, v161
    v_pk_mul_f32 v[66:67], v[64:65], s[42:43]
    v_pk_add_f32 v[160:161], v[160:161], v[64:65] neg_lo:[0,1] neg_hi:[0,1]
    v_exp_f32 v66, v66
    v_exp_f32 v67, v67
    v_pk_add_f32 v[160:161], v[160:161], s[44:45]
    v_pk_add_f32 v[160:161], v[160:161], v[66:67]
    v_min_f32 v68, 0, v162
    v_min_f32 v69, 0, v163
    v_pk_mul_f32 v[70:71], v[68:69], s[42:43]
    v_pk_add_f32 v[162:163], v[162:163], v[68:69] neg_lo:[0,1] neg_hi:[0,1]
    v_exp_f32 v70, v70
    v_exp_f32 v71, v71
    v_pk_add_f32 v[162:163], v[162:163], s[44:45]
    v_pk_add_f32 v[162:163], v[162:163], v[70:71]
    v_min_f32 v64, 0, v188
    v_min_f32 v65, 0, v189
    v_pk_mul_f32 v[66:67], v[64:65], s[42:43]
    v_pk_add_f32 v[188:189], v[188:189], v[64:65] neg_lo:[0,1] neg_hi:[0,1]
    v_exp_f32 v66, v66
    v_exp_f32 v67, v67
    v_pk_add_f32 v[188:189], v[188:189], s[44:45]
    v_pk_add_f32 v[188:189], v[188:189], v[66:67]
    v_min_f32 v68, 0, v190
    v_min_f32 v69, 0, v191
    v_pk_mul_f32 v[70:71], v[68:69], s[42:43]
    v_pk_add_f32 v[190:191], v[190:191], v[68:69] neg_lo:[0,1] neg_hi:[0,1]
    v_exp_f32 v70, v70
    v_exp_f32 v71, v71
    v_pk_add_f32 v[190:191], v[190:191], s[44:45]
    v_pk_add_f32 v[190:191], v[190:191], v[70:71]
    v_min_f32 v64, 0, v216
    v_min_f32 v65, 0, v217
    v_pk_mul_f32 v[66:67], v[64:65], s[42:43]
    v_pk_add_f32 v[216:217], v[216:217], v[64:65] neg_lo:[0,1] neg_hi:[0,1]
    v_exp_f32 v66, v66
    v_exp_f32 v67, v67
    v_pk_add_f32 v[216:217], v[216:217], s[44:45]
    v_pk_add_f32 v[216:217], v[216:217], v[66:67]
    v_min_f32 v68, 0, v218
    v_min_f32 v69, 0, v219
    v_pk_mul_f32 v[70:71], v[68:69], s[42:43]
    v_pk_add_f32 v[218:219], v[218:219], v[68:69] neg_lo:[0,1] neg_hi:[0,1]
    v_exp_f32 v70, v70
    v_exp_f32 v71, v71
    v_pk_add_f32 v[218:219], v[218:219], s[44:45]
    v_pk_add_f32 v[218:219], v[218:219], v[70:71]
    v_min_f32 v64, 0, v244
    v_min_f32 v65, 0, v245
    v_pk_mul_f32 v[66:67], v[64:65], s[42:43]
    v_pk_add_f32 v[244:245], v[244:245], v[64:65] neg_lo:[0,1] neg_hi:[0,1]
    v_exp_f32 v66, v66
    v_exp_f32 v67, v67
    v_pk_add_f32 v[244:245], v[244:245], s[44:45]
    v_pk_add_f32 v[244:245], v[244:245], v[66:67]
    v_min_f32 v68, 0, v246
    v_min_f32 v69, 0, v247
    v_pk_mul_f32 v[70:71], v[68:69], s[42:43]
    v_pk_add_f32 v[246:247], v[246:247], v[68:69] neg_lo:[0,1] neg_hi:[0,1]
    v_exp_f32 v70, v70
    v_exp_f32 v71, v71
    v_pk_add_f32 v[246:247], v[246:247], s[44:45]
    v_pk_add_f32 v[246:247], v[246:247], v[70:71]
    s_mov_b32 exec_lo, 0xf000f000
    s_mov_b32 exec_hi, 0xf000f000
    v_mov_b32 v160, 1.0
    v_mov_b32 v161, 1.0
    v_mov_b32 v162, 1.0
    v_mov_b32 v163, 1.0
    v_mov_b32 v188, 1.0
    v_mov_b32 v189, 1.0
    v_mov_b32 v190, 1.0
    v_mov_b32 v191, 1.0
    v_mov_b32 v216, 1.0
    v_mov_b32 v217, 1.0
    v_mov_b32 v218, 1.0
    v_mov_b32 v219, 1.0
    v_mov_b32 v244, 1.0
    v_mov_b32 v245, 1.0
    v_mov_b32 v246, 1.0
    v_mov_b32 v247, 1.0
    s_mov_b64 exec, -1
    v_cvt_pk_bf16_f32 v136, v144, v145
    v_cvt_pk_bf16_f32 v137, v146, v147
    v_cvt_pk_bf16_f32 v138, v172, v173
    v_cvt_pk_bf16_f32 v139, v174, v175
    v_cvt_pk_bf16_f32 v140, v200, v201
    v_cvt_pk_bf16_f32 v141, v202, v203
    v_cvt_pk_bf16_f32 v142, v228, v229
    v_cvt_pk_bf16_f32 v143, v230, v231
    v_cvt_pk_bf16_f32 v164, v148, v149
    v_cvt_pk_bf16_f32 v165, v150, v151
    v_cvt_pk_bf16_f32 v166, v176, v177
    v_cvt_pk_bf16_f32 v167, v178, v179
    v_cvt_pk_bf16_f32 v168, v204, v205
    v_cvt_pk_bf16_f32 v169, v206, v207
    v_cvt_pk_bf16_f32 v170, v232, v233
    v_cvt_pk_bf16_f32 v171, v234, v235
    v_cvt_pk_bf16_f32 v192, v152, v153
    v_cvt_pk_bf16_f32 v193, v154, v155
    v_cvt_pk_bf16_f32 v194, v180, v181
    v_cvt_pk_bf16_f32 v195, v182, v183
    v_cvt_pk_bf16_f32 v196, v208, v209
    v_cvt_pk_bf16_f32 v197, v210, v211
    v_cvt_pk_bf16_f32 v198, v236, v237
    v_cvt_pk_bf16_f32 v199, v238, v239
    v_cvt_pk_bf16_f32 v220, v156, v157
    v_cvt_pk_bf16_f32 v221, v158, v159
    v_cvt_pk_bf16_f32 v222, v184, v185
    v_cvt_pk_bf16_f32 v223, v186, v187
    v_cvt_pk_bf16_f32 v224, v212, v213
    v_cvt_pk_bf16_f32 v225, v214, v215
    v_cvt_pk_bf16_f32 v226, v240, v241
    v_cvt_pk_bf16_f32 v227, v242, v243
    v_cvt_pk_bf16_f32 v72, v160, v161
    v_cvt_pk_bf16_f32 v73, v162, v163
    v_cvt_pk_bf16_f32 v74, v188, v189
    v_cvt_pk_bf16_f32 v75, v190, v191
    v_cvt_pk_bf16_f32 v76, v216, v217
    v_cvt_pk_bf16_f32 v77, v218, v219
    v_cvt_pk_bf16_f32 v78, v244, v245
    v_cvt_pk_bf16_f32 v79, v246, v247
    s_nop 1
    v_mfma_f32_16x16x32_bf16 v[144:147], v[136:139], v[192:195], 0
    v_mfma_f32_16x16x32_bf16 v[148:151], v[164:167], v[220:223], 0
    v_mfma_f32_16x16x32_bf16 v[152:155], v[136:139], v[72:75], 0
    v_mfma_f32_16x16x32_bf16 v[156:159], v[164:167], v[72:75], 0
    v_mfma_f32_16x16x32_bf16 v[172:175], v[72:75], v[192:195], 0
    v_mfma_f32_16x16x32_bf16 v[176:179], v[72:75], v[220:223], 0
    v_mfma_f32_16x16x32_bf16 v[180:183], v[72:75], v[72:75], 0
    v_mfma_f32_16x16x32_bf16 v[144:147], v[140:143], v[196:199], v[144:147]
    v_mfma_f32_16x16x32_bf16 v[148:151], v[168:171], v[224:227], v[148:151]
    v_mfma_f32_16x16x32_bf16 v[152:155], v[140:143], v[76:79], v[152:155]
    v_mfma_f32_16x16x32_bf16 v[156:159], v[168:171], v[76:79], v[156:159]
    v_mfma_f32_16x16x32_bf16 v[172:175], v[76:79], v[196:199], v[172:175]
    v_mfma_f32_16x16x32_bf16 v[176:179], v[76:79], v[224:227], v[176:179]
    v_mfma_f32_16x16x32_bf16 v[180:183], v[76:79], v[76:79], v[180:183]
    s_mul_i32 s33, s20, 3072
    s_add_u32 s33, s33, 2048
    v_and_b32 v2, 15, v1
    v_lshrrev_b32 v3, 4, v1
    v_mul_u32_u24 v4, 80, v2
    v_add_u32 v4, s33, v4
    v_lshl_add_u32 v5, v3, 4, v4
    v_and_b32 v6, 1, v1
    v_add_u32 v6, 16, v6
    v_cmp_eq_u32 vcc, 12, v2
    v_mov_b32 v7, 18
    s_nop 1
    v_cndmask_b32 v6, v6, v7, vcc
    v_mul_u32_u24 v6, 80, v6
    v_add_u32 v6, s33, v6
    v_lshl_add_u32 v7, v3, 4, v6
    s_nop 7

    ds_write_b128 v5, v[144:147]
    ds_write_b128 v5, v[148:151] offset:1520
    s_mov_b32 exec_lo, 0x13001300
    s_mov_b32 exec_hi, 0x13001300
    ds_write_b128 v7, v[152:155]
    s_mov_b32 exec_lo, 0x1c001c00
    s_mov_b32 exec_hi, 0x1c001c00
    ds_write_b128 v7, v[156:159] offset:1520
    s_mov_b32 exec_lo, 0xffff0000
    s_mov_b32 exec_hi, 0x00000000
    ds_write_b64 v4, v[172:173] offset:64
    ds_write_b64 v4, v[178:179] offset:1584
    s_mov_b32 exec_lo, 0x13000000
    s_mov_b32 exec_hi, 0x00000000
    ds_write_b64 v6, v[180:181] offset:64
    s_mov_b32 exec_lo, 0x1c000000
    s_mov_b32 exec_hi, 0x00000000
    ds_write_b64 v6, v[182:183] offset:1584
    s_mov_b64 exec, -1
    s_lshr_b32 s34, s20, 1
    s_lshl_b32 s34, s34, 10
    v_lshlrev_b32 v2, 4, v1
    v_add_u32 v2, s34, v2
    s_and_b32 s34, s20, 1
    s_mul_i32 s34, s34, 3072
    v_add_u32 v3, s34, v2
    s_lshl_b32 s33, s24, 4
    s_add_u32 s33, s33, s22
    s_mul_i32 s33, s33, 3040
    s_add_u32 s33, s33, 7143424
    s_waitcnt lgkmcnt(0)
    s_barrier

    ds_read_b128 v[48:51], v3 offset:2048
    ds_read_b128 v[52:55], v3 offset:8192
    ds_read_b128 v[56:59], v3 offset:4096
    ds_read_b128 v[60:63], v3 offset:10240
    v_cmp_gt_u32 vcc, 992, v2
    s_waitcnt lgkmcnt(2)
    v_pk_add_f32 v[48:49], v[48:49], v[52:53]
    v_pk_add_f32 v[50:51], v[50:51], v[54:55]
    buffer_store_dwordx4 v[48:51], v2, s[12:15], s33 offen
    s_waitcnt lgkmcnt(0)
    v_pk_add_f32 v[56:57], v[56:57], v[60:61]
    v_pk_add_f32 v[58:59], v[58:59], v[62:63]
    s_and_saveexec_b64 s[42:43], vcc
    s_cbranch_execz L_k1_end
    buffer_store_dwordx4 v[56:59], v2, s[12:15], s33 offen offset:2048

L_k1_end:
    s_endpgm
.p2align 8
k2_kernel:
    s_cmp_ge_u32 s2, 256
    s_cbranch_scc1 L_k2_end

    s_load_dwordx2 s[4:5], s[0:1], 72
    s_load_dwordx2 s[80:81], s[0:1], 16
    s_load_dwordx2 s[84:85], s[0:1], 40
    v_lshrrev_b32 v5, 6, v0
    v_and_b32 v1, 63, v0
    v_readfirstlane_b32 s8, v5
    s_and_b32 s27, s2, 7
    s_lshr_b32 s28, s2, 3
    s_and_b32 s9, s28, 3
    s_lshl_b32 s27, s27, 2
    s_add_u32 s9, s9, s27
    s_lshr_b32 s10, s28, 2
    s_mov_b32 s6, 17825792
    s_mov_b32 s7, 0x00020000
    s_lshr_b32 s11, s8, 2
    s_and_b32 s12, s8, 3
    s_mov_b32 s20, 0x0003ffff
    s_mov_b32 s21, 0x0003ffff
    s_mov_b32 s34, -1
    s_mov_b32 s35, 0
    s_mov_b32 s36, 0x40000000
    s_mov_b32 s26, 0
    s_mov_b32 s22, 0x3fb8aa3b
    s_mov_b32 s23, 0x3fb8aa3b
    s_mov_b32 s24, 0x358637bd
    s_mov_b32 s25, 0x358637bd
    v_lshlrev_b32 v2, 4, v1
    v_lshlrev_b32 v3, 2, v1
    v_mov_b32 v5, s36
    v_cndmask_b32 v3, v5, v3, s[34:35]
    v_lshlrev_b32 v50, 1, v3
    v_lshrrev_b32 v5, 5, v1
    v_mul_u32_u24 v4, 288, v5
    v_and_b32 v6, 31, v1
    v_lshl_add_u32 v4, v6, 4, v4
    s_lshl_b32 s37, s10, 8
    s_lshl_b32 s27, s11, 7
    s_add_u32 s37, s37, s27
    s_lshl_b32 s31, s9, 16
    s_lshl_b32 s32, s9, 13
    s_mul_i32 s33, s9, 73728
    s_waitcnt lgkmcnt(0)

    s_xor_b32 s27, s12, 0
    s_lshl_b32 s27, s27, 5
    s_add_u32 s27, s27, s37
    s_lshl_b32 s28, s27, 5
    s_add_u32 s28, s28, s31
    buffer_load_dwordx4 v[56:59], v2, s[4:7], s28 offen
    s_lshl_b32 s29, s27, 2
    s_add_u32 s29, s29, s32
    s_lshl_b32 s30, s29, 1
    s_add_u32 s30, s30, 11010048
    buffer_load_dwordx2 v[72:73], v50, s[4:7], s30 offen
    s_add_u32 s16, s28, 4194304
    s_add_u32 s17, s29, 6815744
    s_lshl_b32 s18, s27, 2
    s_add_u32 s18, s18, 7077888
    s_xor_b32 s27, s12, 1
    s_lshl_b32 s27, s27, 5
    s_add_u32 s27, s27, s37
    s_lshl_b32 s28, s27, 5
    s_add_u32 s28, s28, s31
    buffer_load_dwordx4 v[60:63], v2, s[4:7], s28 offen
    s_lshl_b32 s29, s27, 2
    s_add_u32 s29, s29, s32
    s_lshl_b32 s30, s29, 1
    s_add_u32 s30, s30, 11010048
    buffer_load_dwordx2 v[74:75], v50, s[4:7], s30 offen
    s_xor_b32 s27, s12, 2
    s_lshl_b32 s27, s27, 5
    s_add_u32 s27, s27, s37
    s_lshl_b32 s28, s27, 5
    s_add_u32 s28, s28, s31
    buffer_load_dwordx4 v[64:67], v2, s[4:7], s28 offen
    s_lshl_b32 s29, s27, 2
    s_add_u32 s29, s29, s32
    s_lshl_b32 s30, s29, 1
    s_add_u32 s30, s30, 11010048
    buffer_load_dwordx2 v[76:77], v50, s[4:7], s30 offen
    s_xor_b32 s27, s12, 3
    s_lshl_b32 s27, s27, 5
    s_add_u32 s27, s27, s37
    s_lshl_b32 s28, s27, 5
    s_add_u32 s28, s28, s31
    buffer_load_dwordx4 v[68:71], v2, s[4:7], s28 offen
    s_lshl_b32 s29, s27, 2
    s_add_u32 s29, s29, s32
    s_lshl_b32 s30, s29, 1
    s_add_u32 s30, s30, 11010048
    buffer_load_dwordx2 v[78:79], v50, s[4:7], s30 offen
    s_add_u32 s31, s31, 2097152
    s_add_u32 s32, s32, 6553600
    s_add_u32 s33, s33, 8388608
    s_lshl_b32 s27, s12, 14
    s_add_u32 s31, s31, s27
    s_lshl_b32 s27, s12, 11
    s_add_u32 s32, s32, s27
    s_mul_i32 s27, s12, 18432
    s_add_u32 s33, s33, s27

    s_and_b32 s72, s2, 7
    s_lshl_b32 s72, s72, 5
    s_lshr_b32 s28, s2, 3
    s_add_u32 s72, s72, s28
    s_mul_i32 s73, s72, 7282
    s_lshr_b32 s73, s73, 16
    s_mul_i32 s28, s73, 9
    s_sub_u32 s74, s72, s28
    s_min_u32 s28, s73, 16
    s_lshl_b32 s75, s73, 2
    s_add_u32 s75, s75, s28
    s_bitcmp0_b32 s8, 1
    s_cselect_b32 s64, s80, s84
    s_cselect_b32 s65, s81, s85
    s_mov_b32 s66, 663552
    s_mov_b32 s67, 0x00020000
    s_and_b32 s27, s8, 1
    s_mul_i32 s76, s27, 331776
    s_lshl_b32 s27, s74, 7
    s_add_u32 s76, s76, s27
    s_add_u32 s77, s76, 331776
    s_and_b32 s79, s74, 3
    s_lshl_b32 s79, s79, 1
    s_lshr_b32 s28, s8, 2
    s_lshl_b32 s27, s28, 1
    s_add_u32 s27, s27, s79
    s_and_b32 s27, s27, 7
    s_mul_i32 s27, s27, 41472
    s_add_u32 s76, s76, s27
    s_and_b32 s78, s8, 3
    s_mul_i32 s78, s78, 18432
    s_mul_i32 s28, s28, 9216
    s_add_u32 s78, s78, s28
    v_lshrrev_b32 v42, 3, v1
    v_mul_u32_u24 v54, 1152, v42
    v_lshrrev_b32 v43, 4, v1
    v_lshlrev_b32 v43, 1, v43
    v_and_b32 v44, 7, v1
    v_xor_b32 v43, v43, v44
    v_lshl_add_u32 v54, v43, 4, v54

    v_mov_b32 v42, 0
    s_mov_b32 exec_lo, 0x00440000
    s_mov_b32 exec_hi, 0x00440000
    v_mov_b32 v42, 0x3f803f80
    s_mov_b64 exec, -1
    v_mov_b32 v104, v42
    v_mov_b32 v105, v42
    v_mov_b32 v106, v42
    v_mov_b32 v107, v42
    v_mov_b32 v108, v42
    v_mov_b32 v109, v42
    v_mov_b32 v110, v42
    v_mov_b32 v111, v42
    buffer_load_dwordx4 v[80:83], v2, s[4:7], s31 offen offset:0
    buffer_load_dword v96, v3, s[4:7], s32 offen offset:0
    s_mov_b64 exec, s[20:21]
    buffer_load_dwordx4 v[104:107], v4, s[4:7], s33 offen offset:0
    buffer_load_dwordx4 v[108:111], v4, s[4:7], s33 offen offset:576
    s_mov_b64 exec, -1
    v_mov_b32 v112, v42
    v_mov_b32 v113, v42
    v_mov_b32 v114, v42
    v_mov_b32 v115, v42
    v_mov_b32 v116, v42
    v_mov_b32 v117, v42
    v_mov_b32 v118, v42
    v_mov_b32 v119, v42
    v_mov_b32 v120, v42
    v_mov_b32 v121, v42
    v_mov_b32 v122, v42
    v_mov_b32 v123, v42
    v_mov_b32 v124, v42
    v_mov_b32 v125, v42
    v_mov_b32 v126, v42
    v_mov_b32 v127, v42
    v_mov_b32 v128, v42
    v_mov_b32 v129, v42
    v_mov_b32 v130, v42
    v_mov_b32 v131, v42
    v_mov_b32 v132, v42
    v_mov_b32 v133, v42
    v_mov_b32 v134, v42
    v_mov_b32 v135, v42
    s_lshr_b32 s38, s9, 1
    s_mul_i32 s38, s38, 48640
    s_and_b32 s28, s9, 1
    s_mul_i32 s28, s28, 1520
    s_add_u32 s38, s38, s28
    s_add_u32 s38, s38, 7143424
    v_lshlrev_b32 v19, 2, v0
    v_mov_b32 v8, s36
    v_cmp_gt_u32 vcc, 380, v0
    s_nop 1
    v_cndmask_b32 v19, v8, v19, vcc

    v_mov_b32 v97, 0x3f803f80
    v_mov_b32 v99, 0x3f803f80
    v_mov_b32 v101, 0x3f803f80
    v_mov_b32 v103, 0x3f803f80
    v_mov_b32 v24, 0
    v_mov_b32 v25, 0
L_k2_main:
    s_mov_b32 s13, s31
    s_mov_b32 s14, s32
    s_mov_b32 s15, s33
    s_waitcnt vmcnt(0)

    v_mfma_f32_32x32x16_bf16 v[136:151], v[80:83], v[56:59], 0
    v_mfma_f32_32x32x8_bf16 v[136:151], v[96:97], v[72:73], v[136:151]
    buffer_load_dwordx4 v[84:87], v2, s[4:7], s31 offen offset:1024
    buffer_load_dword v98, v3, s[4:7], s32 offen offset:128
    s_mov_b64 exec, s[20:21]
    buffer_load_dwordx4 v[112:115], v4, s[4:7], s33 offen offset:1152
    buffer_load_dwordx4 v[116:119], v4, s[4:7], s33 offen offset:1728
    s_mov_b64 exec, -1
    buffer_load_dwordx4 v[88:91], v2, s[4:7], s31 offen offset:2048
    buffer_load_dword v100, v3, s[4:7], s32 offen offset:256
    s_mov_b64 exec, s[20:21]
    buffer_load_dwordx4 v[120:123], v4, s[4:7], s33 offen offset:2304
    buffer_load_dwordx4 v[124:127], v4, s[4:7], s33 offen offset:2880
    s_mov_b64 exec, -1
    s_setprio 3
    v_exp_f32 v136, v136
    v_exp_f32 v137, v137
    buffer_load_dwordx4 v[92:95], v2, s[4:7], s13 offen offset:3072
    buffer_load_dword v102, v3, s[4:7], s14 offen offset:384
    s_mov_b64 exec, s[20:21]
    buffer_load_dwordx4 v[128:131], v4, s[4:7], s15 offen offset:3456
    buffer_load_dwordx4 v[132:135], v4, s[4:7], s15 offen offset:4032
    s_mov_b64 exec, -1
    v_exp_f32 v138, v138
    v_exp_f32 v139, v139
    v_cvt_pk_bf16_f32 v136, v136, v137
    v_cvt_pk_bf16_f32 v137, v138, v139
    v_mfma_f32_32x32x16_bf16 v[152:167], v[80:83], v[60:63], 0
    v_exp_f32 v140, v140
    v_exp_f32 v141, v141
    v_exp_f32 v142, v142
    v_exp_f32 v143, v143
    v_cvt_pk_bf16_f32 v138, v140, v141
    v_cvt_pk_bf16_f32 v139, v142, v143
    v_mfma_f32_32x32x8_bf16 v[152:167], v[96:97], v[74:75], v[152:167]
    v_exp_f32 v144, v144
    v_exp_f32 v145, v145
    v_exp_f32 v146, v146
    v_exp_f32 v147, v147
    v_cvt_pk_bf16_f32 v144, v144, v145
    v_cvt_pk_bf16_f32 v145, v146, v147
    v_mfma_f32_32x32x16_bf16 v[168:183], v[104:107], v[136:139], 0
    v_exp_f32 v148, v148
    v_exp_f32 v149, v149
    v_exp_f32 v150, v150
    v_exp_f32 v151, v151
    v_cvt_pk_bf16_f32 v146, v148, v149
    v_cvt_pk_bf16_f32 v147, v150, v151
    v_exp_f32 v152, v152
    v_exp_f32 v153, v153
    v_mfma_f32_32x32x16_bf16 v[168:183], v[108:111], v[144:147], v[168:183]
    v_exp_f32 v154, v154
    v_exp_f32 v155, v155
    v_cvt_pk_bf16_f32 v152, v152, v153
    v_cvt_pk_bf16_f32 v153, v154, v155
    v_mfma_f32_32x32x16_bf16 v[136:151], v[80:83], v[64:67], 0
    v_exp_f32 v156, v156
    v_exp_f32 v157, v157
    v_exp_f32 v158, v158
    v_exp_f32 v159, v159
    v_cvt_pk_bf16_f32 v154, v156, v157
    v_cvt_pk_bf16_f32 v155, v158, v159
    v_mfma_f32_32x32x8_bf16 v[136:151], v[96:97], v[76:77], v[136:151]
    v_exp_f32 v160, v160
    v_exp_f32 v161, v161
    v_exp_f32 v162, v162
    v_exp_f32 v163, v163
    v_cvt_pk_bf16_f32 v160, v160, v161
    v_cvt_pk_bf16_f32 v161, v162, v163
    v_mfma_f32_32x32x16_bf16 v[184:199], v[104:107], v[152:155], 0
    v_exp_f32 v164, v164
    v_exp_f32 v165, v165
    v_exp_f32 v166, v166
    v_exp_f32 v167, v167
    v_cvt_pk_bf16_f32 v162, v164, v165
    v_cvt_pk_bf16_f32 v163, v166, v167
    v_exp_f32 v136, v136
    v_exp_f32 v137, v137
    v_mfma_f32_32x32x16_bf16 v[184:199], v[108:111], v[160:163], v[184:199]
    v_exp_f32 v138, v138
    v_exp_f32 v139, v139
    v_cvt_pk_bf16_f32 v136, v136, v137
    v_cvt_pk_bf16_f32 v137, v138, v139
    v_mfma_f32_32x32x16_bf16 v[152:167], v[80:83], v[68:71], 0
    v_exp_f32 v140, v140
    v_exp_f32 v141, v141
    v_exp_f32 v142, v142
    v_exp_f32 v143, v143
    v_cvt_pk_bf16_f32 v138, v140, v141
    v_cvt_pk_bf16_f32 v139, v142, v143
    v_mfma_f32_32x32x8_bf16 v[152:167], v[96:97], v[78:79], v[152:167]
    v_exp_f32 v144, v144
    v_exp_f32 v145, v145
    v_exp_f32 v146, v146
    v_exp_f32 v147, v147
    v_cvt_pk_bf16_f32 v144, v144, v145
    v_cvt_pk_bf16_f32 v145, v146, v147
    v_mfma_f32_32x32x16_bf16 v[200:215], v[104:107], v[136:139], 0
    v_exp_f32 v148, v148
    v_exp_f32 v149, v149
    v_exp_f32 v150, v150
    v_exp_f32 v151, v151
    v_cvt_pk_bf16_f32 v146, v148, v149
    v_cvt_pk_bf16_f32 v147, v150, v151
    v_exp_f32 v152, v152
    v_exp_f32 v153, v153
    v_mfma_f32_32x32x16_bf16 v[200:215], v[108:111], v[144:147], v[200:215]
    v_exp_f32 v154, v154
    v_exp_f32 v155, v155
    v_cvt_pk_bf16_f32 v152, v152, v153
    v_cvt_pk_bf16_f32 v153, v154, v155
    s_waitcnt vmcnt(8)
    v_mfma_f32_32x32x16_bf16 v[136:151], v[84:87], v[56:59], 0
    v_exp_f32 v156, v156
    v_exp_f32 v157, v157
    v_exp_f32 v158, v158
    v_exp_f32 v159, v159
    v_cvt_pk_bf16_f32 v154, v156, v157
    v_cvt_pk_bf16_f32 v155, v158, v159
    v_mfma_f32_32x32x8_bf16 v[136:151], v[98:99], v[72:73], v[136:151]
    v_exp_f32 v160, v160
    v_exp_f32 v161, v161
    v_exp_f32 v162, v162
    v_exp_f32 v163, v163
    v_cvt_pk_bf16_f32 v160, v160, v161
    v_cvt_pk_bf16_f32 v161, v162, v163
    v_mfma_f32_32x32x16_bf16 v[216:231], v[104:107], v[152:155], 0
    v_exp_f32 v164, v164
    v_exp_f32 v165, v165
    v_exp_f32 v166, v166
    v_exp_f32 v167, v167
    v_cvt_pk_bf16_f32 v162, v164, v165
    v_cvt_pk_bf16_f32 v163, v166, v167
    v_exp_f32 v136, v136
    v_exp_f32 v137, v137
    v_mfma_f32_32x32x16_bf16 v[216:231], v[108:111], v[160:163], v[216:231]
    s_add_u32 s13, s13, 4096
    s_add_u32 s14, s14, 512
    s_add_u32 s15, s15, 4608
    buffer_load_dwordx4 v[80:83], v2, s[4:7], s13 offen offset:0
    buffer_load_dword v96, v3, s[4:7], s14 offen offset:0
    s_mov_b64 exec, s[20:21]
    buffer_load_dwordx4 v[104:107], v4, s[4:7], s15 offen offset:0
    buffer_load_dwordx4 v[108:111], v4, s[4:7], s15 offen offset:576
    s_mov_b64 exec, -1
    v_exp_f32 v138, v138
    v_exp_f32 v139, v139
    v_cvt_pk_bf16_f32 v136, v136, v137
    v_cvt_pk_bf16_f32 v137, v138, v139
    v_mfma_f32_32x32x16_bf16 v[152:167], v[84:87], v[60:63], 0
    v_exp_f32 v140, v140
    v_exp_f32 v141, v141
    v_exp_f32 v142, v142
    v_exp_f32 v143, v143
    v_cvt_pk_bf16_f32 v138, v140, v141
    v_cvt_pk_bf16_f32 v139, v142, v143
    v_mfma_f32_32x32x8_bf16 v[152:167], v[98:99], v[74:75], v[152:167]
    v_exp_f32 v144, v144
    v_exp_f32 v145, v145
    v_exp_f32 v146, v146
    v_exp_f32 v147, v147
    v_cvt_pk_bf16_f32 v144, v144, v145
    v_cvt_pk_bf16_f32 v145, v146, v147
    v_mfma_f32_32x32x16_bf16 v[168:183], v[112:115], v[136:139], v[168:183]
    v_exp_f32 v148, v148
    v_exp_f32 v149, v149
    v_exp_f32 v150, v150
    v_exp_f32 v151, v151
    v_cvt_pk_bf16_f32 v146, v148, v149
    v_cvt_pk_bf16_f32 v147, v150, v151
    v_exp_f32 v152, v152
    v_exp_f32 v153, v153
    v_mfma_f32_32x32x16_bf16 v[168:183], v[116:119], v[144:147], v[168:183]
    s_mov_b32 s82, 663552
    s_mov_b32 s83, 0x00020000
    s_mov_b32 s86, 663552
    s_mov_b32 s87, 0x00020000
    s_lshr_b32 s27, s2, 3
    s_lshl_b32 s27, s27, 3
    s_add_u32 s27, s27, s8
    s_mul_i32 s27, s27, 2688
    v_lshlrev_b32 v42, 7, v1

    s_mov_b32 exec_lo, 0x001fffff
    s_mov_b32 exec_hi, 0x00000000
    buffer_load_dword v46, v42, s[80:83], s27 offen
    buffer_load_dword v47, v42, s[84:87], s27 offen
    s_mov_b64 exec, -1
    v_exp_f32 v154, v154
    v_exp_f32 v155, v155
    v_cvt_pk_bf16_f32 v152, v152, v153
    v_cvt_pk_bf16_f32 v153, v154, v155
    v_mfma_f32_32x32x16_bf16 v[136:151], v[84:87], v[64:67], 0
    v_exp_f32 v156, v156
    v_exp_f32 v157, v157
    v_exp_f32 v158, v158
    v_exp_f32 v159, v159
    v_cvt_pk_bf16_f32 v154, v156, v157
    v_cvt_pk_bf16_f32 v155, v158, v159
    v_mfma_f32_32x32x8_bf16 v[136:151], v[98:99], v[76:77], v[136:151]
    v_exp_f32 v160, v160
    v_exp_f32 v161, v161
    v_exp_f32 v162, v162
    v_exp_f32 v163, v163
    v_cvt_pk_bf16_f32 v160, v160, v161
    v_cvt_pk_bf16_f32 v161, v162, v163
    v_mfma_f32_32x32x16_bf16 v[184:199], v[112:115], v[152:155], v[184:199]
    v_exp_f32 v164, v164
    v_exp_f32 v165, v165
    v_exp_f32 v166, v166
    v_exp_f32 v167, v167
    v_cvt_pk_bf16_f32 v162, v164, v165
    v_cvt_pk_bf16_f32 v163, v166, v167
    v_exp_f32 v136, v136
    v_exp_f32 v137, v137
    v_mfma_f32_32x32x16_bf16 v[184:199], v[116:119], v[160:163], v[184:199]
    v_exp_f32 v138, v138
    v_exp_f32 v139, v139
    v_cvt_pk_bf16_f32 v136, v136, v137
    v_cvt_pk_bf16_f32 v137, v138, v139
    v_mfma_f32_32x32x16_bf16 v[152:167], v[84:87], v[68:71], 0
    v_exp_f32 v140, v140
    v_exp_f32 v141, v141
    v_exp_f32 v142, v142
    v_exp_f32 v143, v143
    v_cvt_pk_bf16_f32 v138, v140, v141
    v_cvt_pk_bf16_f32 v139, v142, v143
    v_mfma_f32_32x32x8_bf16 v[152:167], v[98:99], v[78:79], v[152:167]
    v_exp_f32 v144, v144
    v_exp_f32 v145, v145
    v_exp_f32 v146, v146
    v_exp_f32 v147, v147
    v_cvt_pk_bf16_f32 v144, v144, v145
    v_cvt_pk_bf16_f32 v145, v146, v147
    v_mfma_f32_32x32x16_bf16 v[200:215], v[112:115], v[136:139], v[200:215]
    v_exp_f32 v148, v148
    v_exp_f32 v149, v149
    v_exp_f32 v150, v150
    v_exp_f32 v151, v151
    v_cvt_pk_bf16_f32 v146, v148, v149
    v_cvt_pk_bf16_f32 v147, v150, v151
    v_exp_f32 v152, v152
    v_exp_f32 v153, v153
    v_mfma_f32_32x32x16_bf16 v[200:215], v[116:119], v[144:147], v[200:215]
    v_exp_f32 v154, v154
    v_exp_f32 v155, v155
    v_cvt_pk_bf16_f32 v152, v152, v153
    v_cvt_pk_bf16_f32 v153, v154, v155
    s_waitcnt vmcnt(10)
    v_mfma_f32_32x32x16_bf16 v[136:151], v[88:91], v[56:59], 0
    v_exp_f32 v156, v156
    v_exp_f32 v157, v157
    v_exp_f32 v158, v158
    v_exp_f32 v159, v159
    v_cvt_pk_bf16_f32 v154, v156, v157
    v_cvt_pk_bf16_f32 v155, v158, v159
    v_mfma_f32_32x32x8_bf16 v[136:151], v[100:101], v[72:73], v[136:151]
    v_exp_f32 v160, v160
    v_exp_f32 v161, v161
    v_exp_f32 v162, v162
    v_exp_f32 v163, v163
    v_cvt_pk_bf16_f32 v160, v160, v161
    v_cvt_pk_bf16_f32 v161, v162, v163
    v_mfma_f32_32x32x16_bf16 v[216:231], v[112:115], v[152:155], v[216:231]
    v_exp_f32 v164, v164
    v_exp_f32 v165, v165
    v_exp_f32 v166, v166
    v_exp_f32 v167, v167
    v_cvt_pk_bf16_f32 v162, v164, v165
    v_cvt_pk_bf16_f32 v163, v166, v167
    v_exp_f32 v136, v136
    v_exp_f32 v137, v137
    v_mfma_f32_32x32x16_bf16 v[216:231], v[116:119], v[160:163], v[216:231]
    buffer_load_dwordx4 v[84:87], v2, s[4:7], s13 offen offset:1024
    buffer_load_dword v98, v3, s[4:7], s14 offen offset:128
    s_mov_b64 exec, s[20:21]
    buffer_load_dwordx4 v[112:115], v4, s[4:7], s15 offen offset:1152
    buffer_load_dwordx4 v[116:119], v4, s[4:7], s15 offen offset:1728
    s_mov_b64 exec, -1
    v_exp_f32 v138, v138
    v_exp_f32 v139, v139
    v_cvt_pk_bf16_f32 v136, v136, v137
    v_cvt_pk_bf16_f32 v137, v138, v139
    v_mfma_f32_32x32x16_bf16 v[152:167], v[88:91], v[60:63], 0
    v_exp_f32 v140, v140
    v_exp_f32 v141, v141
    v_exp_f32 v142, v142
    v_exp_f32 v143, v143
    v_cvt_pk_bf16_f32 v138, v140, v141
    v_cvt_pk_bf16_f32 v139, v142, v143
    v_mfma_f32_32x32x8_bf16 v[152:167], v[100:101], v[74:75], v[152:167]
    v_exp_f32 v144, v144
    v_exp_f32 v145, v145
    v_exp_f32 v146, v146
    v_exp_f32 v147, v147
    v_cvt_pk_bf16_f32 v144, v144, v145
    v_cvt_pk_bf16_f32 v145, v146, v147
    v_mfma_f32_32x32x16_bf16 v[168:183], v[120:123], v[136:139], v[168:183]
    v_exp_f32 v148, v148
    v_exp_f32 v149, v149
    v_exp_f32 v150, v150
    v_exp_f32 v151, v151
    v_cvt_pk_bf16_f32 v146, v148, v149
    v_cvt_pk_bf16_f32 v147, v150, v151
    v_exp_f32 v152, v152
    v_exp_f32 v153, v153
    v_mfma_f32_32x32x16_bf16 v[168:183], v[124:127], v[144:147], v[168:183]
    v_exp_f32 v154, v154
    v_exp_f32 v155, v155
    v_cvt_pk_bf16_f32 v152, v152, v153
    v_cvt_pk_bf16_f32 v153, v154, v155
    v_mfma_f32_32x32x16_bf16 v[136:151], v[88:91], v[64:67], 0
    v_exp_f32 v156, v156
    v_exp_f32 v157, v157
    v_exp_f32 v158, v158
    v_exp_f32 v159, v159
    v_cvt_pk_bf16_f32 v154, v156, v157
    v_cvt_pk_bf16_f32 v155, v158, v159
    v_mfma_f32_32x32x8_bf16 v[136:151], v[100:101], v[76:77], v[136:151]
    v_exp_f32 v160, v160
    v_exp_f32 v161, v161
    v_exp_f32 v162, v162
    v_exp_f32 v163, v163
    v_cvt_pk_bf16_f32 v160, v160, v161
    v_cvt_pk_bf16_f32 v161, v162, v163
    v_mfma_f32_32x32x16_bf16 v[184:199], v[120:123], v[152:155], v[184:199]
    v_exp_f32 v164, v164
    v_exp_f32 v165, v165
    v_exp_f32 v166, v166
    v_exp_f32 v167, v167
    v_cvt_pk_bf16_f32 v162, v164, v165
    v_cvt_pk_bf16_f32 v163, v166, v167
    v_exp_f32 v136, v136
    v_exp_f32 v137, v137
    v_mfma_f32_32x32x16_bf16 v[184:199], v[124:127], v[160:163], v[184:199]
    v_exp_f32 v138, v138
    v_exp_f32 v139, v139
    v_cvt_pk_bf16_f32 v136, v136, v137
    v_cvt_pk_bf16_f32 v137, v138, v139
    v_mfma_f32_32x32x16_bf16 v[152:167], v[88:91], v[68:71], 0
    v_exp_f32 v140, v140
    v_exp_f32 v141, v141
    v_exp_f32 v142, v142
    v_exp_f32 v143, v143
    v_cvt_pk_bf16_f32 v138, v140, v141
    v_cvt_pk_bf16_f32 v139, v142, v143
    v_mfma_f32_32x32x8_bf16 v[152:167], v[100:101], v[78:79], v[152:167]
    v_exp_f32 v144, v144
    v_exp_f32 v145, v145
    v_exp_f32 v146, v146
    v_exp_f32 v147, v147
    v_cvt_pk_bf16_f32 v144, v144, v145
    v_cvt_pk_bf16_f32 v145, v146, v147
    v_mfma_f32_32x32x16_bf16 v[200:215], v[120:123], v[136:139], v[200:215]
    v_exp_f32 v148, v148
    v_exp_f32 v149, v149
    v_exp_f32 v150, v150
    v_exp_f32 v151, v151
    v_cvt_pk_bf16_f32 v146, v148, v149
    v_cvt_pk_bf16_f32 v147, v150, v151
    v_exp_f32 v152, v152
    v_exp_f32 v153, v153
    v_mfma_f32_32x32x16_bf16 v[200:215], v[124:127], v[144:147], v[200:215]
    v_exp_f32 v154, v154
    v_exp_f32 v155, v155
    v_cvt_pk_bf16_f32 v152, v152, v153
    v_cvt_pk_bf16_f32 v153, v154, v155
    s_waitcnt vmcnt(10)
    v_mfma_f32_32x32x16_bf16 v[136:151], v[92:95], v[56:59], 0
    v_exp_f32 v156, v156
    v_exp_f32 v157, v157
    v_exp_f32 v158, v158
    v_exp_f32 v159, v159
    v_cvt_pk_bf16_f32 v154, v156, v157
    v_cvt_pk_bf16_f32 v155, v158, v159
    v_mfma_f32_32x32x8_bf16 v[136:151], v[102:103], v[72:73], v[136:151]
    v_exp_f32 v160, v160
    v_exp_f32 v161, v161
    v_exp_f32 v162, v162
    v_exp_f32 v163, v163
    v_cvt_pk_bf16_f32 v160, v160, v161
    v_cvt_pk_bf16_f32 v161, v162, v163
    v_mfma_f32_32x32x16_bf16 v[216:231], v[120:123], v[152:155], v[216:231]
    v_exp_f32 v164, v164
    v_exp_f32 v165, v165
    v_exp_f32 v166, v166
    v_exp_f32 v167, v167
    v_cvt_pk_bf16_f32 v162, v164, v165
    v_cvt_pk_bf16_f32 v163, v166, v167
    v_exp_f32 v136, v136
    v_exp_f32 v137, v137
    v_mfma_f32_32x32x16_bf16 v[216:231], v[124:127], v[160:163], v[216:231]
    buffer_load_dwordx4 v[88:91], v2, s[4:7], s13 offen offset:2048
    buffer_load_dword v100, v3, s[4:7], s14 offen offset:256
    s_mov_b64 exec, s[20:21]
    buffer_load_dwordx4 v[120:123], v4, s[4:7], s15 offen offset:2304
    buffer_load_dwordx4 v[124:127], v4, s[4:7], s15 offen offset:2880
    s_mov_b64 exec, -1
    v_exp_f32 v138, v138
    v_exp_f32 v139, v139
    v_cvt_pk_bf16_f32 v136, v136, v137
    v_cvt_pk_bf16_f32 v137, v138, v139
    v_mfma_f32_32x32x16_bf16 v[152:167], v[92:95], v[60:63], 0
    v_exp_f32 v140, v140
    v_exp_f32 v141, v141
    v_exp_f32 v142, v142
    v_exp_f32 v143, v143
    v_cvt_pk_bf16_f32 v138, v140, v141
    v_cvt_pk_bf16_f32 v139, v142, v143
    v_mfma_f32_32x32x8_bf16 v[152:167], v[102:103], v[74:75], v[152:167]
    v_exp_f32 v144, v144
    v_exp_f32 v145, v145
    v_exp_f32 v146, v146
    v_exp_f32 v147, v147
    v_cvt_pk_bf16_f32 v144, v144, v145
    v_cvt_pk_bf16_f32 v145, v146, v147
    v_mfma_f32_32x32x16_bf16 v[168:183], v[128:131], v[136:139], v[168:183]
    v_exp_f32 v148, v148
    v_exp_f32 v149, v149
    v_exp_f32 v150, v150
    v_exp_f32 v151, v151
    v_cvt_pk_bf16_f32 v146, v148, v149
    v_cvt_pk_bf16_f32 v147, v150, v151
    v_exp_f32 v152, v152
    v_exp_f32 v153, v153
    v_mfma_f32_32x32x16_bf16 v[168:183], v[132:135], v[144:147], v[168:183]
    v_exp_f32 v154, v154
    v_exp_f32 v155, v155
    v_cvt_pk_bf16_f32 v152, v152, v153
    v_cvt_pk_bf16_f32 v153, v154, v155
    v_mfma_f32_32x32x16_bf16 v[136:151], v[92:95], v[64:67], 0
    v_exp_f32 v156, v156
    v_exp_f32 v157, v157
    v_exp_f32 v158, v158
    v_exp_f32 v159, v159
    v_cvt_pk_bf16_f32 v154, v156, v157
    v_cvt_pk_bf16_f32 v155, v158, v159
    v_mfma_f32_32x32x8_bf16 v[136:151], v[102:103], v[76:77], v[136:151]
    v_exp_f32 v160, v160
    v_exp_f32 v161, v161
    v_exp_f32 v162, v162
    v_exp_f32 v163, v163
    v_cvt_pk_bf16_f32 v160, v160, v161
    v_cvt_pk_bf16_f32 v161, v162, v163
    v_mfma_f32_32x32x16_bf16 v[184:199], v[128:131], v[152:155], v[184:199]
    v_exp_f32 v164, v164
    v_exp_f32 v165, v165
    v_exp_f32 v166, v166
    v_exp_f32 v167, v167
    v_cvt_pk_bf16_f32 v162, v164, v165
    v_cvt_pk_bf16_f32 v163, v166, v167
    v_exp_f32 v136, v136
    v_exp_f32 v137, v137
    v_mfma_f32_32x32x16_bf16 v[184:199], v[132:135], v[160:163], v[184:199]
    v_exp_f32 v138, v138
    v_exp_f32 v139, v139
    v_cvt_pk_bf16_f32 v136, v136, v137
    v_cvt_pk_bf16_f32 v137, v138, v139
    v_mfma_f32_32x32x16_bf16 v[152:167], v[92:95], v[68:71], 0
    v_exp_f32 v140, v140
    v_exp_f32 v141, v141
    v_exp_f32 v142, v142
    v_exp_f32 v143, v143
    v_cvt_pk_bf16_f32 v138, v140, v141
    v_cvt_pk_bf16_f32 v139, v142, v143
    v_mfma_f32_32x32x8_bf16 v[152:167], v[102:103], v[78:79], v[152:167]
    v_exp_f32 v144, v144
    v_exp_f32 v145, v145
    v_exp_f32 v146, v146
    v_exp_f32 v147, v147
    v_cvt_pk_bf16_f32 v144, v144, v145
    v_cvt_pk_bf16_f32 v145, v146, v147
    v_mfma_f32_32x32x16_bf16 v[200:215], v[128:131], v[136:139], v[200:215]
    v_exp_f32 v148, v148
    v_exp_f32 v149, v149
    v_exp_f32 v150, v150
    v_exp_f32 v151, v151
    v_cvt_pk_bf16_f32 v146, v148, v149
    v_cvt_pk_bf16_f32 v147, v150, v151
    v_exp_f32 v152, v152
    v_exp_f32 v153, v153
    v_mfma_f32_32x32x16_bf16 v[200:215], v[132:135], v[144:147], v[200:215]
    v_exp_f32 v154, v154
    v_exp_f32 v155, v155
    v_cvt_pk_bf16_f32 v152, v152, v153
    v_cvt_pk_bf16_f32 v153, v154, v155
    s_waitcnt vmcnt(10)
    v_mfma_f32_32x32x16_bf16 v[136:151], v[80:83], v[56:59], 0
    v_exp_f32 v156, v156
    v_exp_f32 v157, v157
    v_exp_f32 v158, v158
    v_exp_f32 v159, v159
    v_cvt_pk_bf16_f32 v154, v156, v157
    v_cvt_pk_bf16_f32 v155, v158, v159
    v_mfma_f32_32x32x8_bf16 v[136:151], v[96:97], v[72:73], v[136:151]
    v_exp_f32 v160, v160
    v_exp_f32 v161, v161
    v_exp_f32 v162, v162
    v_exp_f32 v163, v163
    v_cvt_pk_bf16_f32 v160, v160, v161
    v_cvt_pk_bf16_f32 v161, v162, v163
    v_mfma_f32_32x32x16_bf16 v[216:231], v[128:131], v[152:155], v[216:231]
    v_exp_f32 v164, v164
    v_exp_f32 v165, v165
    v_exp_f32 v166, v166
    v_exp_f32 v167, v167
    v_cvt_pk_bf16_f32 v162, v164, v165
    v_cvt_pk_bf16_f32 v163, v166, v167
    v_exp_f32 v136, v136
    v_exp_f32 v137, v137
    v_mfma_f32_32x32x16_bf16 v[216:231], v[132:135], v[160:163], v[216:231]
    buffer_load_dwordx4 v[92:95], v2, s[4:7], s13 offen offset:3072
    buffer_load_dword v102, v3, s[4:7], s14 offen offset:384
    s_mov_b64 exec, s[20:21]
    buffer_load_dwordx4 v[128:131], v4, s[4:7], s15 offen offset:3456
    buffer_load_dwordx4 v[132:135], v4, s[4:7], s15 offen offset:4032
    s_mov_b64 exec, -1
    v_exp_f32 v138, v138
    v_exp_f32 v139, v139
    v_cvt_pk_bf16_f32 v136, v136, v137
    v_cvt_pk_bf16_f32 v137, v138, v139
    v_mfma_f32_32x32x16_bf16 v[152:167], v[80:83], v[60:63], 0
    v_exp_f32 v140, v140
    v_exp_f32 v141, v141
    v_exp_f32 v142, v142
    v_exp_f32 v143, v143
    v_cvt_pk_bf16_f32 v138, v140, v141
    v_cvt_pk_bf16_f32 v139, v142, v143
    v_mfma_f32_32x32x8_bf16 v[152:167], v[96:97], v[74:75], v[152:167]
    v_exp_f32 v144, v144
    v_exp_f32 v145, v145
    v_exp_f32 v146, v146
    v_exp_f32 v147, v147
    v_cvt_pk_bf16_f32 v144, v144, v145
    v_cvt_pk_bf16_f32 v145, v146, v147
    v_mfma_f32_32x32x16_bf16 v[168:183], v[104:107], v[136:139], v[168:183]
    v_exp_f32 v148, v148
    v_exp_f32 v149, v149
    v_exp_f32 v150, v150
    v_exp_f32 v151, v151
    v_cvt_pk_bf16_f32 v146, v148, v149
    v_cvt_pk_bf16_f32 v147, v150, v151
    v_exp_f32 v152, v152
    v_exp_f32 v153, v153
    v_mfma_f32_32x32x16_bf16 v[168:183], v[108:111], v[144:147], v[168:183]
    buffer_load_dwordx4 v[14:17], v2, s[4:7], s16 offen
    buffer_load_dword v18, v3, s[4:7], s17 offen
    buffer_load_dword v12, v3, s[4:7], s18 offen
    s_mov_b32 s27, s38

    buffer_load_dword v26, v19, s[4:7], s27 offen
    s_add_u32 s27, s27, 3040
    buffer_load_dword v27, v19, s[4:7], s27 offen
    s_add_u32 s27, s27, 3040
    buffer_load_dword v28, v19, s[4:7], s27 offen
    s_add_u32 s27, s27, 3040
    buffer_load_dword v29, v19, s[4:7], s27 offen
    s_add_u32 s27, s27, 3040
    buffer_load_dword v30, v19, s[4:7], s27 offen
    s_add_u32 s27, s27, 3040
    buffer_load_dword v31, v19, s[4:7], s27 offen
    s_add_u32 s27, s27, 3040
    buffer_load_dword v32, v19, s[4:7], s27 offen
    s_add_u32 s27, s27, 3040
    buffer_load_dword v33, v19, s[4:7], s27 offen
    s_add_u32 s27, s27, 3040
    buffer_load_dword v34, v19, s[4:7], s27 offen
    s_add_u32 s27, s27, 3040
    buffer_load_dword v35, v19, s[4:7], s27 offen
    s_add_u32 s27, s27, 3040
    buffer_load_dword v36, v19, s[4:7], s27 offen
    s_add_u32 s27, s27, 3040
    buffer_load_dword v37, v19, s[4:7], s27 offen
    s_add_u32 s27, s27, 3040
    buffer_load_dword v38, v19, s[4:7], s27 offen
    s_add_u32 s27, s27, 3040
    buffer_load_dword v39, v19, s[4:7], s27 offen
    s_add_u32 s27, s27, 3040
    buffer_load_dword v40, v19, s[4:7], s27 offen
    s_add_u32 s27, s27, 3040
    buffer_load_dword v41, v19, s[4:7], s27 offen
    v_exp_f32 v154, v154
    v_exp_f32 v155, v155
    v_cvt_pk_bf16_f32 v152, v152, v153
    v_cvt_pk_bf16_f32 v153, v154, v155
    v_mfma_f32_32x32x16_bf16 v[136:151], v[80:83], v[64:67], 0
    v_exp_f32 v156, v156
    v_exp_f32 v157, v157
    v_exp_f32 v158, v158
    v_exp_f32 v159, v159
    v_cvt_pk_bf16_f32 v154, v156, v157
    v_cvt_pk_bf16_f32 v155, v158, v159
    v_mfma_f32_32x32x8_bf16 v[136:151], v[96:97], v[76:77], v[136:151]
    v_exp_f32 v160, v160
    v_exp_f32 v161, v161
    v_exp_f32 v162, v162
    v_exp_f32 v163, v163
    v_cvt_pk_bf16_f32 v160, v160, v161
    v_cvt_pk_bf16_f32 v161, v162, v163
    v_mfma_f32_32x32x16_bf16 v[184:199], v[104:107], v[152:155], v[184:199]
    v_exp_f32 v164, v164
    v_exp_f32 v165, v165
    v_exp_f32 v166, v166
    v_exp_f32 v167, v167
    v_cvt_pk_bf16_f32 v162, v164, v165
    v_cvt_pk_bf16_f32 v163, v166, v167
    v_exp_f32 v136, v136
    v_exp_f32 v137, v137
    v_mfma_f32_32x32x16_bf16 v[184:199], v[108:111], v[160:163], v[184:199]
    v_exp_f32 v138, v138
    v_exp_f32 v139, v139
    v_cvt_pk_bf16_f32 v136, v136, v137
    v_cvt_pk_bf16_f32 v137, v138, v139
    v_mfma_f32_32x32x16_bf16 v[152:167], v[80:83], v[68:71], 0
    v_exp_f32 v140, v140
    v_exp_f32 v141, v141
    v_exp_f32 v142, v142
    v_exp_f32 v143, v143
    v_cvt_pk_bf16_f32 v138, v140, v141
    v_cvt_pk_bf16_f32 v139, v142, v143
    v_mfma_f32_32x32x8_bf16 v[152:167], v[96:97], v[78:79], v[152:167]
    v_exp_f32 v144, v144
    v_exp_f32 v145, v145
    v_exp_f32 v146, v146
    v_exp_f32 v147, v147
    v_cvt_pk_bf16_f32 v144, v144, v145
    v_cvt_pk_bf16_f32 v145, v146, v147
    v_mfma_f32_32x32x16_bf16 v[200:215], v[104:107], v[136:139], v[200:215]
    v_exp_f32 v148, v148
    v_exp_f32 v149, v149
    v_exp_f32 v150, v150
    v_exp_f32 v151, v151
    v_cvt_pk_bf16_f32 v146, v148, v149
    v_cvt_pk_bf16_f32 v147, v150, v151
    v_exp_f32 v152, v152
    v_exp_f32 v153, v153
    v_mfma_f32_32x32x16_bf16 v[200:215], v[108:111], v[144:147], v[200:215]
    v_exp_f32 v154, v154
    v_exp_f32 v155, v155
    v_cvt_pk_bf16_f32 v152, v152, v153
    v_cvt_pk_bf16_f32 v153, v154, v155
    s_waitcnt vmcnt(27)
    v_mfma_f32_32x32x16_bf16 v[136:151], v[84:87], v[56:59], 0
    v_exp_f32 v156, v156
    v_exp_f32 v157, v157
    v_exp_f32 v158, v158
    v_exp_f32 v159, v159
    v_cvt_pk_bf16_f32 v154, v156, v157
    v_cvt_pk_bf16_f32 v155, v158, v159
    v_mfma_f32_32x32x8_bf16 v[136:151], v[98:99], v[72:73], v[136:151]
    v_exp_f32 v160, v160
    v_exp_f32 v161, v161
    v_exp_f32 v162, v162
    v_exp_f32 v163, v163
    v_cvt_pk_bf16_f32 v160, v160, v161
    v_cvt_pk_bf16_f32 v161, v162, v163
    v_mfma_f32_32x32x16_bf16 v[216:231], v[104:107], v[152:155], v[216:231]
    v_exp_f32 v164, v164
    v_exp_f32 v165, v165
    v_exp_f32 v166, v166
    v_exp_f32 v167, v167
    v_cvt_pk_bf16_f32 v162, v164, v165
    v_cvt_pk_bf16_f32 v163, v166, v167
    v_exp_f32 v136, v136
    v_exp_f32 v137, v137
    v_mfma_f32_32x32x16_bf16 v[216:231], v[108:111], v[160:163], v[216:231]
    s_add_u32 s13, s13, 4096
    s_add_u32 s14, s14, 512
    s_add_u32 s15, s15, 4608
    buffer_load_dwordx4 v[80:83], v2, s[4:7], s13 offen offset:0
    buffer_load_dword v96, v3, s[4:7], s14 offen offset:0
    s_mov_b64 exec, s[20:21]
    buffer_load_dwordx4 v[104:107], v4, s[4:7], s15 offen offset:0
    buffer_load_dwordx4 v[108:111], v4, s[4:7], s15 offen offset:576
    s_mov_b64 exec, -1
    v_exp_f32 v138, v138
    v_exp_f32 v139, v139
    v_cvt_pk_bf16_f32 v136, v136, v137
    v_cvt_pk_bf16_f32 v137, v138, v139
    v_mfma_f32_32x32x16_bf16 v[152:167], v[84:87], v[60:63], 0
    v_exp_f32 v140, v140
    v_exp_f32 v141, v141
    v_exp_f32 v142, v142
    v_exp_f32 v143, v143
    v_cvt_pk_bf16_f32 v138, v140, v141
    v_cvt_pk_bf16_f32 v139, v142, v143
    v_mfma_f32_32x32x8_bf16 v[152:167], v[98:99], v[74:75], v[152:167]
    v_exp_f32 v144, v144
    v_exp_f32 v145, v145
    v_exp_f32 v146, v146
    v_exp_f32 v147, v147
    v_cvt_pk_bf16_f32 v144, v144, v145
    v_cvt_pk_bf16_f32 v145, v146, v147
    v_mfma_f32_32x32x16_bf16 v[168:183], v[112:115], v[136:139], v[168:183]
    v_exp_f32 v148, v148
    v_exp_f32 v149, v149
    v_exp_f32 v150, v150
    v_exp_f32 v151, v151
    v_cvt_pk_bf16_f32 v146, v148, v149
    v_cvt_pk_bf16_f32 v147, v150, v151
    v_exp_f32 v152, v152
    v_exp_f32 v153, v153
    v_mfma_f32_32x32x16_bf16 v[168:183], v[116:119], v[144:147], v[168:183]
    v_exp_f32 v154, v154
    v_exp_f32 v155, v155
    v_cvt_pk_bf16_f32 v152, v152, v153
    v_cvt_pk_bf16_f32 v153, v154, v155
    v_mfma_f32_32x32x16_bf16 v[136:151], v[84:87], v[64:67], 0
    v_exp_f32 v156, v156
    v_exp_f32 v157, v157
    v_exp_f32 v158, v158
    v_exp_f32 v159, v159
    v_cvt_pk_bf16_f32 v154, v156, v157
    v_cvt_pk_bf16_f32 v155, v158, v159
    v_mfma_f32_32x32x8_bf16 v[136:151], v[98:99], v[76:77], v[136:151]
    v_exp_f32 v160, v160
    v_exp_f32 v161, v161
    v_exp_f32 v162, v162
    v_exp_f32 v163, v163
    v_cvt_pk_bf16_f32 v160, v160, v161
    v_cvt_pk_bf16_f32 v161, v162, v163
    v_mfma_f32_32x32x16_bf16 v[184:199], v[112:115], v[152:155], v[184:199]
    v_exp_f32 v164, v164
    v_exp_f32 v165, v165
    v_exp_f32 v166, v166
    v_exp_f32 v167, v167
    v_cvt_pk_bf16_f32 v162, v164, v165
    v_cvt_pk_bf16_f32 v163, v166, v167
    v_exp_f32 v136, v136
    v_exp_f32 v137, v137
    v_mfma_f32_32x32x16_bf16 v[184:199], v[116:119], v[160:163], v[184:199]
    v_exp_f32 v138, v138
    v_exp_f32 v139, v139
    v_cvt_pk_bf16_f32 v136, v136, v137
    v_cvt_pk_bf16_f32 v137, v138, v139
    v_mfma_f32_32x32x16_bf16 v[152:167], v[84:87], v[68:71], 0
    v_exp_f32 v140, v140
    v_exp_f32 v141, v141
    v_exp_f32 v142, v142
    v_exp_f32 v143, v143
    v_cvt_pk_bf16_f32 v138, v140, v141
    v_cvt_pk_bf16_f32 v139, v142, v143
    v_mfma_f32_32x32x8_bf16 v[152:167], v[98:99], v[78:79], v[152:167]
    v_exp_f32 v144, v144
    v_exp_f32 v145, v145
    v_exp_f32 v146, v146
    v_exp_f32 v147, v147
    v_cvt_pk_bf16_f32 v144, v144, v145
    v_cvt_pk_bf16_f32 v145, v146, v147
    v_mfma_f32_32x32x16_bf16 v[200:215], v[112:115], v[136:139], v[200:215]
    v_exp_f32 v148, v148
    v_exp_f32 v149, v149
    v_exp_f32 v150, v150
    v_exp_f32 v151, v151
    v_cvt_pk_bf16_f32 v146, v148, v149
    v_cvt_pk_bf16_f32 v147, v150, v151
    v_exp_f32 v152, v152
    v_exp_f32 v153, v153
    v_mfma_f32_32x32x16_bf16 v[200:215], v[116:119], v[144:147], v[200:215]
    v_exp_f32 v154, v154
    v_exp_f32 v155, v155
    v_cvt_pk_bf16_f32 v152, v152, v153
    v_cvt_pk_bf16_f32 v153, v154, v155
    s_waitcnt vmcnt(27)
    v_mfma_f32_32x32x16_bf16 v[136:151], v[88:91], v[56:59], 0
    v_exp_f32 v156, v156
    v_exp_f32 v157, v157
    v_exp_f32 v158, v158
    v_exp_f32 v159, v159
    v_cvt_pk_bf16_f32 v154, v156, v157
    v_cvt_pk_bf16_f32 v155, v158, v159
    v_mfma_f32_32x32x8_bf16 v[136:151], v[100:101], v[72:73], v[136:151]
    v_exp_f32 v160, v160
    v_exp_f32 v161, v161
    v_exp_f32 v162, v162
    v_exp_f32 v163, v163
    v_cvt_pk_bf16_f32 v160, v160, v161
    v_cvt_pk_bf16_f32 v161, v162, v163
    v_mfma_f32_32x32x16_bf16 v[216:231], v[112:115], v[152:155], v[216:231]
    v_exp_f32 v164, v164
    v_exp_f32 v165, v165
    v_exp_f32 v166, v166
    v_exp_f32 v167, v167
    v_cvt_pk_bf16_f32 v162, v164, v165
    v_cvt_pk_bf16_f32 v163, v166, v167
    v_exp_f32 v136, v136
    v_exp_f32 v137, v137
    v_mfma_f32_32x32x16_bf16 v[216:231], v[116:119], v[160:163], v[216:231]
    buffer_load_dwordx4 v[84:87], v2, s[4:7], s13 offen offset:1024
    buffer_load_dword v98, v3, s[4:7], s14 offen offset:128
    s_mov_b64 exec, s[20:21]
    buffer_load_dwordx4 v[112:115], v4, s[4:7], s15 offen offset:1152
    buffer_load_dwordx4 v[116:119], v4, s[4:7], s15 offen offset:1728
    s_mov_b64 exec, -1
    v_exp_f32 v138, v138
    v_exp_f32 v139, v139
    v_cvt_pk_bf16_f32 v136, v136, v137
    v_cvt_pk_bf16_f32 v137, v138, v139
    v_mfma_f32_32x32x16_bf16 v[152:167], v[88:91], v[60:63], 0
    v_exp_f32 v140, v140
    v_exp_f32 v141, v141
    v_exp_f32 v142, v142
    v_exp_f32 v143, v143
    v_cvt_pk_bf16_f32 v138, v140, v141
    v_cvt_pk_bf16_f32 v139, v142, v143
    v_mfma_f32_32x32x8_bf16 v[152:167], v[100:101], v[74:75], v[152:167]
    v_exp_f32 v144, v144
    v_exp_f32 v145, v145
    v_exp_f32 v146, v146
    v_exp_f32 v147, v147
    v_cvt_pk_bf16_f32 v144, v144, v145
    v_cvt_pk_bf16_f32 v145, v146, v147
    v_mfma_f32_32x32x16_bf16 v[168:183], v[120:123], v[136:139], v[168:183]
    v_exp_f32 v148, v148
    v_exp_f32 v149, v149
    v_exp_f32 v150, v150
    v_exp_f32 v151, v151
    v_cvt_pk_bf16_f32 v146, v148, v149
    v_cvt_pk_bf16_f32 v147, v150, v151
    v_exp_f32 v152, v152
    v_exp_f32 v153, v153
    v_mfma_f32_32x32x16_bf16 v[168:183], v[124:127], v[144:147], v[168:183]
    v_exp_f32 v154, v154
    v_exp_f32 v155, v155
    v_cvt_pk_bf16_f32 v152, v152, v153
    v_cvt_pk_bf16_f32 v153, v154, v155
    v_mfma_f32_32x32x16_bf16 v[136:151], v[88:91], v[64:67], 0
    v_exp_f32 v156, v156
    v_exp_f32 v157, v157
    v_exp_f32 v158, v158
    v_exp_f32 v159, v159
    v_cvt_pk_bf16_f32 v154, v156, v157
    v_cvt_pk_bf16_f32 v155, v158, v159
    v_mfma_f32_32x32x8_bf16 v[136:151], v[100:101], v[76:77], v[136:151]
    v_exp_f32 v160, v160
    v_exp_f32 v161, v161
    v_exp_f32 v162, v162
    v_exp_f32 v163, v163
    v_cvt_pk_bf16_f32 v160, v160, v161
    v_cvt_pk_bf16_f32 v161, v162, v163
    v_mfma_f32_32x32x16_bf16 v[184:199], v[120:123], v[152:155], v[184:199]
    v_exp_f32 v164, v164
    v_exp_f32 v165, v165
    v_exp_f32 v166, v166
    v_exp_f32 v167, v167
    v_cvt_pk_bf16_f32 v162, v164, v165
    v_cvt_pk_bf16_f32 v163, v166, v167
    v_exp_f32 v136, v136
    v_exp_f32 v137, v137
    v_mfma_f32_32x32x16_bf16 v[184:199], v[124:127], v[160:163], v[184:199]
    v_exp_f32 v138, v138
    v_exp_f32 v139, v139
    v_cvt_pk_bf16_f32 v136, v136, v137
    v_cvt_pk_bf16_f32 v137, v138, v139
    v_mfma_f32_32x32x16_bf16 v[152:167], v[88:91], v[68:71], 0
    v_exp_f32 v140, v140
    v_exp_f32 v141, v141
    v_exp_f32 v142, v142
    v_exp_f32 v143, v143
    v_cvt_pk_bf16_f32 v138, v140, v141
    v_cvt_pk_bf16_f32 v139, v142, v143
    v_mfma_f32_32x32x8_bf16 v[152:167], v[100:101], v[78:79], v[152:167]
    v_exp_f32 v144, v144
    v_exp_f32 v145, v145
    v_exp_f32 v146, v146
    v_exp_f32 v147, v147
    v_cvt_pk_bf16_f32 v144, v144, v145
    v_cvt_pk_bf16_f32 v145, v146, v147
    v_mfma_f32_32x32x16_bf16 v[200:215], v[120:123], v[136:139], v[200:215]
    v_exp_f32 v148, v148
    v_exp_f32 v149, v149
    v_exp_f32 v150, v150
    v_exp_f32 v151, v151
    v_cvt_pk_bf16_f32 v146, v148, v149
    v_cvt_pk_bf16_f32 v147, v150, v151
    v_exp_f32 v152, v152
    v_exp_f32 v153, v153
    v_mfma_f32_32x32x16_bf16 v[200:215], v[124:127], v[144:147], v[200:215]
    v_exp_f32 v154, v154
    v_exp_f32 v155, v155
    v_cvt_pk_bf16_f32 v152, v152, v153
    v_cvt_pk_bf16_f32 v153, v154, v155
    s_waitcnt vmcnt(27)
    v_mfma_f32_32x32x16_bf16 v[136:151], v[92:95], v[56:59], 0
    v_exp_f32 v156, v156
    v_exp_f32 v157, v157
    v_exp_f32 v158, v158
    v_exp_f32 v159, v159
    v_cvt_pk_bf16_f32 v154, v156, v157
    v_cvt_pk_bf16_f32 v155, v158, v159
    v_mfma_f32_32x32x8_bf16 v[136:151], v[102:103], v[72:73], v[136:151]
    v_exp_f32 v160, v160
    v_exp_f32 v161, v161
    v_exp_f32 v162, v162
    v_exp_f32 v163, v163
    v_cvt_pk_bf16_f32 v160, v160, v161
    v_cvt_pk_bf16_f32 v161, v162, v163
    v_mfma_f32_32x32x16_bf16 v[216:231], v[120:123], v[152:155], v[216:231]
    v_exp_f32 v164, v164
    v_exp_f32 v165, v165
    v_exp_f32 v166, v166
    v_exp_f32 v167, v167
    v_cvt_pk_bf16_f32 v162, v164, v165
    v_cvt_pk_bf16_f32 v163, v166, v167
    v_exp_f32 v136, v136
    v_exp_f32 v137, v137
    v_mfma_f32_32x32x16_bf16 v[216:231], v[124:127], v[160:163], v[216:231]
    buffer_load_dwordx4 v[88:91], v2, s[4:7], s13 offen offset:2048
    buffer_load_dword v100, v3, s[4:7], s14 offen offset:256
    s_mov_b64 exec, s[20:21]
    buffer_load_dwordx4 v[120:123], v4, s[4:7], s15 offen offset:2304
    buffer_load_dwordx4 v[124:127], v4, s[4:7], s15 offen offset:2880
    s_mov_b64 exec, -1
    v_exp_f32 v138, v138
    v_exp_f32 v139, v139
    v_cvt_pk_bf16_f32 v136, v136, v137
    v_cvt_pk_bf16_f32 v137, v138, v139
    v_mfma_f32_32x32x16_bf16 v[152:167], v[92:95], v[60:63], 0
    v_exp_f32 v140, v140
    v_exp_f32 v141, v141
    v_exp_f32 v142, v142
    v_exp_f32 v143, v143
    v_cvt_pk_bf16_f32 v138, v140, v141
    v_cvt_pk_bf16_f32 v139, v142, v143
    v_mfma_f32_32x32x8_bf16 v[152:167], v[102:103], v[74:75], v[152:167]
    v_exp_f32 v144, v144
    v_exp_f32 v145, v145
    v_exp_f32 v146, v146
    v_exp_f32 v147, v147
    v_cvt_pk_bf16_f32 v144, v144, v145
    v_cvt_pk_bf16_f32 v145, v146, v147
    v_mfma_f32_32x32x16_bf16 v[168:183], v[128:131], v[136:139], v[168:183]
    v_exp_f32 v148, v148
    v_exp_f32 v149, v149
    v_exp_f32 v150, v150
    v_exp_f32 v151, v151
    v_cvt_pk_bf16_f32 v146, v148, v149
    v_cvt_pk_bf16_f32 v147, v150, v151
    v_exp_f32 v152, v152
    v_exp_f32 v153, v153
    v_mfma_f32_32x32x16_bf16 v[168:183], v[132:135], v[144:147], v[168:183]
    v_exp_f32 v154, v154
    v_exp_f32 v155, v155
    v_cvt_pk_bf16_f32 v152, v152, v153
    v_cvt_pk_bf16_f32 v153, v154, v155
    v_mfma_f32_32x32x16_bf16 v[136:151], v[92:95], v[64:67], 0
    v_exp_f32 v156, v156
    v_exp_f32 v157, v157
    v_exp_f32 v158, v158
    v_exp_f32 v159, v159
    v_cvt_pk_bf16_f32 v154, v156, v157
    v_cvt_pk_bf16_f32 v155, v158, v159
    v_mfma_f32_32x32x8_bf16 v[136:151], v[102:103], v[76:77], v[136:151]
    v_exp_f32 v160, v160
    v_exp_f32 v161, v161
    v_exp_f32 v162, v162
    v_exp_f32 v163, v163
    v_cvt_pk_bf16_f32 v160, v160, v161
    v_cvt_pk_bf16_f32 v161, v162, v163
    v_mfma_f32_32x32x16_bf16 v[184:199], v[128:131], v[152:155], v[184:199]
    v_exp_f32 v164, v164
    v_exp_f32 v165, v165
    v_exp_f32 v166, v166
    v_exp_f32 v167, v167
    v_cvt_pk_bf16_f32 v162, v164, v165
    v_cvt_pk_bf16_f32 v163, v166, v167
    v_exp_f32 v136, v136
    v_exp_f32 v137, v137
    v_mfma_f32_32x32x16_bf16 v[184:199], v[132:135], v[160:163], v[184:199]
    v_exp_f32 v138, v138
    v_exp_f32 v139, v139
    v_cvt_pk_bf16_f32 v136, v136, v137
    v_cvt_pk_bf16_f32 v137, v138, v139
    v_mfma_f32_32x32x16_bf16 v[152:167], v[92:95], v[68:71], 0
    v_exp_f32 v140, v140
    v_exp_f32 v141, v141
    v_exp_f32 v142, v142
    v_exp_f32 v143, v143
    v_cvt_pk_bf16_f32 v138, v140, v141
    v_cvt_pk_bf16_f32 v139, v142, v143
    v_mfma_f32_32x32x8_bf16 v[152:167], v[102:103], v[78:79], v[152:167]
    v_exp_f32 v144, v144
    v_exp_f32 v145, v145
    v_exp_f32 v146, v146
    v_exp_f32 v147, v147
    v_cvt_pk_bf16_f32 v144, v144, v145
    v_cvt_pk_bf16_f32 v145, v146, v147
    v_mfma_f32_32x32x16_bf16 v[200:215], v[128:131], v[136:139], v[200:215]
    v_exp_f32 v148, v148
    v_exp_f32 v149, v149
    v_exp_f32 v150, v150
    v_exp_f32 v151, v151
    v_cvt_pk_bf16_f32 v146, v148, v149
    v_cvt_pk_bf16_f32 v147, v150, v151
    v_exp_f32 v152, v152
    v_exp_f32 v153, v153
    v_mfma_f32_32x32x16_bf16 v[200:215], v[132:135], v[144:147], v[200:215]
    v_exp_f32 v154, v154
    v_exp_f32 v155, v155
    v_cvt_pk_bf16_f32 v152, v152, v153
    v_cvt_pk_bf16_f32 v153, v154, v155
    s_waitcnt vmcnt(8)
    v_mfma_f32_32x32x16_bf16 v[136:151], v[80:83], v[56:59], 0
    v_exp_f32 v156, v156
    v_exp_f32 v157, v157
    v_exp_f32 v158, v158
    v_exp_f32 v159, v159
    v_cvt_pk_bf16_f32 v154, v156, v157
    v_cvt_pk_bf16_f32 v155, v158, v159
    v_mfma_f32_32x32x8_bf16 v[136:151], v[96:97], v[72:73], v[136:151]
    v_exp_f32 v160, v160
    v_exp_f32 v161, v161
    v_exp_f32 v162, v162
    v_exp_f32 v163, v163
    v_cvt_pk_bf16_f32 v160, v160, v161
    v_cvt_pk_bf16_f32 v161, v162, v163
    v_mfma_f32_32x32x16_bf16 v[216:231], v[128:131], v[152:155], v[216:231]
    v_exp_f32 v164, v164
    v_exp_f32 v165, v165
    v_exp_f32 v166, v166
    v_exp_f32 v167, v167
    v_cvt_pk_bf16_f32 v162, v164, v165
    v_cvt_pk_bf16_f32 v163, v166, v167
    s_setprio 2
    v_exp_f32 v136, v136
    v_exp_f32 v137, v137
    v_mfma_f32_32x32x16_bf16 v[216:231], v[132:135], v[160:163], v[216:231]
    buffer_load_dwordx4 v[92:95], v2, s[4:7], s13 offen offset:3072
    buffer_load_dword v102, v3, s[4:7], s14 offen offset:384
    s_mov_b64 exec, s[20:21]
    buffer_load_dwordx4 v[128:131], v4, s[4:7], s15 offen offset:3456
    buffer_load_dwordx4 v[132:135], v4, s[4:7], s15 offen offset:4032
    s_mov_b64 exec, -1
    v_exp_f32 v138, v138
    v_exp_f32 v139, v139
    v_cvt_pk_bf16_f32 v136, v136, v137
    v_cvt_pk_bf16_f32 v137, v138, v139
    v_mfma_f32_32x32x16_bf16 v[152:167], v[80:83], v[60:63], 0
    v_exp_f32 v140, v140
    v_exp_f32 v141, v141
    v_exp_f32 v142, v142
    v_exp_f32 v143, v143
    v_cvt_pk_bf16_f32 v138, v140, v141
    v_cvt_pk_bf16_f32 v139, v142, v143
    v_mfma_f32_32x32x8_bf16 v[152:167], v[96:97], v[74:75], v[152:167]
    v_exp_f32 v144, v144
    v_exp_f32 v145, v145
    v_exp_f32 v146, v146
    v_exp_f32 v147, v147
    v_cvt_pk_bf16_f32 v144, v144, v145
    v_cvt_pk_bf16_f32 v145, v146, v147
    v_mfma_f32_32x32x16_bf16 v[168:183], v[104:107], v[136:139], v[168:183]
    v_exp_f32 v148, v148
    v_exp_f32 v149, v149
    v_exp_f32 v150, v150
    v_exp_f32 v151, v151
    v_cvt_pk_bf16_f32 v146, v148, v149
    v_cvt_pk_bf16_f32 v147, v150, v151
    v_exp_f32 v152, v152
    v_exp_f32 v153, v153
    v_mfma_f32_32x32x16_bf16 v[168:183], v[108:111], v[144:147], v[168:183]
    v_exp_f32 v154, v154
    v_exp_f32 v155, v155
    v_cvt_pk_bf16_f32 v152, v152, v153
    v_cvt_pk_bf16_f32 v153, v154, v155
    v_mfma_f32_32x32x16_bf16 v[136:151], v[80:83], v[64:67], 0
    v_exp_f32 v156, v156
    v_exp_f32 v157, v157
    v_exp_f32 v158, v158
    v_exp_f32 v159, v159
    v_cvt_pk_bf16_f32 v154, v156, v157
    v_cvt_pk_bf16_f32 v155, v158, v159
    v_mfma_f32_32x32x8_bf16 v[136:151], v[96:97], v[76:77], v[136:151]
    v_exp_f32 v160, v160
    v_exp_f32 v161, v161
    v_exp_f32 v162, v162
    v_exp_f32 v163, v163
    v_cvt_pk_bf16_f32 v160, v160, v161
    v_cvt_pk_bf16_f32 v161, v162, v163
    v_mfma_f32_32x32x16_bf16 v[184:199], v[104:107], v[152:155], v[184:199]
    v_exp_f32 v164, v164
    v_exp_f32 v165, v165
    v_exp_f32 v166, v166
    v_exp_f32 v167, v167
    v_cvt_pk_bf16_f32 v162, v164, v165
    v_cvt_pk_bf16_f32 v163, v166, v167
    v_exp_f32 v136, v136
    v_exp_f32 v137, v137
    v_mfma_f32_32x32x16_bf16 v[184:199], v[108:111], v[160:163], v[184:199]
    v_exp_f32 v138, v138
    v_exp_f32 v139, v139
    v_cvt_pk_bf16_f32 v136, v136, v137
    v_cvt_pk_bf16_f32 v137, v138, v139
    v_mfma_f32_32x32x16_bf16 v[152:167], v[80:83], v[68:71], 0
    v_exp_f32 v140, v140
    v_exp_f32 v141, v141
    v_exp_f32 v142, v142
    v_exp_f32 v143, v143
    v_cvt_pk_bf16_f32 v138, v140, v141
    v_cvt_pk_bf16_f32 v139, v142, v143
    v_mfma_f32_32x32x8_bf16 v[152:167], v[96:97], v[78:79], v[152:167]
    v_exp_f32 v144, v144
    v_exp_f32 v145, v145
    v_exp_f32 v146, v146
    v_exp_f32 v147, v147
    v_cvt_pk_bf16_f32 v144, v144, v145
    v_cvt_pk_bf16_f32 v145, v146, v147
    v_mfma_f32_32x32x16_bf16 v[200:215], v[104:107], v[136:139], v[200:215]
    v_exp_f32 v148, v148
    v_exp_f32 v149, v149
    v_exp_f32 v150, v150
    v_exp_f32 v151, v151
    v_cvt_pk_bf16_f32 v146, v148, v149
    v_cvt_pk_bf16_f32 v147, v150, v151
    v_exp_f32 v152, v152
    v_exp_f32 v153, v153
    v_mfma_f32_32x32x16_bf16 v[200:215], v[108:111], v[144:147], v[200:215]
    v_exp_f32 v154, v154
    v_exp_f32 v155, v155
    v_cvt_pk_bf16_f32 v152, v152, v153
    v_cvt_pk_bf16_f32 v153, v154, v155
    s_waitcnt vmcnt(8)
    v_mfma_f32_32x32x16_bf16 v[136:151], v[84:87], v[56:59], 0
    v_exp_f32 v156, v156
    v_exp_f32 v157, v157
    v_exp_f32 v158, v158
    v_exp_f32 v159, v159
    v_cvt_pk_bf16_f32 v154, v156, v157
    v_cvt_pk_bf16_f32 v155, v158, v159
    v_mfma_f32_32x32x8_bf16 v[136:151], v[98:99], v[72:73], v[136:151]
    v_exp_f32 v160, v160
    v_exp_f32 v161, v161
    v_exp_f32 v162, v162
    v_exp_f32 v163, v163
    v_cvt_pk_bf16_f32 v160, v160, v161
    v_cvt_pk_bf16_f32 v161, v162, v163
    v_mfma_f32_32x32x16_bf16 v[216:231], v[104:107], v[152:155], v[216:231]
    v_exp_f32 v164, v164
    v_exp_f32 v165, v165
    v_exp_f32 v166, v166
    v_exp_f32 v167, v167
    v_cvt_pk_bf16_f32 v162, v164, v165
    v_cvt_pk_bf16_f32 v163, v166, v167
    v_exp_f32 v136, v136
    v_exp_f32 v137, v137
    v_mfma_f32_32x32x16_bf16 v[216:231], v[108:111], v[160:163], v[216:231]
    s_add_u32 s13, s13, 4096
    s_add_u32 s14, s14, 512
    s_add_u32 s15, s15, 4608
    buffer_load_dwordx4 v[80:83], v2, s[4:7], s13 offen offset:0
    buffer_load_dword v96, v3, s[4:7], s14 offen offset:0
    s_mov_b64 exec, s[20:21]
    buffer_load_dwordx4 v[104:107], v4, s[4:7], s15 offen offset:0
    buffer_load_dwordx4 v[108:111], v4, s[4:7], s15 offen offset:576
    s_mov_b64 exec, -1
    v_exp_f32 v138, v138
    v_exp_f32 v139, v139
    v_cvt_pk_bf16_f32 v136, v136, v137
    v_cvt_pk_bf16_f32 v137, v138, v139
    v_mfma_f32_32x32x16_bf16 v[152:167], v[84:87], v[60:63], 0
    v_exp_f32 v140, v140
    v_exp_f32 v141, v141
    v_exp_f32 v142, v142
    v_exp_f32 v143, v143
    v_cvt_pk_bf16_f32 v138, v140, v141
    v_cvt_pk_bf16_f32 v139, v142, v143
    v_mfma_f32_32x32x8_bf16 v[152:167], v[98:99], v[74:75], v[152:167]
    v_exp_f32 v144, v144
    v_exp_f32 v145, v145
    v_exp_f32 v146, v146
    v_exp_f32 v147, v147
    v_cvt_pk_bf16_f32 v144, v144, v145
    v_cvt_pk_bf16_f32 v145, v146, v147
    v_mfma_f32_32x32x16_bf16 v[168:183], v[112:115], v[136:139], v[168:183]
    v_exp_f32 v148, v148
    v_exp_f32 v149, v149
    v_exp_f32 v150, v150
    v_exp_f32 v151, v151
    v_cvt_pk_bf16_f32 v146, v148, v149
    v_cvt_pk_bf16_f32 v147, v150, v151
    v_exp_f32 v152, v152
    v_exp_f32 v153, v153
    v_mfma_f32_32x32x16_bf16 v[168:183], v[116:119], v[144:147], v[168:183]
    v_exp_f32 v154, v154
    v_exp_f32 v155, v155
    v_cvt_pk_bf16_f32 v152, v152, v153
    v_cvt_pk_bf16_f32 v153, v154, v155
    v_mfma_f32_32x32x16_bf16 v[136:151], v[84:87], v[64:67], 0
    v_exp_f32 v156, v156
    v_exp_f32 v157, v157
    v_exp_f32 v158, v158
    v_exp_f32 v159, v159
    v_cvt_pk_bf16_f32 v154, v156, v157
    v_cvt_pk_bf16_f32 v155, v158, v159
    v_mfma_f32_32x32x8_bf16 v[136:151], v[98:99], v[76:77], v[136:151]
    v_exp_f32 v160, v160
    v_exp_f32 v161, v161
    v_exp_f32 v162, v162
    v_exp_f32 v163, v163
    v_cvt_pk_bf16_f32 v160, v160, v161
    v_cvt_pk_bf16_f32 v161, v162, v163
    v_mfma_f32_32x32x16_bf16 v[184:199], v[112:115], v[152:155], v[184:199]
    v_exp_f32 v164, v164
    v_exp_f32 v165, v165
    v_exp_f32 v166, v166
    v_exp_f32 v167, v167
    v_cvt_pk_bf16_f32 v162, v164, v165
    v_cvt_pk_bf16_f32 v163, v166, v167
    v_exp_f32 v136, v136
    v_exp_f32 v137, v137
    v_mfma_f32_32x32x16_bf16 v[184:199], v[116:119], v[160:163], v[184:199]
    v_exp_f32 v138, v138
    v_exp_f32 v139, v139
    v_cvt_pk_bf16_f32 v136, v136, v137
    v_cvt_pk_bf16_f32 v137, v138, v139
    v_mfma_f32_32x32x16_bf16 v[152:167], v[84:87], v[68:71], 0
    v_exp_f32 v140, v140
    v_exp_f32 v141, v141
    v_exp_f32 v142, v142
    v_exp_f32 v143, v143
    v_cvt_pk_bf16_f32 v138, v140, v141
    v_cvt_pk_bf16_f32 v139, v142, v143
    v_mfma_f32_32x32x8_bf16 v[152:167], v[98:99], v[78:79], v[152:167]
    v_exp_f32 v144, v144
    v_exp_f32 v145, v145
    v_exp_f32 v146, v146
    v_exp_f32 v147, v147
    v_cvt_pk_bf16_f32 v144, v144, v145
    v_cvt_pk_bf16_f32 v145, v146, v147
    v_mfma_f32_32x32x16_bf16 v[200:215], v[112:115], v[136:139], v[200:215]
    v_exp_f32 v148, v148
    v_exp_f32 v149, v149
    v_exp_f32 v150, v150
    v_exp_f32 v151, v151
    v_cvt_pk_bf16_f32 v146, v148, v149
    v_cvt_pk_bf16_f32 v147, v150, v151
    v_exp_f32 v152, v152
    v_exp_f32 v153, v153
    v_mfma_f32_32x32x16_bf16 v[200:215], v[116:119], v[144:147], v[200:215]
    v_exp_f32 v154, v154
    v_exp_f32 v155, v155
    v_cvt_pk_bf16_f32 v152, v152, v153
    v_cvt_pk_bf16_f32 v153, v154, v155
    s_waitcnt vmcnt(8)
    v_mfma_f32_32x32x16_bf16 v[136:151], v[88:91], v[56:59], 0
    v_exp_f32 v156, v156
    v_exp_f32 v157, v157
    v_exp_f32 v158, v158
    v_exp_f32 v159, v159
    v_cvt_pk_bf16_f32 v154, v156, v157
    v_cvt_pk_bf16_f32 v155, v158, v159
    v_mfma_f32_32x32x8_bf16 v[136:151], v[100:101], v[72:73], v[136:151]
    v_exp_f32 v160, v160
    v_exp_f32 v161, v161
    v_exp_f32 v162, v162
    v_exp_f32 v163, v163
    v_cvt_pk_bf16_f32 v160, v160, v161
    v_cvt_pk_bf16_f32 v161, v162, v163
    v_mfma_f32_32x32x16_bf16 v[216:231], v[112:115], v[152:155], v[216:231]
    v_exp_f32 v164, v164
    v_exp_f32 v165, v165
    v_exp_f32 v166, v166
    v_exp_f32 v167, v167
    v_cvt_pk_bf16_f32 v162, v164, v165
    v_cvt_pk_bf16_f32 v163, v166, v167
    v_exp_f32 v136, v136
    v_exp_f32 v137, v137
    v_mfma_f32_32x32x16_bf16 v[216:231], v[116:119], v[160:163], v[216:231]
    buffer_load_dwordx4 v[84:87], v2, s[4:7], s13 offen offset:1024
    buffer_load_dword v98, v3, s[4:7], s14 offen offset:128
    s_mov_b64 exec, s[20:21]
    buffer_load_dwordx4 v[112:115], v4, s[4:7], s15 offen offset:1152
    buffer_load_dwordx4 v[116:119], v4, s[4:7], s15 offen offset:1728
    s_mov_b64 exec, -1
    v_exp_f32 v138, v138
    v_exp_f32 v139, v139
    v_cvt_pk_bf16_f32 v136, v136, v137
    v_cvt_pk_bf16_f32 v137, v138, v139
    v_mfma_f32_32x32x16_bf16 v[152:167], v[88:91], v[60:63], 0
    v_exp_f32 v140, v140
    v_exp_f32 v141, v141
    v_exp_f32 v142, v142
    v_exp_f32 v143, v143
    v_cvt_pk_bf16_f32 v138, v140, v141
    v_cvt_pk_bf16_f32 v139, v142, v143
    v_mfma_f32_32x32x8_bf16 v[152:167], v[100:101], v[74:75], v[152:167]
    v_exp_f32 v144, v144
    v_exp_f32 v145, v145
    v_exp_f32 v146, v146
    v_exp_f32 v147, v147
    v_cvt_pk_bf16_f32 v144, v144, v145
    v_cvt_pk_bf16_f32 v145, v146, v147
    v_mfma_f32_32x32x16_bf16 v[168:183], v[120:123], v[136:139], v[168:183]
    v_exp_f32 v148, v148
    v_exp_f32 v149, v149
    v_exp_f32 v150, v150
    v_exp_f32 v151, v151
    v_cvt_pk_bf16_f32 v146, v148, v149
    v_cvt_pk_bf16_f32 v147, v150, v151
    v_exp_f32 v152, v152
    v_exp_f32 v153, v153
    v_mfma_f32_32x32x16_bf16 v[168:183], v[124:127], v[144:147], v[168:183]
    v_exp_f32 v154, v154
    v_exp_f32 v155, v155
    v_cvt_pk_bf16_f32 v152, v152, v153
    v_cvt_pk_bf16_f32 v153, v154, v155
    v_mfma_f32_32x32x16_bf16 v[136:151], v[88:91], v[64:67], 0
    v_exp_f32 v156, v156
    v_exp_f32 v157, v157
    v_exp_f32 v158, v158
    v_exp_f32 v159, v159
    v_cvt_pk_bf16_f32 v154, v156, v157
    v_cvt_pk_bf16_f32 v155, v158, v159
    v_mfma_f32_32x32x8_bf16 v[136:151], v[100:101], v[76:77], v[136:151]
    v_exp_f32 v160, v160
    v_exp_f32 v161, v161
    v_exp_f32 v162, v162
    v_exp_f32 v163, v163
    v_cvt_pk_bf16_f32 v160, v160, v161
    v_cvt_pk_bf16_f32 v161, v162, v163
    v_mfma_f32_32x32x16_bf16 v[184:199], v[120:123], v[152:155], v[184:199]
    v_exp_f32 v164, v164
    v_exp_f32 v165, v165
    v_exp_f32 v166, v166
    v_exp_f32 v167, v167
    v_cvt_pk_bf16_f32 v162, v164, v165
    v_cvt_pk_bf16_f32 v163, v166, v167
    v_exp_f32 v136, v136
    v_exp_f32 v137, v137
    v_mfma_f32_32x32x16_bf16 v[184:199], v[124:127], v[160:163], v[184:199]
    v_exp_f32 v138, v138
    v_exp_f32 v139, v139
    v_cvt_pk_bf16_f32 v136, v136, v137
    v_cvt_pk_bf16_f32 v137, v138, v139
    v_mfma_f32_32x32x16_bf16 v[152:167], v[88:91], v[68:71], 0
    v_exp_f32 v140, v140
    v_exp_f32 v141, v141
    v_exp_f32 v142, v142
    v_exp_f32 v143, v143
    v_cvt_pk_bf16_f32 v138, v140, v141
    v_cvt_pk_bf16_f32 v139, v142, v143
    v_mfma_f32_32x32x8_bf16 v[152:167], v[100:101], v[78:79], v[152:167]
    v_exp_f32 v144, v144
    v_exp_f32 v145, v145
    v_exp_f32 v146, v146
    v_exp_f32 v147, v147
    v_cvt_pk_bf16_f32 v144, v144, v145
    v_cvt_pk_bf16_f32 v145, v146, v147
    v_mfma_f32_32x32x16_bf16 v[200:215], v[120:123], v[136:139], v[200:215]
    v_exp_f32 v148, v148
    v_exp_f32 v149, v149
    v_exp_f32 v150, v150
    v_exp_f32 v151, v151
    v_cvt_pk_bf16_f32 v146, v148, v149
    v_cvt_pk_bf16_f32 v147, v150, v151
    v_exp_f32 v152, v152
    v_exp_f32 v153, v153
    v_mfma_f32_32x32x16_bf16 v[200:215], v[124:127], v[144:147], v[200:215]
    v_exp_f32 v154, v154
    v_exp_f32 v155, v155
    v_cvt_pk_bf16_f32 v152, v152, v153
    v_cvt_pk_bf16_f32 v153, v154, v155
    s_waitcnt vmcnt(8)
    v_mfma_f32_32x32x16_bf16 v[136:151], v[92:95], v[56:59], 0
    v_exp_f32 v156, v156
    v_exp_f32 v157, v157
    v_exp_f32 v158, v158
    v_exp_f32 v159, v159
    v_cvt_pk_bf16_f32 v154, v156, v157
    v_cvt_pk_bf16_f32 v155, v158, v159
    v_mfma_f32_32x32x8_bf16 v[136:151], v[102:103], v[72:73], v[136:151]
    v_exp_f32 v160, v160
    v_exp_f32 v161, v161
    v_exp_f32 v162, v162
    v_exp_f32 v163, v163
    v_cvt_pk_bf16_f32 v160, v160, v161
    v_cvt_pk_bf16_f32 v161, v162, v163
    v_mfma_f32_32x32x16_bf16 v[216:231], v[120:123], v[152:155], v[216:231]
    v_exp_f32 v164, v164
    v_exp_f32 v165, v165
    v_exp_f32 v166, v166
    v_exp_f32 v167, v167
    v_cvt_pk_bf16_f32 v162, v164, v165
    v_cvt_pk_bf16_f32 v163, v166, v167
    v_exp_f32 v136, v136
    v_exp_f32 v137, v137
    v_mfma_f32_32x32x16_bf16 v[216:231], v[124:127], v[160:163], v[216:231]
    buffer_load_dwordx4 v[88:91], v2, s[4:7], s13 offen offset:2048
    buffer_load_dword v100, v3, s[4:7], s14 offen offset:256
    s_mov_b64 exec, s[20:21]
    buffer_load_dwordx4 v[120:123], v4, s[4:7], s15 offen offset:2304
    buffer_load_dwordx4 v[124:127], v4, s[4:7], s15 offen offset:2880
    s_mov_b64 exec, -1
    v_exp_f32 v138, v138
    v_exp_f32 v139, v139
    v_cvt_pk_bf16_f32 v136, v136, v137
    v_cvt_pk_bf16_f32 v137, v138, v139
    v_mfma_f32_32x32x16_bf16 v[152:167], v[92:95], v[60:63], 0
    v_exp_f32 v140, v140
    v_exp_f32 v141, v141
    v_exp_f32 v142, v142
    v_exp_f32 v143, v143
    v_cvt_pk_bf16_f32 v138, v140, v141
    v_cvt_pk_bf16_f32 v139, v142, v143
    v_mfma_f32_32x32x8_bf16 v[152:167], v[102:103], v[74:75], v[152:167]
    v_exp_f32 v144, v144
    v_exp_f32 v145, v145
    v_exp_f32 v146, v146
    v_exp_f32 v147, v147
    v_cvt_pk_bf16_f32 v144, v144, v145
    v_cvt_pk_bf16_f32 v145, v146, v147
    v_mfma_f32_32x32x16_bf16 v[168:183], v[128:131], v[136:139], v[168:183]
    v_exp_f32 v148, v148
    v_exp_f32 v149, v149
    v_exp_f32 v150, v150
    v_exp_f32 v151, v151
    v_cvt_pk_bf16_f32 v146, v148, v149
    v_cvt_pk_bf16_f32 v147, v150, v151
    v_exp_f32 v152, v152
    v_exp_f32 v153, v153
    v_mfma_f32_32x32x16_bf16 v[168:183], v[132:135], v[144:147], v[168:183]
    v_exp_f32 v154, v154
    v_exp_f32 v155, v155
    v_cvt_pk_bf16_f32 v152, v152, v153
    v_cvt_pk_bf16_f32 v153, v154, v155
    v_mfma_f32_32x32x16_bf16 v[136:151], v[92:95], v[64:67], 0
    v_exp_f32 v156, v156
    v_exp_f32 v157, v157
    v_exp_f32 v158, v158
    v_exp_f32 v159, v159
    v_cvt_pk_bf16_f32 v154, v156, v157
    v_cvt_pk_bf16_f32 v155, v158, v159
    v_mfma_f32_32x32x8_bf16 v[136:151], v[102:103], v[76:77], v[136:151]
    v_exp_f32 v160, v160
    v_exp_f32 v161, v161
    v_exp_f32 v162, v162
    v_exp_f32 v163, v163
    v_cvt_pk_bf16_f32 v160, v160, v161
    v_cvt_pk_bf16_f32 v161, v162, v163
    v_mfma_f32_32x32x16_bf16 v[184:199], v[128:131], v[152:155], v[184:199]
    v_exp_f32 v164, v164
    v_exp_f32 v165, v165
    v_exp_f32 v166, v166
    v_exp_f32 v167, v167
    v_cvt_pk_bf16_f32 v162, v164, v165
    v_cvt_pk_bf16_f32 v163, v166, v167
    v_exp_f32 v136, v136
    v_exp_f32 v137, v137
    v_mfma_f32_32x32x16_bf16 v[184:199], v[132:135], v[160:163], v[184:199]
    v_exp_f32 v138, v138
    v_exp_f32 v139, v139
    v_cvt_pk_bf16_f32 v136, v136, v137
    v_cvt_pk_bf16_f32 v137, v138, v139
    v_mfma_f32_32x32x16_bf16 v[152:167], v[92:95], v[68:71], 0
    v_exp_f32 v140, v140
    v_exp_f32 v141, v141
    v_exp_f32 v142, v142
    v_exp_f32 v143, v143
    v_cvt_pk_bf16_f32 v138, v140, v141
    v_cvt_pk_bf16_f32 v139, v142, v143
    v_mfma_f32_32x32x8_bf16 v[152:167], v[102:103], v[78:79], v[152:167]
    v_exp_f32 v144, v144
    v_exp_f32 v145, v145
    v_exp_f32 v146, v146
    v_exp_f32 v147, v147
    v_cvt_pk_bf16_f32 v144, v144, v145
    v_cvt_pk_bf16_f32 v145, v146, v147
    v_mfma_f32_32x32x16_bf16 v[200:215], v[128:131], v[136:139], v[200:215]
    v_exp_f32 v148, v148
    v_exp_f32 v149, v149
    v_exp_f32 v150, v150
    v_exp_f32 v151, v151
    v_cvt_pk_bf16_f32 v146, v148, v149
    v_cvt_pk_bf16_f32 v147, v150, v151
    v_exp_f32 v152, v152
    v_exp_f32 v153, v153
    v_mfma_f32_32x32x16_bf16 v[200:215], v[132:135], v[144:147], v[200:215]
    v_exp_f32 v154, v154
    v_exp_f32 v155, v155
    v_cvt_pk_bf16_f32 v152, v152, v153
    v_cvt_pk_bf16_f32 v153, v154, v155
    s_waitcnt vmcnt(8)
    v_mfma_f32_32x32x16_bf16 v[136:151], v[80:83], v[56:59], 0
    v_exp_f32 v156, v156
    v_exp_f32 v157, v157
    v_exp_f32 v158, v158
    v_exp_f32 v159, v159
    v_cvt_pk_bf16_f32 v154, v156, v157
    v_cvt_pk_bf16_f32 v155, v158, v159
    v_mfma_f32_32x32x8_bf16 v[136:151], v[96:97], v[72:73], v[136:151]
    v_exp_f32 v160, v160
    v_exp_f32 v161, v161
    v_exp_f32 v162, v162
    v_exp_f32 v163, v163
    v_cvt_pk_bf16_f32 v160, v160, v161
    v_cvt_pk_bf16_f32 v161, v162, v163
    v_mfma_f32_32x32x16_bf16 v[216:231], v[128:131], v[152:155], v[216:231]
    v_exp_f32 v164, v164
    v_exp_f32 v165, v165
    v_exp_f32 v166, v166
    v_exp_f32 v167, v167
    v_cvt_pk_bf16_f32 v162, v164, v165
    v_cvt_pk_bf16_f32 v163, v166, v167
    s_setprio 1
    v_exp_f32 v136, v136
    v_exp_f32 v137, v137
    v_mfma_f32_32x32x16_bf16 v[216:231], v[132:135], v[160:163], v[216:231]
    buffer_load_dwordx4 v[92:95], v2, s[4:7], s13 offen offset:3072
    buffer_load_dword v102, v3, s[4:7], s14 offen offset:384
    s_mov_b64 exec, s[20:21]
    buffer_load_dwordx4 v[128:131], v4, s[4:7], s15 offen offset:3456
    buffer_load_dwordx4 v[132:135], v4, s[4:7], s15 offen offset:4032
    s_mov_b64 exec, -1
    v_exp_f32 v138, v138
    v_exp_f32 v139, v139
    v_cvt_pk_bf16_f32 v136, v136, v137
    v_cvt_pk_bf16_f32 v137, v138, v139
    v_mfma_f32_32x32x16_bf16 v[152:167], v[80:83], v[60:63], 0
    v_exp_f32 v140, v140
    v_exp_f32 v141, v141
    v_exp_f32 v142, v142
    v_exp_f32 v143, v143
    v_cvt_pk_bf16_f32 v138, v140, v141
    v_cvt_pk_bf16_f32 v139, v142, v143
    v_mfma_f32_32x32x8_bf16 v[152:167], v[96:97], v[74:75], v[152:167]
    v_exp_f32 v144, v144
    v_exp_f32 v145, v145
    v_exp_f32 v146, v146
    v_exp_f32 v147, v147
    v_cvt_pk_bf16_f32 v144, v144, v145
    v_cvt_pk_bf16_f32 v145, v146, v147
    v_mfma_f32_32x32x16_bf16 v[168:183], v[104:107], v[136:139], v[168:183]
    v_exp_f32 v148, v148
    v_exp_f32 v149, v149
    v_exp_f32 v150, v150
    v_exp_f32 v151, v151
    v_cvt_pk_bf16_f32 v146, v148, v149
    v_cvt_pk_bf16_f32 v147, v150, v151
    v_exp_f32 v152, v152
    v_exp_f32 v153, v153
    v_mfma_f32_32x32x16_bf16 v[168:183], v[108:111], v[144:147], v[168:183]
    s_mov_b32 s27, s76
    s_add_u32 m0, s78, 81920
    s_nop 0
    buffer_load_dwordx4 v54, s[64:67], s27 offen lds
    s_add_u32 m0, s78, 82944
    s_add_u32 s27, s27, 9216
    buffer_load_dwordx4 v54, s[64:67], s27 offen lds
    s_add_u32 m0, s78, 83968
    s_add_u32 s27, s27, 9216
    buffer_load_dwordx4 v54, s[64:67], s27 offen lds
    s_add_u32 m0, s78, 84992
    s_add_u32 s27, s27, 9216
    buffer_load_dwordx4 v54, s[64:67], s27 offen lds
    s_add_u32 m0, s78, 86016
    s_add_u32 s27, s27, 9216
    buffer_load_dwordx4 v54, s[64:67], s27 offen lds
    s_add_u32 m0, s78, 87040
    s_add_u32 s27, s27, 9216
    buffer_load_dwordx4 v54, s[64:67], s27 offen lds
    s_add_u32 m0, s78, 88064
    s_add_u32 s27, s27, 9216
    buffer_load_dwordx4 v54, s[64:67], s27 offen lds
    s_add_u32 m0, s78, 89088
    s_add_u32 s27, s27, 9216
    buffer_load_dwordx4 v54, s[64:67], s27 offen lds
    s_add_u32 m0, s78, 90112
    s_add_u32 s27, s27, 9216
    buffer_load_dwordx4 v54, s[64:67], s27 offen lds
    v_exp_f32 v154, v154
    v_exp_f32 v155, v155
    v_cvt_pk_bf16_f32 v152, v152, v153
    v_cvt_pk_bf16_f32 v153, v154, v155
    v_mfma_f32_32x32x16_bf16 v[136:151], v[80:83], v[64:67], 0
    v_exp_f32 v156, v156
    v_exp_f32 v157, v157
    v_exp_f32 v158, v158
    v_exp_f32 v159, v159
    v_cvt_pk_bf16_f32 v154, v156, v157
    v_cvt_pk_bf16_f32 v155, v158, v159
    v_mfma_f32_32x32x8_bf16 v[136:151], v[96:97], v[76:77], v[136:151]
    v_exp_f32 v160, v160
    v_exp_f32 v161, v161
    v_exp_f32 v162, v162
    v_exp_f32 v163, v163
    v_cvt_pk_bf16_f32 v160, v160, v161
    v_cvt_pk_bf16_f32 v161, v162, v163
    v_mfma_f32_32x32x16_bf16 v[184:199], v[104:107], v[152:155], v[184:199]
    v_exp_f32 v164, v164
    v_exp_f32 v165, v165
    v_exp_f32 v166, v166
    v_exp_f32 v167, v167
    v_cvt_pk_bf16_f32 v162, v164, v165
    v_cvt_pk_bf16_f32 v163, v166, v167
    v_exp_f32 v136, v136
    v_exp_f32 v137, v137
    v_mfma_f32_32x32x16_bf16 v[184:199], v[108:111], v[160:163], v[184:199]
    v_exp_f32 v138, v138
    v_exp_f32 v139, v139
    v_cvt_pk_bf16_f32 v136, v136, v137
    v_cvt_pk_bf16_f32 v137, v138, v139
    v_mfma_f32_32x32x16_bf16 v[152:167], v[80:83], v[68:71], 0
    v_exp_f32 v140, v140
    v_exp_f32 v141, v141
    v_exp_f32 v142, v142
    v_exp_f32 v143, v143
    v_cvt_pk_bf16_f32 v138, v140, v141
    v_cvt_pk_bf16_f32 v139, v142, v143
    v_mfma_f32_32x32x8_bf16 v[152:167], v[96:97], v[78:79], v[152:167]
    v_exp_f32 v144, v144
    v_exp_f32 v145, v145
    v_exp_f32 v146, v146
    v_exp_f32 v147, v147
    v_cvt_pk_bf16_f32 v144, v144, v145
    v_cvt_pk_bf16_f32 v145, v146, v147
    v_mfma_f32_32x32x16_bf16 v[200:215], v[104:107], v[136:139], v[200:215]
    v_exp_f32 v148, v148
    v_exp_f32 v149, v149
    v_exp_f32 v150, v150
    v_exp_f32 v151, v151
    v_cvt_pk_bf16_f32 v146, v148, v149
    v_cvt_pk_bf16_f32 v147, v150, v151
    v_exp_f32 v152, v152
    v_exp_f32 v153, v153
    v_mfma_f32_32x32x16_bf16 v[200:215], v[108:111], v[144:147], v[200:215]
    v_exp_f32 v154, v154
    v_exp_f32 v155, v155
    v_cvt_pk_bf16_f32 v152, v152, v153
    v_cvt_pk_bf16_f32 v153, v154, v155
    s_waitcnt vmcnt(17)
    v_mfma_f32_32x32x16_bf16 v[136:151], v[84:87], v[56:59], 0
    v_exp_f32 v156, v156
    v_exp_f32 v157, v157
    v_exp_f32 v158, v158
    v_exp_f32 v159, v159
    v_cvt_pk_bf16_f32 v154, v156, v157
    v_cvt_pk_bf16_f32 v155, v158, v159
    v_mfma_f32_32x32x8_bf16 v[136:151], v[98:99], v[72:73], v[136:151]
    v_exp_f32 v160, v160
    v_exp_f32 v161, v161
    v_exp_f32 v162, v162
    v_exp_f32 v163, v163
    v_cvt_pk_bf16_f32 v160, v160, v161
    v_cvt_pk_bf16_f32 v161, v162, v163
    v_mfma_f32_32x32x16_bf16 v[216:231], v[104:107], v[152:155], v[216:231]
    v_exp_f32 v164, v164
    v_exp_f32 v165, v165
    v_exp_f32 v166, v166
    v_exp_f32 v167, v167
    v_cvt_pk_bf16_f32 v162, v164, v165
    v_cvt_pk_bf16_f32 v163, v166, v167
    v_exp_f32 v136, v136
    v_exp_f32 v137, v137
    v_mfma_f32_32x32x16_bf16 v[216:231], v[108:111], v[160:163], v[216:231]
    v_exp_f32 v138, v138
    v_exp_f32 v139, v139
    v_cvt_pk_bf16_f32 v136, v136, v137
    v_cvt_pk_bf16_f32 v137, v138, v139
    v_mfma_f32_32x32x16_bf16 v[152:167], v[84:87], v[60:63], 0
    v_exp_f32 v140, v140
    v_exp_f32 v141, v141
    v_exp_f32 v142, v142
    v_exp_f32 v143, v143
    v_cvt_pk_bf16_f32 v138, v140, v141
    v_cvt_pk_bf16_f32 v139, v142, v143
    v_mfma_f32_32x32x8_bf16 v[152:167], v[98:99], v[74:75], v[152:167]
    v_exp_f32 v144, v144
    v_exp_f32 v145, v145
    v_exp_f32 v146, v146
    v_exp_f32 v147, v147
    v_cvt_pk_bf16_f32 v144, v144, v145
    v_cvt_pk_bf16_f32 v145, v146, v147
    v_mfma_f32_32x32x16_bf16 v[168:183], v[112:115], v[136:139], v[168:183]
    v_exp_f32 v148, v148
    v_exp_f32 v149, v149
    v_exp_f32 v150, v150
    v_exp_f32 v151, v151
    v_cvt_pk_bf16_f32 v146, v148, v149
    v_cvt_pk_bf16_f32 v147, v150, v151
    v_exp_f32 v152, v152
    v_exp_f32 v153, v153
    v_mfma_f32_32x32x16_bf16 v[168:183], v[116:119], v[144:147], v[168:183]
    v_exp_f32 v154, v154
    v_exp_f32 v155, v155
    v_cvt_pk_bf16_f32 v152, v152, v153
    v_cvt_pk_bf16_f32 v153, v154, v155
    v_mfma_f32_32x32x16_bf16 v[136:151], v[84:87], v[64:67], 0
    v_exp_f32 v156, v156
    v_exp_f32 v157, v157
    v_exp_f32 v158, v158
    v_exp_f32 v159, v159
    v_cvt_pk_bf16_f32 v154, v156, v157
    v_cvt_pk_bf16_f32 v155, v158, v159
    v_mfma_f32_32x32x8_bf16 v[136:151], v[98:99], v[76:77], v[136:151]
    v_exp_f32 v160, v160
    v_exp_f32 v161, v161
    v_exp_f32 v162, v162
    v_exp_f32 v163, v163
    v_cvt_pk_bf16_f32 v160, v160, v161
    v_cvt_pk_bf16_f32 v161, v162, v163
    v_mfma_f32_32x32x16_bf16 v[184:199], v[112:115], v[152:155], v[184:199]
    v_exp_f32 v164, v164
    v_exp_f32 v165, v165
    v_exp_f32 v166, v166
    v_exp_f32 v167, v167
    v_cvt_pk_bf16_f32 v162, v164, v165
    v_cvt_pk_bf16_f32 v163, v166, v167
    v_exp_f32 v136, v136
    v_exp_f32 v137, v137
    v_mfma_f32_32x32x16_bf16 v[184:199], v[116:119], v[160:163], v[184:199]
    v_exp_f32 v138, v138
    v_exp_f32 v139, v139
    v_cvt_pk_bf16_f32 v136, v136, v137
    v_cvt_pk_bf16_f32 v137, v138, v139
    v_mfma_f32_32x32x16_bf16 v[152:167], v[84:87], v[68:71], 0
    v_exp_f32 v140, v140
    v_exp_f32 v141, v141
    v_exp_f32 v142, v142
    v_exp_f32 v143, v143
    v_cvt_pk_bf16_f32 v138, v140, v141
    v_cvt_pk_bf16_f32 v139, v142, v143
    v_mfma_f32_32x32x8_bf16 v[152:167], v[98:99], v[78:79], v[152:167]
    v_exp_f32 v144, v144
    v_exp_f32 v145, v145
    v_exp_f32 v146, v146
    v_exp_f32 v147, v147
    v_cvt_pk_bf16_f32 v144, v144, v145
    v_cvt_pk_bf16_f32 v145, v146, v147
    v_mfma_f32_32x32x16_bf16 v[200:215], v[112:115], v[136:139], v[200:215]
    v_exp_f32 v148, v148
    v_exp_f32 v149, v149
    v_exp_f32 v150, v150
    v_exp_f32 v151, v151
    v_cvt_pk_bf16_f32 v146, v148, v149
    v_cvt_pk_bf16_f32 v147, v150, v151
    v_exp_f32 v152, v152
    v_exp_f32 v153, v153
    v_mfma_f32_32x32x16_bf16 v[200:215], v[116:119], v[144:147], v[200:215]
    v_exp_f32 v154, v154
    v_exp_f32 v155, v155
    v_cvt_pk_bf16_f32 v152, v152, v153
    v_cvt_pk_bf16_f32 v153, v154, v155
    s_waitcnt vmcnt(13)
    v_mfma_f32_32x32x16_bf16 v[136:151], v[88:91], v[56:59], 0
    v_exp_f32 v156, v156
    v_exp_f32 v157, v157
    v_exp_f32 v158, v158
    v_exp_f32 v159, v159
    v_cvt_pk_bf16_f32 v154, v156, v157
    v_cvt_pk_bf16_f32 v155, v158, v159
    v_mfma_f32_32x32x8_bf16 v[136:151], v[100:101], v[72:73], v[136:151]
    v_exp_f32 v160, v160
    v_exp_f32 v161, v161
    v_exp_f32 v162, v162
    v_exp_f32 v163, v163
    v_cvt_pk_bf16_f32 v160, v160, v161
    v_cvt_pk_bf16_f32 v161, v162, v163
    v_mfma_f32_32x32x16_bf16 v[216:231], v[112:115], v[152:155], v[216:231]
    v_exp_f32 v164, v164
    v_exp_f32 v165, v165
    v_exp_f32 v166, v166
    v_exp_f32 v167, v167
    v_cvt_pk_bf16_f32 v162, v164, v165
    v_cvt_pk_bf16_f32 v163, v166, v167
    s_setprio 0
    v_exp_f32 v136, v136
    v_exp_f32 v137, v137
    v_mfma_f32_32x32x16_bf16 v[216:231], v[116:119], v[160:163], v[216:231]
    v_exp_f32 v138, v138
    v_exp_f32 v139, v139
    v_cvt_pk_bf16_f32 v136, v136, v137
    v_cvt_pk_bf16_f32 v137, v138, v139
    v_mfma_f32_32x32x16_bf16 v[152:167], v[88:91], v[60:63], 0
    v_exp_f32 v140, v140
    v_exp_f32 v141, v141
    v_exp_f32 v142, v142
    v_exp_f32 v143, v143
    v_cvt_pk_bf16_f32 v138, v140, v141
    v_cvt_pk_bf16_f32 v139, v142, v143
    v_mfma_f32_32x32x8_bf16 v[152:167], v[100:101], v[74:75], v[152:167]
    v_exp_f32 v144, v144
    v_exp_f32 v145, v145
    v_exp_f32 v146, v146
    v_exp_f32 v147, v147
    v_cvt_pk_bf16_f32 v144, v144, v145
    v_cvt_pk_bf16_f32 v145, v146, v147
    v_mfma_f32_32x32x16_bf16 v[168:183], v[120:123], v[136:139], v[168:183]
    v_exp_f32 v148, v148
    v_exp_f32 v149, v149
    v_exp_f32 v150, v150
    v_exp_f32 v151, v151
    v_cvt_pk_bf16_f32 v146, v148, v149
    v_cvt_pk_bf16_f32 v147, v150, v151
    v_exp_f32 v152, v152
    v_exp_f32 v153, v153
    v_mfma_f32_32x32x16_bf16 v[168:183], v[124:127], v[144:147], v[168:183]
    v_exp_f32 v154, v154
    v_exp_f32 v155, v155
    v_cvt_pk_bf16_f32 v152, v152, v153
    v_cvt_pk_bf16_f32 v153, v154, v155
    v_mfma_f32_32x32x16_bf16 v[136:151], v[88:91], v[64:67], 0
    v_exp_f32 v156, v156
    v_exp_f32 v157, v157
    v_exp_f32 v158, v158
    v_exp_f32 v159, v159
    v_cvt_pk_bf16_f32 v154, v156, v157
    v_cvt_pk_bf16_f32 v155, v158, v159
    v_mfma_f32_32x32x8_bf16 v[136:151], v[100:101], v[76:77], v[136:151]
    v_exp_f32 v160, v160
    v_exp_f32 v161, v161
    v_exp_f32 v162, v162
    v_exp_f32 v163, v163
    v_cvt_pk_bf16_f32 v160, v160, v161
    v_cvt_pk_bf16_f32 v161, v162, v163
    v_mfma_f32_32x32x16_bf16 v[184:199], v[120:123], v[152:155], v[184:199]
    v_exp_f32 v164, v164
    v_exp_f32 v165, v165
    v_exp_f32 v166, v166
    v_exp_f32 v167, v167
    v_cvt_pk_bf16_f32 v162, v164, v165
    v_cvt_pk_bf16_f32 v163, v166, v167
    v_exp_f32 v136, v136
    v_exp_f32 v137, v137
    v_mfma_f32_32x32x16_bf16 v[184:199], v[124:127], v[160:163], v[184:199]
    v_exp_f32 v138, v138
    v_exp_f32 v139, v139
    v_cvt_pk_bf16_f32 v136, v136, v137
    v_cvt_pk_bf16_f32 v137, v138, v139
    v_mfma_f32_32x32x16_bf16 v[152:167], v[88:91], v[68:71], 0
    v_exp_f32 v140, v140
    v_exp_f32 v141, v141
    v_exp_f32 v142, v142
    v_exp_f32 v143, v143
    v_cvt_pk_bf16_f32 v138, v140, v141
    v_cvt_pk_bf16_f32 v139, v142, v143
    v_mfma_f32_32x32x8_bf16 v[152:167], v[100:101], v[78:79], v[152:167]
    v_exp_f32 v144, v144
    v_exp_f32 v145, v145
    v_exp_f32 v146, v146
    v_exp_f32 v147, v147
    v_cvt_pk_bf16_f32 v144, v144, v145
    v_cvt_pk_bf16_f32 v145, v146, v147
    v_mfma_f32_32x32x16_bf16 v[200:215], v[120:123], v[136:139], v[200:215]
    v_exp_f32 v148, v148
    v_exp_f32 v149, v149
    v_exp_f32 v150, v150
    v_exp_f32 v151, v151
    v_cvt_pk_bf16_f32 v146, v148, v149
    v_cvt_pk_bf16_f32 v147, v150, v151
    v_exp_f32 v152, v152
    v_exp_f32 v153, v153
    v_mfma_f32_32x32x16_bf16 v[200:215], v[124:127], v[144:147], v[200:215]
    v_exp_f32 v154, v154
    v_exp_f32 v155, v155
    v_cvt_pk_bf16_f32 v152, v152, v153
    v_cvt_pk_bf16_f32 v153, v154, v155
    s_waitcnt vmcnt(9)
    v_mfma_f32_32x32x16_bf16 v[136:151], v[92:95], v[56:59], 0
    v_exp_f32 v156, v156
    v_exp_f32 v157, v157
    v_exp_f32 v158, v158
    v_exp_f32 v159, v159
    v_cvt_pk_bf16_f32 v154, v156, v157
    v_cvt_pk_bf16_f32 v155, v158, v159
    v_mfma_f32_32x32x8_bf16 v[136:151], v[102:103], v[72:73], v[136:151]
    v_exp_f32 v160, v160
    v_exp_f32 v161, v161
    v_exp_f32 v162, v162
    v_exp_f32 v163, v163
    v_cvt_pk_bf16_f32 v160, v160, v161
    v_cvt_pk_bf16_f32 v161, v162, v163
    v_mfma_f32_32x32x16_bf16 v[216:231], v[120:123], v[152:155], v[216:231]
    v_exp_f32 v164, v164
    v_exp_f32 v165, v165
    v_exp_f32 v166, v166
    v_exp_f32 v167, v167
    v_cvt_pk_bf16_f32 v162, v164, v165
    v_cvt_pk_bf16_f32 v163, v166, v167
    v_exp_f32 v136, v136
    v_exp_f32 v137, v137
    v_mfma_f32_32x32x16_bf16 v[216:231], v[124:127], v[160:163], v[216:231]
    v_exp_f32 v138, v138
    v_exp_f32 v139, v139
    v_cvt_pk_bf16_f32 v136, v136, v137
    v_cvt_pk_bf16_f32 v137, v138, v139
    v_mfma_f32_32x32x16_bf16 v[152:167], v[92:95], v[60:63], 0
    v_exp_f32 v140, v140
    v_exp_f32 v141, v141
    v_exp_f32 v142, v142
    v_exp_f32 v143, v143
    v_cvt_pk_bf16_f32 v138, v140, v141
    v_cvt_pk_bf16_f32 v139, v142, v143
    v_mfma_f32_32x32x8_bf16 v[152:167], v[102:103], v[74:75], v[152:167]
    v_exp_f32 v144, v144
    v_exp_f32 v145, v145
    v_exp_f32 v146, v146
    v_exp_f32 v147, v147
    v_cvt_pk_bf16_f32 v144, v144, v145
    v_cvt_pk_bf16_f32 v145, v146, v147
    v_mfma_f32_32x32x16_bf16 v[168:183], v[128:131], v[136:139], v[168:183]
    v_exp_f32 v148, v148
    v_exp_f32 v149, v149
    v_exp_f32 v150, v150
    v_exp_f32 v151, v151
    v_cvt_pk_bf16_f32 v146, v148, v149
    v_cvt_pk_bf16_f32 v147, v150, v151
    v_exp_f32 v152, v152
    v_exp_f32 v153, v153
    v_mfma_f32_32x32x16_bf16 v[168:183], v[132:135], v[144:147], v[168:183]
    v_exp_f32 v154, v154
    v_exp_f32 v155, v155
    v_cvt_pk_bf16_f32 v152, v152, v153
    v_cvt_pk_bf16_f32 v153, v154, v155
    v_mfma_f32_32x32x16_bf16 v[136:151], v[92:95], v[64:67], 0
    v_exp_f32 v156, v156
    v_exp_f32 v157, v157
    v_exp_f32 v158, v158
    v_exp_f32 v159, v159
    v_cvt_pk_bf16_f32 v154, v156, v157
    v_cvt_pk_bf16_f32 v155, v158, v159
    v_mfma_f32_32x32x8_bf16 v[136:151], v[102:103], v[76:77], v[136:151]
    v_exp_f32 v160, v160
    v_exp_f32 v161, v161
    v_exp_f32 v162, v162
    v_exp_f32 v163, v163
    v_cvt_pk_bf16_f32 v160, v160, v161
    v_cvt_pk_bf16_f32 v161, v162, v163
    v_mfma_f32_32x32x16_bf16 v[184:199], v[128:131], v[152:155], v[184:199]
    v_exp_f32 v164, v164
    v_exp_f32 v165, v165
    v_exp_f32 v166, v166
    v_exp_f32 v167, v167
    v_cvt_pk_bf16_f32 v162, v164, v165
    v_cvt_pk_bf16_f32 v163, v166, v167
    v_exp_f32 v136, v136
    v_exp_f32 v137, v137
    v_mfma_f32_32x32x16_bf16 v[184:199], v[132:135], v[160:163], v[184:199]
    v_exp_f32 v138, v138
    v_exp_f32 v139, v139
    v_cvt_pk_bf16_f32 v136, v136, v137
    v_cvt_pk_bf16_f32 v137, v138, v139
    v_mfma_f32_32x32x16_bf16 v[152:167], v[92:95], v[68:71], 0
    v_exp_f32 v140, v140
    v_exp_f32 v141, v141
    v_exp_f32 v142, v142
    v_exp_f32 v143, v143
    v_cvt_pk_bf16_f32 v138, v140, v141
    v_cvt_pk_bf16_f32 v139, v142, v143
    v_mfma_f32_32x32x8_bf16 v[152:167], v[102:103], v[78:79], v[152:167]
    v_exp_f32 v144, v144
    v_exp_f32 v145, v145
    v_exp_f32 v146, v146
    v_exp_f32 v147, v147
    v_cvt_pk_bf16_f32 v144, v144, v145
    v_cvt_pk_bf16_f32 v145, v146, v147
    v_mfma_f32_32x32x16_bf16 v[200:215], v[128:131], v[136:139], v[200:215]
    v_exp_f32 v148, v148
    v_exp_f32 v149, v149
    v_exp_f32 v150, v150
    v_exp_f32 v151, v151
    v_cvt_pk_bf16_f32 v146, v148, v149
    v_cvt_pk_bf16_f32 v147, v150, v151
    v_exp_f32 v152, v152
    v_exp_f32 v153, v153
    v_mfma_f32_32x32x16_bf16 v[200:215], v[132:135], v[144:147], v[200:215]
    v_exp_f32 v154, v154
    v_exp_f32 v155, v155
    v_cvt_pk_bf16_f32 v152, v152, v153
    v_cvt_pk_bf16_f32 v153, v154, v155
    v_exp_f32 v156, v156
    v_exp_f32 v157, v157
    v_exp_f32 v158, v158
    v_exp_f32 v159, v159
    v_cvt_pk_bf16_f32 v154, v156, v157
    v_cvt_pk_bf16_f32 v155, v158, v159
    v_exp_f32 v160, v160
    v_exp_f32 v161, v161
    v_exp_f32 v162, v162
    v_exp_f32 v163, v163
    v_cvt_pk_bf16_f32 v160, v160, v161
    v_cvt_pk_bf16_f32 v161, v162, v163
    v_mfma_f32_32x32x16_bf16 v[216:231], v[128:131], v[152:155], v[216:231]
    v_exp_f32 v164, v164
    v_exp_f32 v165, v165
    v_exp_f32 v166, v166
    v_exp_f32 v167, v167
    v_cvt_pk_bf16_f32 v162, v164, v165
    v_cvt_pk_bf16_f32 v163, v166, v167
    s_nop 1
    v_mfma_f32_32x32x16_bf16 v[216:231], v[132:135], v[160:163], v[216:231]
    s_xor_b32 s27, s12, 1
    s_lshl_b32 s28, s11, 2
    s_add_u32 s27, s27, s28
    s_mul_i32 s27, s27, 9216
    s_add_u32 s27, s27, 0
    v_add_u32 v6, s27, v2
    s_xor_b32 s27, s12, 2
    s_lshl_b32 s28, s11, 2
    s_add_u32 s27, s27, s28
    s_mul_i32 s27, s27, 9216
    s_add_u32 s27, s27, 3072
    v_add_u32 v7, s27, v2
    s_xor_b32 s27, s12, 3
    s_lshl_b32 s28, s11, 2
    s_add_u32 s27, s27, s28
    s_mul_i32 s27, s27, 9216
    s_add_u32 s27, s27, 6144
    v_add_u32 v8, s27, v2
    ds_write_b128 v6, v[184:187] offset:6144
    ds_write_b128 v6, v[188:191] offset:7168
    ds_write_b128 v6, v[192:195] offset:8192
    ds_write_b128 v7, v[200:203] offset:6144
    ds_write_b128 v7, v[204:207] offset:7168
    ds_write_b128 v7, v[208:211] offset:8192
    v_pk_add_f32 v[136:137], v[26:27], v[28:29]
    v_pk_add_f32 v[138:139], v[30:31], v[32:33]
    v_pk_add_f32 v[140:141], v[34:35], v[36:37]
    v_pk_add_f32 v[142:143], v[38:39], v[40:41]
    v_pk_add_f32 v[136:137], v[136:137], v[138:139]
    v_pk_add_f32 v[140:141], v[140:141], v[142:143]
    v_pk_add_f32 v[136:137], v[136:137], v[140:141]
    v_add_f32 v136, v136, v137
    v_min_u32 v137, 383, v0
    v_lshlrev_b32 v137, 2, v137
    ds_write_b128 v8, v[216:219] offset:6144
    ds_write_b128 v8, v[220:223] offset:7168
    ds_write_b128 v8, v[224:227] offset:8192
    ds_write_b32 v137, v136 offset:0
    v_mov_b32 v140, 0x57800000
    v_max3_f32 v141, v178, v194, v210
    v_cmp_nle_f32 s[28:29], v226, v140
    v_cmp_nle_f32 vcc, v141, v140
    s_or_b64 s[28:29], s[28:29], vcc
    v_cmp_u_f32 vcc, v178, v194
    s_or_b64 s[28:29], s[28:29], vcc
    v_cmp_u_f32 vcc, v210, v210
    s_or_b64 s[28:29], s[28:29], vcc
    s_or_b32 s27, s28, s29
    v_mov_b32 v142, s27
    s_lshl_b32 s28, s8, 2
    v_mov_b32 v143, s28
    ds_write_b32 v143, v142 offset:1536
    v_lshlrev_b32 v152, 16, v14
    v_and_b32 v153, 0xffff0000, v14
    v_lshlrev_b32 v154, 16, v15
    v_and_b32 v155, 0xffff0000, v15
    v_lshlrev_b32 v156, 16, v16
    v_and_b32 v157, 0xffff0000, v16
    v_lshlrev_b32 v158, 16, v17
    v_and_b32 v159, 0xffff0000, v17
    v_lshlrev_b32 v160, 16, v18
    v_and_b32 v161, 0xffff0000, v18
    v_min_f32 v144, 0, v152
    v_min_f32 v145, 0, v153
    v_pk_mul_f32 v[146:147], v[144:145], s[22:23]
    v_pk_add_f32 v[152:153], v[152:153], v[144:145] neg_lo:[0,1] neg_hi:[0,1]
    v_exp_f32 v146, v146
    v_exp_f32 v147, v147
    v_pk_add_f32 v[152:153], v[152:153], s[24:25]
    v_pk_add_f32 v[152:153], v[152:153], v[146:147]
    v_min_f32 v148, 0, v154
    v_min_f32 v149, 0, v155
    v_pk_mul_f32 v[150:151], v[148:149], s[22:23]
    v_pk_add_f32 v[154:155], v[154:155], v[148:149] neg_lo:[0,1] neg_hi:[0,1]
    v_exp_f32 v150, v150
    v_exp_f32 v151, v151
    v_pk_add_f32 v[154:155], v[154:155], s[24:25]
    v_pk_add_f32 v[154:155], v[154:155], v[150:151]
    v_min_f32 v144, 0, v156
    v_min_f32 v145, 0, v157
    v_pk_mul_f32 v[146:147], v[144:145], s[22:23]
    v_pk_add_f32 v[156:157], v[156:157], v[144:145] neg_lo:[0,1] neg_hi:[0,1]
    v_exp_f32 v146, v146
    v_exp_f32 v147, v147
    v_pk_add_f32 v[156:157], v[156:157], s[24:25]
    v_pk_add_f32 v[156:157], v[156:157], v[146:147]
    v_min_f32 v148, 0, v158
    v_min_f32 v149, 0, v159
    v_pk_mul_f32 v[150:151], v[148:149], s[22:23]
    v_pk_add_f32 v[158:159], v[158:159], v[148:149] neg_lo:[0,1] neg_hi:[0,1]
    v_exp_f32 v150, v150
    v_exp_f32 v151, v151
    v_pk_add_f32 v[158:159], v[158:159], s[24:25]
    v_pk_add_f32 v[158:159], v[158:159], v[150:151]
    v_min_f32 v144, 0, v160
    v_min_f32 v145, 0, v161
    v_pk_mul_f32 v[146:147], v[144:145], s[22:23]
    v_pk_add_f32 v[160:161], v[160:161], v[144:145] neg_lo:[0,1] neg_hi:[0,1]
    v_exp_f32 v146, v146
    v_exp_f32 v147, v147
    v_pk_add_f32 v[160:161], v[160:161], s[24:25]
    v_pk_add_f32 v[160:161], v[160:161], v[146:147]
    v_cvt_pk_bf16_f32 v20, v152, v153
    v_cvt_pk_bf16_f32 v21, v154, v155
    v_cvt_pk_bf16_f32 v22, v156, v157
    v_cvt_pk_bf16_f32 v23, v158, v159
    s_mov_b32 exec_lo, 0xffffffff
    s_mov_b32 exec_hi, 0x00000000
    v_cvt_pk_bf16_f32 v24, v160, v161
    s_mov_b64 exec, -1
    v_mov_b32 v42, v12
    v_mov_b32 v43, v12
    s_nop 1
    v_permlane32_swap_b32 v42, v43
    s_nop 1
    v_mul_f32 v13, 0xbfb8aa3b, v42
    v_exp_f32 v13, v13
    s_nop 0
    v_add_f32 v13, 1.0, v13
    v_rcp_f32 v13, v13
    s_lshl_b32 s27, s11, 2
    s_add_u32 s27, s27, s12
    s_mul_i32 s27, s27, 9216
    v_add_u32 v6, s27, v2
    v_and_b32 v7, 31, v1
    v_min_u32 v7, 18, v7
    v_mul_u32_u24 v7, 80, v7
    v_lshrrev_b32 v8, 5, v1
    v_lshl_add_u32 v8, v8, 5, v7
    v_mov_b32 v9, 0
    s_waitcnt lgkmcnt(0)
    s_barrier

    s_waitcnt lgkmcnt(0)
    ds_read_b128 v[136:139], v9 offset:1536
    ds_read_b128 v[140:143], v9 offset:1552
    ds_read_b128 v[144:147], v8 offset:0
    ds_read_b128 v[148:151], v8 offset:16
    ds_read_b64 v[152:153], v7 offset:64

    ds_read_b128 v[184:187], v6 offset:6144
    ds_read_b128 v[188:191], v6 offset:7168
    ds_read_b128 v[192:195], v6 offset:8192
    ds_read_b128 v[200:203], v6 offset:9216
    ds_read_b128 v[204:207], v6 offset:10240
    ds_read_b128 v[208:211], v6 offset:11264
    ds_read_b128 v[216:219], v6 offset:12288
    ds_read_b128 v[220:223], v6 offset:13312
    ds_read_b128 v[224:227], v6 offset:14336
    s_waitcnt lgkmcnt(12)
    v_or3_b32 v136, v136, v137, v138
    v_or3_b32 v139, v139, v140, v141
    v_or3_b32 v136, v136, v142, v143
    v_or_b32 v136, v136, v139
    s_nop 0
    v_readfirstlane_b32 s27, v136
    s_nop 3
    s_cmp_eq_u32 s27, 0
    s_cselect_b32 s27, 1, s26
    s_cmp_eq_u32 s27, 0
    s_cbranch_scc1 L_k2_fallback
    s_waitcnt lgkmcnt(9)

    v_cvt_pk_bf16_f32 v136, v144, v145
    v_cvt_pk_bf16_f32 v137, v146, v147
    v_cvt_pk_bf16_f32 v138, v148, v149
    v_cvt_pk_bf16_f32 v139, v150, v151
    v_cvt_pk_bf16_f32 v140, v152, v153
    v_mov_b32 v141, 0
    s_lshl_b32 s29, s12, 5
    s_add_u32 s29, s29, s37
    s_lshl_b32 s29, s29, 6
    v_mfma_f32_32x32x16_bf16 v[152:167], v[136:139], v[20:23], 0
    v_mfma_f32_32x32x8_bf16 v[152:167], v[140:141], v[24:25], v[152:167]
    s_lshr_b32 s27, s9, 1
    s_mul_i32 s27, s27, 131072
    s_add_u32 s27, s27, s29
    s_and_b32 s28, s9, 1
    s_lshl_b32 s30, s28, 9
    s_add_u32 s27, s27, s30
    v_bfe_u32 v6, v1, 4, 1
    v_lshlrev_b32 v6, 10, v6
    v_and_b32 v7, 15, v1
    v_lshl_add_u32 v6, v7, 4, v6
    v_lshrrev_b32 v7, 5, v1
    v_lshl_add_u32 v5, v7, 8, v6
    s_lshr_b32 s28, s29, 4
    s_lshl_b32 s30, s9, 13
    s_add_u32 s28, s28, s30

    s_waitcnt lgkmcnt(6)
    v_pk_add_f32 v[168:169], v[168:169], v[184:185]
    v_pk_add_f32 v[170:171], v[170:171], v[186:187]
    v_pk_add_f32 v[172:173], v[172:173], v[188:189]
    v_pk_add_f32 v[174:175], v[174:175], v[190:191]
    v_pk_add_f32 v[176:177], v[176:177], v[192:193]
    v_pk_add_f32 v[178:179], v[178:179], v[194:195]
    s_waitcnt lgkmcnt(3)
    v_pk_add_f32 v[168:169], v[168:169], v[200:201]
    v_pk_add_f32 v[170:171], v[170:171], v[202:203]
    v_pk_add_f32 v[172:173], v[172:173], v[204:205]
    v_pk_add_f32 v[174:175], v[174:175], v[206:207]
    v_pk_add_f32 v[176:177], v[176:177], v[208:209]
    v_pk_add_f32 v[178:179], v[178:179], v[210:211]
    s_waitcnt lgkmcnt(0)
    v_pk_add_f32 v[168:169], v[168:169], v[216:217]
    v_pk_add_f32 v[170:171], v[170:171], v[218:219]
    v_pk_add_f32 v[172:173], v[172:173], v[220:221]
    v_pk_add_f32 v[174:175], v[174:175], v[222:223]
    v_pk_add_f32 v[176:177], v[176:177], v[224:225]
    v_pk_add_f32 v[178:179], v[178:179], v[226:227]
    v_rcp_f32 v10, v178
    v_add_f32 v162, s24, v162
    v_mul_f32 v10, v10, v13
    v_pk_mul_f32 v[168:169], v[168:169], v[10:11] op_sel_hi:[1,0]
    v_pk_mul_f32 v[170:171], v[170:171], v[10:11] op_sel_hi:[1,0]
    v_pk_mul_f32 v[172:173], v[172:173], v[10:11] op_sel_hi:[1,0]
    v_pk_mul_f32 v[174:175], v[174:175], v[10:11] op_sel_hi:[1,0]
    v_pk_mul_f32 v[176:177], v[176:177], v[10:11] op_sel_hi:[1,0]
    v_cvt_pk_bf16_f32 v184, v168, v169
    v_cvt_pk_bf16_f32 v185, v170, v171
    v_cvt_pk_bf16_f32 v186, v172, v173
    v_cvt_pk_bf16_f32 v187, v174, v175
    v_cvt_pk_bf16_f32 v188, v176, v177
    s_add_u32 s29, s27, 12582912
    buffer_store_dwordx4 v[184:187], v5, s[4:7], s29 offen sc1
    s_add_u32 s29, s28, 17301504
    buffer_store_dword v188, v3, s[4:7], s29 offen sc1
    v_rcp_f32 v10, v162
    v_sub_f32 v13, 1.0, v13
    v_mul_f32 v10, v10, v13
    v_pk_mul_f32 v[152:153], v[152:153], v[10:11] op_sel_hi:[1,0]
    v_pk_mul_f32 v[154:155], v[154:155], v[10:11] op_sel_hi:[1,0]
    v_pk_mul_f32 v[156:157], v[156:157], v[10:11] op_sel_hi:[1,0]
    v_pk_mul_f32 v[158:159], v[158:159], v[10:11] op_sel_hi:[1,0]
    v_pk_mul_f32 v[160:161], v[160:161], v[10:11] op_sel_hi:[1,0]
    v_cvt_pk_bf16_f32 v200, v152, v153
    v_cvt_pk_bf16_f32 v201, v154, v155
    v_cvt_pk_bf16_f32 v202, v156, v157
    v_cvt_pk_bf16_f32 v203, v158, v159
    v_cvt_pk_bf16_f32 v204, v160, v161
    s_add_u32 s29, s27, 14680064
    buffer_store_dwordx4 v[200:203], v5, s[4:7], s29 offen sc1
    s_add_u32 s29, s28, 17563648
    buffer_store_dword v204, v3, s[4:7], s29 offen sc1
    s_load_dwordx2 s[68:69], s[0:1], 56
    s_add_u32 s76, s76, 165888
    s_sub_u32 s15, s76, 331776
    s_cmp_ge_u32 s76, s77
    s_cselect_b32 s76, s15, s76
    s_barrier

    s_mov_b32 s15, s76
    s_add_u32 m0, s78, 0
    s_nop 0
    buffer_load_dwordx4 v54, s[64:67], s15 offen lds
    s_add_u32 m0, s78, 1024
    s_add_u32 s15, s15, 9216
    buffer_load_dwordx4 v54, s[64:67], s15 offen lds
    s_add_u32 m0, s78, 2048
    s_add_u32 s15, s15, 9216
    buffer_load_dwordx4 v54, s[64:67], s15 offen lds
    s_add_u32 m0, s78, 3072
    s_add_u32 s15, s15, 9216
    buffer_load_dwordx4 v54, s[64:67], s15 offen lds
    s_add_u32 m0, s78, 4096
    s_add_u32 s15, s15, 9216
    buffer_load_dwordx4 v54, s[64:67], s15 offen lds
    s_add_u32 m0, s78, 5120
    s_add_u32 s15, s15, 9216
    buffer_load_dwordx4 v54, s[64:67], s15 offen lds
    s_add_u32 m0, s78, 6144
    s_add_u32 s15, s15, 9216
    buffer_load_dwordx4 v54, s[64:67], s15 offen lds
    s_add_u32 m0, s78, 7168
    s_add_u32 s15, s15, 9216
    buffer_load_dwordx4 v54, s[64:67], s15 offen lds
    s_add_u32 m0, s78, 8192
    s_add_u32 s15, s15, 9216
    buffer_load_dwordx4 v54, s[64:67], s15 offen lds
    s_waitcnt vmcnt(9)
    s_barrier
    s_cmp_ge_u32 s8, 4
    s_cbranch_scc1 L_t_helper
    s_cmp_ge_u32 s72, 252
    s_cbranch_scc1 L_k2_end
    s_cmp_lt_u32 s73, 16
    s_cselect_b32 s27, 128, 0
    s_movk_i32 s25, 4096
    s_cselect_b32 s25, s25, 0x40000000
    s_mov_b32 s70, 2359296
    s_mov_b32 s71, 0x00020000
    v_add_u32 v13, s25, v2
    s_mul_i32 s22, s8, 18432
    s_mul_i32 s24, s8, 1048576
    s_lshl_b32 s15, s75, 10
    s_add_u32 s24, s24, s15
    s_add_u32 s24, s24, 12582912
    s_add_u32 s28, s24, 1048576
    s_mul_i32 s15, s79, 131072
    s_add_u32 s24, s24, s15
    s_lshl_b32 s32, s8, 17
    s_lshl_b32 s15, s75, 6
    s_add_u32 s32, s32, s15
    s_add_u32 s32, s32, 17301504
    s_add_u32 s33, s32, 8192
    v_lshrrev_b32 v26, 4, v1
    v_add_u32 v26, s79, v26
    v_and_b32 v26, 7, v26
    v_lshlrev_b32 v26, 14, v26
    v_and_b32 v5, 15, v1
    v_lshl_add_u32 v26, v5, 2, v26
    v_xor_b32 v27, 0x10000, v26
    s_add_u32 s18, s22, 81920
    v_lshrrev_b32 v5, 4, v1
    v_bfe_u32 v6, v1, 2, 2
    v_and_b32 v7, 3, v1
    v_lshrrev_b32 v9, 1, v5
    v_mul_u32_u24 v9, 20, v9
    v_and_b32 v10, 1, v5
    v_lshl_add_u32 v9, v10, 2, v9
    v_add_u32 v9, v9, v6
    v_bfe_u32 v10, v9, 1, 2
    v_xor_b32 v10, s8, v10
    v_lshlrev_b32 v9, 7, v9
    v_lshl_add_u32 v9, v7, 3, v9
    v_add_u32 v9, s18, v9

    v_xor_b32 v11, 0, v10
    v_lshl_add_u32 v14, v11, 5, v9
    v_xor_b32 v18, 64, v14
    v_xor_b32 v11, 1, v10
    v_lshl_add_u32 v15, v11, 5, v9
    v_xor_b32 v19, 64, v15
    v_xor_b32 v11, 2, v10
    v_lshl_add_u32 v16, v11, 5, v9
    v_xor_b32 v20, 64, v16
    v_xor_b32 v11, 3, v10
    v_lshl_add_u32 v17, v11, 5, v9
    v_xor_b32 v21, 64, v17
    v_mul_u32_u24 v9, 36, v5
    v_add_u32 v9, v9, v6
    v_add_u32 v9, 16, v9
    v_bfe_u32 v10, v9, 1, 2
    v_xor_b32 v10, s8, v10
    v_lshlrev_b32 v9, 7, v9
    v_lshl_add_u32 v9, v7, 3, v9
    v_add_u32 v9, s22, v9

    v_xor_b32 v11, 0, v10
    v_lshl_add_u32 v22, v11, 5, v9
    v_add_u32 v11, 81920, v22
    ds_read_b64_tr_b16 v[60:61], v11
    v_xor_b32 v11, 1, v10
    v_lshl_add_u32 v23, v11, 5, v9
    v_add_u32 v11, 81920, v23
    ds_read_b64_tr_b16 v[64:65], v11
    v_xor_b32 v11, 2, v10
    v_lshl_add_u32 v24, v11, 5, v9
    v_add_u32 v11, 81920, v24
    ds_read_b64_tr_b16 v[68:69], v11
    v_xor_b32 v11, 3, v10
    v_lshl_add_u32 v25, v11, 5, v9
    v_add_u32 v11, 81920, v25
    ds_read_b64_tr_b16 v[72:73], v11
    ds_read_b64_tr_b16 v[28:29], v14 offset:0
    ds_read_b64_tr_b16 v[30:31], v14 offset:1024
    ds_read_b64_tr_b16 v[32:33], v15 offset:0
    ds_read_b64_tr_b16 v[34:35], v15 offset:1024
    ds_read_b64_tr_b16 v[36:37], v16 offset:0
    ds_read_b64_tr_b16 v[38:39], v16 offset:1024
    ds_read_b64_tr_b16 v[40:41], v17 offset:0
    ds_read_b64_tr_b16 v[42:43], v17 offset:1024
    s_waitcnt vmcnt(0)
    s_barrier
    buffer_load_dwordx4 v[156:159], v2, s[4:7], s24 offen offset:0 sc1
    buffer_load_dwordx4 v[160:163], v2, s[4:7], s24 offen offset:1024 sc1
    buffer_load_dwordx4 v[164:167], v2, s[4:7], s24 offen offset:2048 sc1
    buffer_load_dwordx4 v[168:171], v2, s[4:7], s24 offen offset:3072 sc1
    buffer_load_dwordx4 v[172:175], v13, s[4:7], s24 offen sc1
    s_add_u32 s24, s24, 131072
    buffer_load_dwordx4 v[176:179], v2, s[4:7], s24 offen offset:0 sc1
    buffer_load_dwordx4 v[180:183], v2, s[4:7], s24 offen offset:1024 sc1
    buffer_load_dwordx4 v[184:187], v2, s[4:7], s24 offen offset:2048 sc1
    buffer_load_dwordx4 v[188:191], v2, s[4:7], s24 offen offset:3072 sc1
    buffer_load_dwordx4 v[192:195], v13, s[4:7], s24 offen sc1
    s_add_u32 s24, s24, 131072
    s_sub_u32 s18, s24, 1048576
    s_cmp_eq_u32 s24, s28
    s_cselect_b32 s24, s18, s24
    ds_read_b64_tr_b16 v[62:63], v22
    ds_read_b64_tr_b16 v[66:67], v23
    ds_read_b64_tr_b16 v[70:71], v24
    ds_read_b64_tr_b16 v[74:75], v25
    buffer_load_dwordx4 v[196:199], v2, s[4:7], s24 offen offset:0 sc1
    buffer_load_dwordx4 v[200:203], v2, s[4:7], s24 offen offset:1024 sc1
    buffer_load_dwordx4 v[204:207], v2, s[4:7], s24 offen offset:2048 sc1
    buffer_load_dwordx4 v[208:211], v2, s[4:7], s24 offen offset:3072 sc1
    buffer_load_dwordx4 v[212:215], v13, s[4:7], s24 offen sc1
    s_add_u32 s24, s24, 131072
    s_waitcnt vmcnt(10) lgkmcnt(0)
    v_mfma_f32_16x16x32_bf16 v[76:79], v[28:31], v[156:159], 0
    ds_read_b64_tr_b16 v[44:45], v18 offset:4608
    v_mfma_f32_16x16x32_bf16 v[80:83], v[32:35], v[156:159], 0
    ds_read_b64_tr_b16 v[46:47], v18 offset:5632
    v_mfma_f32_16x16x32_bf16 v[84:87], v[36:39], v[156:159], 0
    ds_read_b64_tr_b16 v[48:49], v19 offset:4608
    v_mfma_f32_16x16x32_bf16 v[88:91], v[40:43], v[156:159], 0
    ds_read_b64_tr_b16 v[50:51], v19 offset:5632
    v_mfma_f32_16x16x32_bf16 v[92:95], v[28:31], v[160:163], 0
    ds_read_b64_tr_b16 v[52:53], v20 offset:4608
    v_mfma_f32_16x16x32_bf16 v[96:99], v[32:35], v[160:163], 0
    ds_read_b64_tr_b16 v[54:55], v20 offset:5632
    v_mfma_f32_16x16x32_bf16 v[100:103], v[36:39], v[160:163], 0
    ds_read_b64_tr_b16 v[56:57], v21 offset:4608
    v_mfma_f32_16x16x32_bf16 v[104:107], v[40:43], v[160:163], 0
    ds_read_b64_tr_b16 v[58:59], v21 offset:5632
    v_mfma_f32_16x16x32_bf16 v[108:111], v[28:31], v[164:167], 0
    v_mfma_f32_16x16x32_bf16 v[112:115], v[32:35], v[164:167], 0
    v_mfma_f32_16x16x32_bf16 v[116:119], v[36:39], v[164:167], 0
    v_mfma_f32_16x16x32_bf16 v[120:123], v[40:43], v[164:167], 0
    v_mfma_f32_16x16x32_bf16 v[124:127], v[28:31], v[168:171], 0
    v_mfma_f32_16x16x32_bf16 v[128:131], v[32:35], v[168:171], 0
    v_mfma_f32_16x16x32_bf16 v[132:135], v[36:39], v[168:171], 0
    v_mfma_f32_16x16x32_bf16 v[136:139], v[40:43], v[168:171], 0
    v_mfma_f32_16x16x32_bf16 v[140:143], v[28:31], v[172:175], 0
    v_mfma_f32_16x16x32_bf16 v[144:147], v[32:35], v[172:175], 0
    v_mfma_f32_16x16x32_bf16 v[148:151], v[36:39], v[172:175], 0
    v_mfma_f32_16x16x32_bf16 v[152:155], v[40:43], v[172:175], 0
    buffer_load_dwordx4 v[156:159], v2, s[4:7], s24 offen offset:0 sc1
    buffer_load_dwordx4 v[160:163], v2, s[4:7], s24 offen offset:1024 sc1
    buffer_load_dwordx4 v[164:167], v2, s[4:7], s24 offen offset:2048 sc1
    buffer_load_dwordx4 v[168:171], v2, s[4:7], s24 offen offset:3072 sc1
    buffer_load_dwordx4 v[172:175], v13, s[4:7], s24 offen sc1
    s_add_u32 s24, s24, 131072
    s_sub_u32 s18, s24, 1048576
    s_cmp_eq_u32 s24, s28
    s_cselect_b32 s24, s18, s24
    s_waitcnt vmcnt(10) lgkmcnt(0)
    v_mfma_f32_16x16x32_bf16 v[76:79], v[44:47], v[176:179], v[76:79]
    ds_read_b64_tr_b16 v[28:29], v14 offset:9216
    v_mfma_f32_16x16x32_bf16 v[80:83], v[48:51], v[176:179], v[80:83]
    ds_read_b64_tr_b16 v[30:31], v14 offset:10240
    v_mfma_f32_16x16x32_bf16 v[84:87], v[52:55], v[176:179], v[84:87]
    ds_read_b64_tr_b16 v[32:33], v15 offset:9216
    v_mfma_f32_16x16x32_bf16 v[88:91], v[56:59], v[176:179], v[88:91]
    ds_read_b64_tr_b16 v[34:35], v15 offset:10240
    v_mfma_f32_16x16x32_bf16 v[92:95], v[44:47], v[180:183], v[92:95]
    ds_read_b64_tr_b16 v[36:37], v16 offset:9216
    v_mfma_f32_16x16x32_bf16 v[96:99], v[48:51], v[180:183], v[96:99]
    ds_read_b64_tr_b16 v[38:39], v16 offset:10240
    v_mfma_f32_16x16x32_bf16 v[100:103], v[52:55], v[180:183], v[100:103]
    ds_read_b64_tr_b16 v[40:41], v17 offset:9216
    v_mfma_f32_16x16x32_bf16 v[104:107], v[56:59], v[180:183], v[104:107]
    ds_read_b64_tr_b16 v[42:43], v17 offset:10240
    v_mfma_f32_16x16x32_bf16 v[108:111], v[44:47], v[184:187], v[108:111]
    v_mfma_f32_16x16x32_bf16 v[112:115], v[48:51], v[184:187], v[112:115]
    v_mfma_f32_16x16x32_bf16 v[116:119], v[52:55], v[184:187], v[116:119]
    v_mfma_f32_16x16x32_bf16 v[120:123], v[56:59], v[184:187], v[120:123]
    v_mfma_f32_16x16x32_bf16 v[124:127], v[44:47], v[188:191], v[124:127]
    v_mfma_f32_16x16x32_bf16 v[128:131], v[48:51], v[188:191], v[128:131]
    v_mfma_f32_16x16x32_bf16 v[132:135], v[52:55], v[188:191], v[132:135]
    v_mfma_f32_16x16x32_bf16 v[136:139], v[56:59], v[188:191], v[136:139]
    v_mfma_f32_16x16x32_bf16 v[140:143], v[44:47], v[192:195], v[140:143]
    v_mfma_f32_16x16x32_bf16 v[144:147], v[48:51], v[192:195], v[144:147]
    v_mfma_f32_16x16x32_bf16 v[148:151], v[52:55], v[192:195], v[148:151]
    v_mfma_f32_16x16x32_bf16 v[152:155], v[56:59], v[192:195], v[152:155]
    buffer_load_dwordx4 v[176:179], v2, s[4:7], s24 offen offset:0 sc1
    buffer_load_dwordx4 v[180:183], v2, s[4:7], s24 offen offset:1024 sc1
    buffer_load_dwordx4 v[184:187], v2, s[4:7], s24 offen offset:2048 sc1
    buffer_load_dwordx4 v[188:191], v2, s[4:7], s24 offen offset:3072 sc1
    buffer_load_dwordx4 v[192:195], v13, s[4:7], s24 offen sc1
    s_add_u32 s24, s24, 131072
    s_waitcnt vmcnt(10) lgkmcnt(0)
    v_mfma_f32_16x16x32_bf16 v[76:79], v[28:31], v[196:199], v[76:79]
    ds_read_b64_tr_b16 v[44:45], v18 offset:13824
    v_mfma_f32_16x16x32_bf16 v[80:83], v[32:35], v[196:199], v[80:83]
    ds_read_b64_tr_b16 v[46:47], v18 offset:14848
    v_mfma_f32_16x16x32_bf16 v[84:87], v[36:39], v[196:199], v[84:87]
    ds_read_b64_tr_b16 v[48:49], v19 offset:13824
    v_mfma_f32_16x16x32_bf16 v[88:91], v[40:43], v[196:199], v[88:91]
    ds_read_b64_tr_b16 v[50:51], v19 offset:14848
    v_mfma_f32_16x16x32_bf16 v[92:95], v[28:31], v[200:203], v[92:95]
    ds_read_b64_tr_b16 v[52:53], v20 offset:13824
    v_mfma_f32_16x16x32_bf16 v[96:99], v[32:35], v[200:203], v[96:99]
    ds_read_b64_tr_b16 v[54:55], v20 offset:14848
    v_mfma_f32_16x16x32_bf16 v[100:103], v[36:39], v[200:203], v[100:103]
    ds_read_b64_tr_b16 v[56:57], v21 offset:13824
    v_mfma_f32_16x16x32_bf16 v[104:107], v[40:43], v[200:203], v[104:107]
    ds_read_b64_tr_b16 v[58:59], v21 offset:14848
    v_mfma_f32_16x16x32_bf16 v[108:111], v[28:31], v[204:207], v[108:111]
    v_mfma_f32_16x16x32_bf16 v[112:115], v[32:35], v[204:207], v[112:115]
    v_mfma_f32_16x16x32_bf16 v[116:119], v[36:39], v[204:207], v[116:119]
    v_mfma_f32_16x16x32_bf16 v[120:123], v[40:43], v[204:207], v[120:123]
    v_mfma_f32_16x16x32_bf16 v[124:127], v[28:31], v[208:211], v[124:127]
    v_mfma_f32_16x16x32_bf16 v[128:131], v[32:35], v[208:211], v[128:131]
    v_mfma_f32_16x16x32_bf16 v[132:135], v[36:39], v[208:211], v[132:135]
    v_mfma_f32_16x16x32_bf16 v[136:139], v[40:43], v[208:211], v[136:139]
    v_mfma_f32_16x16x32_bf16 v[140:143], v[28:31], v[212:215], v[140:143]
    v_mfma_f32_16x16x32_bf16 v[144:147], v[32:35], v[212:215], v[144:147]
    v_mfma_f32_16x16x32_bf16 v[148:151], v[36:39], v[212:215], v[148:151]
    v_mfma_f32_16x16x32_bf16 v[152:155], v[40:43], v[212:215], v[152:155]
    buffer_load_dwordx4 v[196:199], v2, s[4:7], s24 offen offset:0 sc1
    buffer_load_dwordx4 v[200:203], v2, s[4:7], s24 offen offset:1024 sc1
    buffer_load_dwordx4 v[204:207], v2, s[4:7], s24 offen offset:2048 sc1
    buffer_load_dwordx4 v[208:211], v2, s[4:7], s24 offen offset:3072 sc1
    buffer_load_dwordx4 v[212:215], v13, s[4:7], s24 offen sc1
    s_add_u32 s24, s24, 131072
    s_sub_u32 s18, s24, 1048576
    s_cmp_eq_u32 s24, s28
    s_cselect_b32 s24, s18, s24
    s_waitcnt vmcnt(10) lgkmcnt(0)
    v_mfma_f32_16x16x32_bf16 v[76:79], v[44:47], v[156:159], v[76:79]
    v_subrev_u32 v14, 81920, v14
    v_mfma_f32_16x16x32_bf16 v[80:83], v[48:51], v[156:159], v[80:83]
    v_subrev_u32 v15, 81920, v15
    v_mfma_f32_16x16x32_bf16 v[84:87], v[52:55], v[156:159], v[84:87]
    v_subrev_u32 v16, 81920, v16
    v_mfma_f32_16x16x32_bf16 v[88:91], v[56:59], v[156:159], v[88:91]
    v_subrev_u32 v17, 81920, v17
    v_mfma_f32_16x16x32_bf16 v[92:95], v[44:47], v[160:163], v[92:95]
    v_subrev_u32 v18, 81920, v18
    v_mfma_f32_16x16x32_bf16 v[96:99], v[48:51], v[160:163], v[96:99]
    v_subrev_u32 v19, 81920, v19
    v_mfma_f32_16x16x32_bf16 v[100:103], v[52:55], v[160:163], v[100:103]
    v_subrev_u32 v20, 81920, v20
    v_mfma_f32_16x16x32_bf16 v[104:107], v[56:59], v[160:163], v[104:107]
    v_subrev_u32 v21, 81920, v21
    v_mfma_f32_16x16x32_bf16 v[108:111], v[44:47], v[164:167], v[108:111]
    ds_read_b64_tr_b16 v[28:29], v14 offset:0
    v_mfma_f32_16x16x32_bf16 v[112:115], v[48:51], v[164:167], v[112:115]
    ds_read_b64_tr_b16 v[30:31], v14 offset:1024
    v_mfma_f32_16x16x32_bf16 v[116:119], v[52:55], v[164:167], v[116:119]
    ds_read_b64_tr_b16 v[32:33], v15 offset:0
    v_mfma_f32_16x16x32_bf16 v[120:123], v[56:59], v[164:167], v[120:123]
    ds_read_b64_tr_b16 v[34:35], v15 offset:1024
    v_mfma_f32_16x16x32_bf16 v[124:127], v[44:47], v[168:171], v[124:127]
    ds_read_b64_tr_b16 v[36:37], v16 offset:0
    v_mfma_f32_16x16x32_bf16 v[128:131], v[48:51], v[168:171], v[128:131]
    ds_read_b64_tr_b16 v[38:39], v16 offset:1024
    v_mfma_f32_16x16x32_bf16 v[132:135], v[52:55], v[168:171], v[132:135]
    ds_read_b64_tr_b16 v[40:41], v17 offset:0
    v_mfma_f32_16x16x32_bf16 v[136:139], v[56:59], v[168:171], v[136:139]
    ds_read_b64_tr_b16 v[42:43], v17 offset:1024
    v_mfma_f32_16x16x32_bf16 v[140:143], v[44:47], v[172:175], v[140:143]
    v_mfma_f32_16x16x32_bf16 v[144:147], v[48:51], v[172:175], v[144:147]
    v_mfma_f32_16x16x32_bf16 v[148:151], v[52:55], v[172:175], v[148:151]
    v_mfma_f32_16x16x32_bf16 v[152:155], v[56:59], v[172:175], v[152:155]
    buffer_load_dwordx4 v[156:159], v2, s[4:7], s24 offen offset:0 sc1
    buffer_load_dwordx4 v[160:163], v2, s[4:7], s24 offen offset:1024 sc1
    buffer_load_dwordx4 v[164:167], v2, s[4:7], s24 offen offset:2048 sc1
    buffer_load_dwordx4 v[168:171], v2, s[4:7], s24 offen offset:3072 sc1
    buffer_load_dwordx4 v[172:175], v13, s[4:7], s24 offen sc1
    s_add_u32 s24, s24, 131072
    s_waitcnt vmcnt(10) lgkmcnt(0)
    v_mfma_f32_16x16x32_bf16 v[76:79], v[28:31], v[176:179], v[76:79]
    ds_read_b64_tr_b16 v[44:45], v18 offset:4608
    v_mfma_f32_16x16x32_bf16 v[80:83], v[32:35], v[176:179], v[80:83]
    ds_read_b64_tr_b16 v[46:47], v18 offset:5632
    v_mfma_f32_16x16x32_bf16 v[84:87], v[36:39], v[176:179], v[84:87]
    ds_read_b64_tr_b16 v[48:49], v19 offset:4608
    v_mfma_f32_16x16x32_bf16 v[88:91], v[40:43], v[176:179], v[88:91]
    ds_read_b64_tr_b16 v[50:51], v19 offset:5632
    v_mfma_f32_16x16x32_bf16 v[92:95], v[28:31], v[180:183], v[92:95]
    ds_read_b64_tr_b16 v[52:53], v20 offset:4608
    v_mfma_f32_16x16x32_bf16 v[96:99], v[32:35], v[180:183], v[96:99]
    ds_read_b64_tr_b16 v[54:55], v20 offset:5632
    v_mfma_f32_16x16x32_bf16 v[100:103], v[36:39], v[180:183], v[100:103]
    ds_read_b64_tr_b16 v[56:57], v21 offset:4608
    v_mfma_f32_16x16x32_bf16 v[104:107], v[40:43], v[180:183], v[104:107]
    ds_read_b64_tr_b16 v[58:59], v21 offset:5632
    v_mfma_f32_16x16x32_bf16 v[108:111], v[28:31], v[184:187], v[108:111]
    v_mfma_f32_16x16x32_bf16 v[112:115], v[32:35], v[184:187], v[112:115]
    v_mfma_f32_16x16x32_bf16 v[116:119], v[36:39], v[184:187], v[116:119]
    v_mfma_f32_16x16x32_bf16 v[120:123], v[40:43], v[184:187], v[120:123]
    v_mfma_f32_16x16x32_bf16 v[124:127], v[28:31], v[188:191], v[124:127]
    v_mfma_f32_16x16x32_bf16 v[128:131], v[32:35], v[188:191], v[128:131]
    v_mfma_f32_16x16x32_bf16 v[132:135], v[36:39], v[188:191], v[132:135]
    v_mfma_f32_16x16x32_bf16 v[136:139], v[40:43], v[188:191], v[136:139]
    v_mfma_f32_16x16x32_bf16 v[140:143], v[28:31], v[192:195], v[140:143]
    v_mfma_f32_16x16x32_bf16 v[144:147], v[32:35], v[192:195], v[144:147]
    v_mfma_f32_16x16x32_bf16 v[148:151], v[36:39], v[192:195], v[148:151]
    v_mfma_f32_16x16x32_bf16 v[152:155], v[40:43], v[192:195], v[152:155]
    buffer_load_dwordx4 v[176:179], v2, s[4:7], s24 offen offset:0 sc1
    buffer_load_dwordx4 v[180:183], v2, s[4:7], s24 offen offset:1024 sc1
    buffer_load_dwordx4 v[184:187], v2, s[4:7], s24 offen offset:2048 sc1
    buffer_load_dwordx4 v[188:191], v2, s[4:7], s24 offen offset:3072 sc1
    buffer_load_dwordx4 v[192:195], v13, s[4:7], s24 offen sc1
    s_waitcnt vmcnt(10) lgkmcnt(0)
    v_mfma_f32_16x16x32_bf16 v[76:79], v[44:47], v[196:199], v[76:79]
    ds_read_b64_tr_b16 v[28:29], v14 offset:9216
    v_mfma_f32_16x16x32_bf16 v[80:83], v[48:51], v[196:199], v[80:83]
    ds_read_b64_tr_b16 v[30:31], v14 offset:10240
    v_mfma_f32_16x16x32_bf16 v[84:87], v[52:55], v[196:199], v[84:87]
    ds_read_b64_tr_b16 v[32:33], v15 offset:9216
    v_mfma_f32_16x16x32_bf16 v[88:91], v[56:59], v[196:199], v[88:91]
    ds_read_b64_tr_b16 v[34:35], v15 offset:10240
    v_mfma_f32_16x16x32_bf16 v[92:95], v[44:47], v[200:203], v[92:95]
    ds_read_b64_tr_b16 v[36:37], v16 offset:9216
    v_mfma_f32_16x16x32_bf16 v[96:99], v[48:51], v[200:203], v[96:99]
    ds_read_b64_tr_b16 v[38:39], v16 offset:10240
    v_mfma_f32_16x16x32_bf16 v[100:103], v[52:55], v[200:203], v[100:103]
    ds_read_b64_tr_b16 v[40:41], v17 offset:9216
    v_mfma_f32_16x16x32_bf16 v[104:107], v[56:59], v[200:203], v[104:107]
    ds_read_b64_tr_b16 v[42:43], v17 offset:10240
    v_mfma_f32_16x16x32_bf16 v[108:111], v[44:47], v[204:207], v[108:111]
    v_mfma_f32_16x16x32_bf16 v[112:115], v[48:51], v[204:207], v[112:115]
    v_mfma_f32_16x16x32_bf16 v[116:119], v[52:55], v[204:207], v[116:119]
    v_mfma_f32_16x16x32_bf16 v[120:123], v[56:59], v[204:207], v[120:123]
    v_mfma_f32_16x16x32_bf16 v[124:127], v[44:47], v[208:211], v[124:127]
    v_mfma_f32_16x16x32_bf16 v[128:131], v[48:51], v[208:211], v[128:131]
    v_mfma_f32_16x16x32_bf16 v[132:135], v[52:55], v[208:211], v[132:135]
    v_mfma_f32_16x16x32_bf16 v[136:139], v[56:59], v[208:211], v[136:139]
    v_mfma_f32_16x16x32_bf16 v[140:143], v[44:47], v[212:215], v[140:143]
    v_mfma_f32_16x16x32_bf16 v[144:147], v[48:51], v[212:215], v[144:147]
    v_mfma_f32_16x16x32_bf16 v[148:151], v[52:55], v[212:215], v[148:151]
    v_mfma_f32_16x16x32_bf16 v[152:155], v[56:59], v[212:215], v[152:155]
    buffer_load_dword v196, v26, s[4:7], s32 offen offset:0 sc1
    buffer_load_dword v200, v26, s[4:7], s32 offen offset:64 sc1
    buffer_load_dword v204, v26, s[4:7], s32 offen offset:128 sc1
    buffer_load_dword v208, v26, s[4:7], s32 offen offset:192 sc1
    buffer_load_dword v212, v26, s[4:7], s32 offen offset:256 sc1
    buffer_load_dword v197, v26, s[4:7], s33 offen offset:0 sc1
    buffer_load_dword v201, v26, s[4:7], s33 offen offset:64 sc1
    buffer_load_dword v205, v26, s[4:7], s33 offen offset:128 sc1
    buffer_load_dword v209, v26, s[4:7], s33 offen offset:192 sc1
    buffer_load_dword v213, v26, s[4:7], s33 offen offset:256 sc1
    buffer_load_dword v198, v27, s[4:7], s32 offen offset:0 sc1
    buffer_load_dword v202, v27, s[4:7], s32 offen offset:64 sc1
    buffer_load_dword v206, v27, s[4:7], s32 offen offset:128 sc1
    buffer_load_dword v210, v27, s[4:7], s32 offen offset:192 sc1
    buffer_load_dword v214, v27, s[4:7], s32 offen offset:256 sc1
    buffer_load_dword v199, v27, s[4:7], s33 offen offset:0 sc1
    buffer_load_dword v203, v27, s[4:7], s33 offen offset:64 sc1
    buffer_load_dword v207, v27, s[4:7], s33 offen offset:128 sc1
    buffer_load_dword v211, v27, s[4:7], s33 offen offset:192 sc1
    buffer_load_dword v215, v27, s[4:7], s33 offen offset:256 sc1
    s_waitcnt vmcnt(25) lgkmcnt(0)
    v_mfma_f32_16x16x32_bf16 v[76:79], v[28:31], v[156:159], v[76:79]
    ds_read_b64_tr_b16 v[44:45], v18 offset:13824
    v_mfma_f32_16x16x32_bf16 v[80:83], v[32:35], v[156:159], v[80:83]
    ds_read_b64_tr_b16 v[46:47], v18 offset:14848
    v_mfma_f32_16x16x32_bf16 v[84:87], v[36:39], v[156:159], v[84:87]
    ds_read_b64_tr_b16 v[48:49], v19 offset:13824
    v_mfma_f32_16x16x32_bf16 v[88:91], v[40:43], v[156:159], v[88:91]
    ds_read_b64_tr_b16 v[50:51], v19 offset:14848
    v_mfma_f32_16x16x32_bf16 v[92:95], v[28:31], v[160:163], v[92:95]
    ds_read_b64_tr_b16 v[52:53], v20 offset:13824
    v_mfma_f32_16x16x32_bf16 v[96:99], v[32:35], v[160:163], v[96:99]
    ds_read_b64_tr_b16 v[54:55], v20 offset:14848
    v_mfma_f32_16x16x32_bf16 v[100:103], v[36:39], v[160:163], v[100:103]
    ds_read_b64_tr_b16 v[56:57], v21 offset:13824
    v_mfma_f32_16x16x32_bf16 v[104:107], v[40:43], v[160:163], v[104:107]
    ds_read_b64_tr_b16 v[58:59], v21 offset:14848
    v_mfma_f32_16x16x32_bf16 v[108:111], v[28:31], v[164:167], v[108:111]
    v_mfma_f32_16x16x32_bf16 v[112:115], v[32:35], v[164:167], v[112:115]
    v_mfma_f32_16x16x32_bf16 v[116:119], v[36:39], v[164:167], v[116:119]
    v_mfma_f32_16x16x32_bf16 v[120:123], v[40:43], v[164:167], v[120:123]
    v_mfma_f32_16x16x32_bf16 v[124:127], v[28:31], v[168:171], v[124:127]
    v_mfma_f32_16x16x32_bf16 v[128:131], v[32:35], v[168:171], v[128:131]
    v_mfma_f32_16x16x32_bf16 v[132:135], v[36:39], v[168:171], v[132:135]
    v_mfma_f32_16x16x32_bf16 v[136:139], v[40:43], v[168:171], v[136:139]
    v_mfma_f32_16x16x32_bf16 v[140:143], v[28:31], v[172:175], v[140:143]
    v_mfma_f32_16x16x32_bf16 v[144:147], v[32:35], v[172:175], v[144:147]
    v_mfma_f32_16x16x32_bf16 v[148:151], v[36:39], v[172:175], v[148:151]
    v_mfma_f32_16x16x32_bf16 v[152:155], v[40:43], v[172:175], v[152:155]
    s_waitcnt vmcnt(20) lgkmcnt(0)
    v_mfma_f32_16x16x32_bf16 v[76:79], v[44:47], v[176:179], v[76:79]
    v_mfma_f32_16x16x32_bf16 v[80:83], v[48:51], v[176:179], v[80:83]
    v_mfma_f32_16x16x32_bf16 v[84:87], v[52:55], v[176:179], v[84:87]
    v_mfma_f32_16x16x32_bf16 v[88:91], v[56:59], v[176:179], v[88:91]
    v_mfma_f32_16x16x32_bf16 v[92:95], v[44:47], v[180:183], v[92:95]
    v_mfma_f32_16x16x32_bf16 v[96:99], v[48:51], v[180:183], v[96:99]
    v_mfma_f32_16x16x32_bf16 v[100:103], v[52:55], v[180:183], v[100:103]
    v_mfma_f32_16x16x32_bf16 v[104:107], v[56:59], v[180:183], v[104:107]
    v_mfma_f32_16x16x32_bf16 v[108:111], v[44:47], v[184:187], v[108:111]
    v_mfma_f32_16x16x32_bf16 v[112:115], v[48:51], v[184:187], v[112:115]
    v_mfma_f32_16x16x32_bf16 v[116:119], v[52:55], v[184:187], v[116:119]
    v_mfma_f32_16x16x32_bf16 v[120:123], v[56:59], v[184:187], v[120:123]
    v_mfma_f32_16x16x32_bf16 v[124:127], v[44:47], v[188:191], v[124:127]
    v_mfma_f32_16x16x32_bf16 v[128:131], v[48:51], v[188:191], v[128:131]
    v_mfma_f32_16x16x32_bf16 v[132:135], v[52:55], v[188:191], v[132:135]
    v_mfma_f32_16x16x32_bf16 v[136:139], v[56:59], v[188:191], v[136:139]
    v_mfma_f32_16x16x32_bf16 v[140:143], v[44:47], v[192:195], v[140:143]
    v_mfma_f32_16x16x32_bf16 v[144:147], v[48:51], v[192:195], v[144:147]
    v_mfma_f32_16x16x32_bf16 v[148:151], v[52:55], v[192:195], v[148:151]
    v_mfma_f32_16x16x32_bf16 v[152:155], v[56:59], v[192:195], v[152:155]
    s_waitcnt vmcnt(0) lgkmcnt(0)
    v_mfma_f32_16x16x32_bf16 v[76:79], v[60:63], v[196:199], v[76:79]
    v_mfma_f32_16x16x32_bf16 v[80:83], v[64:67], v[196:199], v[80:83]
    v_mfma_f32_16x16x32_bf16 v[84:87], v[68:71], v[196:199], v[84:87]
    v_mfma_f32_16x16x32_bf16 v[88:91], v[72:75], v[196:199], v[88:91]
    v_mfma_f32_16x16x32_bf16 v[92:95], v[60:63], v[200:203], v[92:95]
    v_mfma_f32_16x16x32_bf16 v[96:99], v[64:67], v[200:203], v[96:99]
    v_mfma_f32_16x16x32_bf16 v[100:103], v[68:71], v[200:203], v[100:103]
    v_mfma_f32_16x16x32_bf16 v[104:107], v[72:75], v[200:203], v[104:107]
    v_mfma_f32_16x16x32_bf16 v[108:111], v[60:63], v[204:207], v[108:111]
    v_mfma_f32_16x16x32_bf16 v[112:115], v[64:67], v[204:207], v[112:115]
    v_mfma_f32_16x16x32_bf16 v[116:119], v[68:71], v[204:207], v[116:119]
    v_mfma_f32_16x16x32_bf16 v[120:123], v[72:75], v[204:207], v[120:123]
    v_mfma_f32_16x16x32_bf16 v[124:127], v[60:63], v[208:211], v[124:127]
    v_mfma_f32_16x16x32_bf16 v[128:131], v[64:67], v[208:211], v[128:131]
    v_mfma_f32_16x16x32_bf16 v[132:135], v[68:71], v[208:211], v[132:135]
    v_mfma_f32_16x16x32_bf16 v[136:139], v[72:75], v[208:211], v[136:139]
    v_mfma_f32_16x16x32_bf16 v[140:143], v[60:63], v[212:215], v[140:143]
    v_mfma_f32_16x16x32_bf16 v[144:147], v[64:67], v[212:215], v[144:147]
    v_mfma_f32_16x16x32_bf16 v[148:151], v[68:71], v[212:215], v[148:151]
    v_mfma_f32_16x16x32_bf16 v[152:155], v[72:75], v[212:215], v[152:155]
    v_add_u32 v6, s22, v2
    s_xor_b32 s15, s8, 1
    s_mul_i32 s15, s15, 18432
    v_add_u32 v7, s15, v2
    s_xor_b32 s15, s8, 2
    s_mul_i32 s15, s15, 18432
    v_add_u32 v8, s15, v2
    s_xor_b32 s15, s8, 3
    s_mul_i32 s15, s15, 18432
    v_add_u32 v9, s15, v2
    v_and_b32 v10, 15, v1
    v_mul_u32_u24 v10, 144, v10
    v_lshrrev_b32 v11, 4, v1
    v_lshl_add_u32 v10, v11, 3, v10
    s_lshl_b32 s15, s8, 5
    s_add_u32 s15, s15, 81920
    v_add_u32 v10, s15, v10

    ds_write_b128 v6, v[80:83] offset:0
    ds_write_b128 v6, v[84:87] offset:5120
    ds_write_b128 v6, v[88:91] offset:10240
    ds_write_b128 v6, v[96:99] offset:1024
    ds_write_b128 v6, v[100:103] offset:6144
    ds_write_b128 v6, v[104:107] offset:11264
    ds_write_b128 v6, v[112:115] offset:2048
    ds_write_b128 v6, v[116:119] offset:7168
    ds_write_b128 v6, v[120:123] offset:12288
    ds_write_b128 v6, v[128:131] offset:3072
    ds_write_b128 v6, v[132:135] offset:8192
    ds_write_b128 v6, v[136:139] offset:13312
    ds_write_b128 v6, v[144:147] offset:4096
    ds_write_b128 v6, v[148:151] offset:9216
    ds_write_b128 v6, v[152:155] offset:14336
    v_lshrrev_b32 v12, 3, v0
    v_add_u32 v11, v12, v0
    v_lshlrev_b32 v11, 4, v11
    v_add_u32 v11, 81920, v11
    v_mul_u32_u24 v12, 1152, v12
    v_and_b32 v5, 7, v0
    v_lshl_add_u32 v12, v5, 4, v12
    s_mul_i32 s15, s75, 18432
    s_lshl_b32 s16, s74, 7
    s_add_u32 s15, s15, s16
    s_add_u32 s16, s15, 36864
    s_add_u32 s17, s15, 73728
    s_waitcnt lgkmcnt(0)
    s_barrier

    ds_read_b128 v[156:159], v7 offset:0
    ds_read_b128 v[160:163], v8 offset:5120
    ds_read_b128 v[164:167], v9 offset:10240
    ds_read_b128 v[168:171], v7 offset:1024
    ds_read_b128 v[172:175], v8 offset:6144
    ds_read_b128 v[176:179], v9 offset:11264
    ds_read_b128 v[180:183], v7 offset:2048
    ds_read_b128 v[184:187], v8 offset:7168
    ds_read_b128 v[188:191], v9 offset:12288
    ds_read_b128 v[192:195], v7 offset:3072
    ds_read_b128 v[196:199], v8 offset:8192
    ds_read_b128 v[200:203], v9 offset:13312
    ds_read_b128 v[204:207], v7 offset:4096
    ds_read_b128 v[208:211], v8 offset:9216
    ds_read_b128 v[212:215], v9 offset:14336
    s_waitcnt lgkmcnt(12)
    v_pk_add_f32 v[76:77], v[76:77], v[156:157]
    v_pk_add_f32 v[78:79], v[78:79], v[158:159]
    v_pk_add_f32 v[160:161], v[160:161], v[164:165]
    v_pk_add_f32 v[162:163], v[162:163], v[166:167]
    v_pk_add_f32 v[76:77], v[76:77], v[160:161]
    v_pk_add_f32 v[78:79], v[78:79], v[162:163]
    v_cvt_pk_bf16_f32 v28, v76, v77
    v_cvt_pk_bf16_f32 v29, v78, v79
    s_waitcnt lgkmcnt(9)
    v_pk_add_f32 v[92:93], v[92:93], v[168:169]
    v_pk_add_f32 v[94:95], v[94:95], v[170:171]
    v_pk_add_f32 v[172:173], v[172:173], v[176:177]
    v_pk_add_f32 v[174:175], v[174:175], v[178:179]
    v_pk_add_f32 v[92:93], v[92:93], v[172:173]
    v_pk_add_f32 v[94:95], v[94:95], v[174:175]
    v_cvt_pk_bf16_f32 v30, v92, v93
    v_cvt_pk_bf16_f32 v31, v94, v95
    s_waitcnt lgkmcnt(6)
    v_pk_add_f32 v[108:109], v[108:109], v[180:181]
    v_pk_add_f32 v[110:111], v[110:111], v[182:183]
    v_pk_add_f32 v[184:185], v[184:185], v[188:189]
    v_pk_add_f32 v[186:187], v[186:187], v[190:191]
    v_pk_add_f32 v[108:109], v[108:109], v[184:185]
    v_pk_add_f32 v[110:111], v[110:111], v[186:187]
    v_cvt_pk_bf16_f32 v32, v108, v109
    v_cvt_pk_bf16_f32 v33, v110, v111
    s_waitcnt lgkmcnt(3)
    v_pk_add_f32 v[124:125], v[124:125], v[192:193]
    v_pk_add_f32 v[126:127], v[126:127], v[194:195]
    v_pk_add_f32 v[196:197], v[196:197], v[200:201]
    v_pk_add_f32 v[198:199], v[198:199], v[202:203]
    v_pk_add_f32 v[124:125], v[124:125], v[196:197]
    v_pk_add_f32 v[126:127], v[126:127], v[198:199]
    v_cvt_pk_bf16_f32 v34, v124, v125
    v_cvt_pk_bf16_f32 v35, v126, v127
    s_waitcnt lgkmcnt(0)
    v_pk_add_f32 v[140:141], v[140:141], v[204:205]
    v_pk_add_f32 v[142:143], v[142:143], v[206:207]
    v_pk_add_f32 v[208:209], v[208:209], v[212:213]
    v_pk_add_f32 v[210:211], v[210:211], v[214:215]
    v_pk_add_f32 v[140:141], v[140:141], v[208:209]
    v_pk_add_f32 v[142:143], v[142:143], v[210:211]
    v_cvt_pk_bf16_f32 v36, v140, v141
    v_cvt_pk_bf16_f32 v37, v142, v143
    ds_write_b64 v10, v[28:29] offset:0
    ds_write_b64 v10, v[30:31] offset:2304
    ds_write_b64 v10, v[32:33] offset:4608
    ds_write_b64 v10, v[34:35] offset:6912
    ds_write_b64 v10, v[36:37] offset:9216
    v_cmp_gt_u32 vcc, s27, v0
    s_waitcnt lgkmcnt(0)
    s_barrier
    ds_read_b128 v[156:159], v11 offset:0
    ds_read_b128 v[160:163], v11 offset:4608
    ds_read_b128 v[164:167], v11 offset:9216
    s_waitcnt lgkmcnt(2)
    buffer_store_dwordx4 v[156:159], v12, s[68:71], s15 offen nt
    s_waitcnt lgkmcnt(1)
    buffer_store_dwordx4 v[160:163], v12, s[68:71], s16 offen nt
    s_waitcnt lgkmcnt(0)
    s_and_saveexec_b64 s[30:31], vcc
    s_cbranch_execz L_t_skip
    buffer_store_dwordx4 v[164:167], v12, s[68:71], s17 offen nt
L_t_skip:
    s_endpgm
L_t_helper:
    s_cmp_lg_u32 s8, 4
    s_cbranch_scc1 L_t_h2
    s_lshl_b32 s15, s10, 10
    s_lshl_b32 s16, s9, 2
    s_add_u32 s15, s15, s16
    s_add_u32 s15, s15, 7995392
    v_lshlrev_b32 v5, 7, v1
    v_mov_b32 v6, 1
    s_mov_b64 exec, 255
    buffer_store_dword v6, v5, s[4:7], s15 offen sc1
    s_mov_b64 exec, -1
    s_cmp_ge_u32 s72, 252
    s_cbranch_scc1 L_k2_end

    s_lshr_b32 s15, s75, 4
    s_add_u32 s16, s75, 4
    s_min_u32 s16, s16, 127
    s_lshr_b32 s16, s16, 4
    s_sub_u32 s16, s16, s15
    s_lshl_b32 s16, s16, 10
    s_lshl_b32 s15, s15, 10
    s_and_b32 s17, s2, 7
    s_lshl_b32 s17, s17, 7
    s_add_u32 s15, s15, s17
    s_add_u32 s15, s15, 7995392
    v_lshrrev_b32 v5, 5, v1
    v_mul_lo_u32 v5, s16, v5
    v_and_b32 v7, 31, v1
    v_lshl_add_u32 v5, v7, 2, v5
    s_mov_b32 s17, 0

L_t_poll:
    s_sleep 8
    buffer_load_dword v6, v5, s[4:7], s15 offen sc1
    s_add_u32 s17, s17, 1
    s_waitcnt vmcnt(0)
    v_cmp_ne_u32 vcc, 1, v6
    s_cmp_gt_u32 s17, 0x40000
    s_cbranch_scc1 L_t_go
    s_nop 2
    s_cbranch_vccnz L_t_poll

L_t_go:
    s_barrier
    s_endpgm
L_t_h2:
    s_waitcnt vmcnt(0)
    s_endpgm
L_k2_end:
    s_endpgm
L_k2_fallback:
    s_waitcnt lgkmcnt(0) vmcnt(0)
    s_mov_b32 s26, 1
    v_mov_b32 v73, 0
    v_mov_b32 v42, 0xff800000
    v_mov_b32 v75, 0
    v_mov_b32 v43, 0xff800000
    v_mov_b32 v77, 0
    v_mov_b32 v44, 0xff800000
    v_mov_b32 v79, 0
    v_mov_b32 v45, 0xff800000
    s_mov_b32 s13, s31
    s_mov_b32 s14, s32
    s_mov_b32 s19, 0
L_k2_fb_loop:
    buffer_load_dwordx4 v[92:95], v2, s[4:7], s13 offen
    buffer_load_dword v102, v3, s[4:7], s14 offen
    s_waitcnt vmcnt(0)
    v_mfma_f32_32x32x16_bf16 v[136:151], v[92:95], v[56:59], 0
    v_mfma_f32_32x32x8_bf16 v[136:151], v[102:103], v[72:73], v[136:151]
    s_nop 15
    v_max3_f32 v42, v42, v136, v137
    v_max3_f32 v42, v42, v138, v139
    v_max3_f32 v42, v42, v140, v141
    v_max3_f32 v42, v42, v142, v143
    v_max3_f32 v42, v42, v144, v145
    v_max3_f32 v42, v42, v146, v147
    v_max3_f32 v42, v42, v148, v149
    v_max3_f32 v42, v42, v150, v151
    v_mfma_f32_32x32x16_bf16 v[136:151], v[92:95], v[60:63], 0
    v_mfma_f32_32x32x8_bf16 v[136:151], v[102:103], v[74:75], v[136:151]
    s_nop 15
    v_max3_f32 v43, v43, v136, v137
    v_max3_f32 v43, v43, v138, v139
    v_max3_f32 v43, v43, v140, v141
    v_max3_f32 v43, v43, v142, v143
    v_max3_f32 v43, v43, v144, v145
    v_max3_f32 v43, v43, v146, v147
    v_max3_f32 v43, v43, v148, v149
    v_max3_f32 v43, v43, v150, v151
    v_mfma_f32_32x32x16_bf16 v[136:151], v[92:95], v[64:67], 0
    v_mfma_f32_32x32x8_bf16 v[136:151], v[102:103], v[76:77], v[136:151]
    s_nop 15
    v_max3_f32 v44, v44, v136, v137
    v_max3_f32 v44, v44, v138, v139
    v_max3_f32 v44, v44, v140, v141
    v_max3_f32 v44, v44, v142, v143
    v_max3_f32 v44, v44, v144, v145
    v_max3_f32 v44, v44, v146, v147
    v_max3_f32 v44, v44, v148, v149
    v_max3_f32 v44, v44, v150, v151
    v_mfma_f32_32x32x16_bf16 v[136:151], v[92:95], v[68:71], 0
    v_mfma_f32_32x32x8_bf16 v[136:151], v[102:103], v[78:79], v[136:151]
    s_nop 15
    v_max3_f32 v45, v45, v136, v137
    v_max3_f32 v45, v45, v138, v139
    v_max3_f32 v45, v45, v140, v141
    v_max3_f32 v45, v45, v142, v143
    v_max3_f32 v45, v45, v144, v145
    v_max3_f32 v45, v45, v146, v147
    v_max3_f32 v45, v45, v148, v149
    v_max3_f32 v45, v45, v150, v151
    s_add_u32 s13, s13, 1024
    s_add_u32 s14, s14, 128
    s_add_u32 s19, s19, 1
    s_cmp_lt_u32 s19, 16
    s_cbranch_scc1 L_k2_fb_loop
    v_and_b32 v5, 31, v1
    v_lshlrev_b32 v5, 2, v5

    v_mov_b32 v46, v42
    s_nop 1
    v_permlane32_swap_b32 v46, v42
    s_nop 1
    v_max_f32 v42, v42, v46
    s_xor_b32 s27, s12, 0
    s_lshl_b32 s28, s11, 2
    s_add_u32 s27, s27, s28
    s_lshl_b32 s27, s27, 9
    v_add_u32 v184, s27, v5
    s_lshl_b32 s28, s12, 7
    v_add_u32 v188, s28, v184
    ds_write_b32 v188, v42 offset:2048
    v_mov_b32 v46, v43
    s_nop 1
    v_permlane32_swap_b32 v46, v43
    s_nop 1
    v_max_f32 v43, v43, v46
    s_xor_b32 s27, s12, 1
    s_lshl_b32 s28, s11, 2
    s_add_u32 s27, s27, s28
    s_lshl_b32 s27, s27, 9
    v_add_u32 v185, s27, v5
    s_lshl_b32 s28, s12, 7
    v_add_u32 v189, s28, v185
    ds_write_b32 v189, v43 offset:2048
    v_mov_b32 v46, v44
    s_nop 1
    v_permlane32_swap_b32 v46, v44
    s_nop 1
    v_max_f32 v44, v44, v46
    s_xor_b32 s27, s12, 2
    s_lshl_b32 s28, s11, 2
    s_add_u32 s27, s27, s28
    s_lshl_b32 s27, s27, 9
    v_add_u32 v186, s27, v5
    s_lshl_b32 s28, s12, 7
    v_add_u32 v190, s28, v186
    ds_write_b32 v190, v44 offset:2048
    v_mov_b32 v46, v45
    s_nop 1
    v_permlane32_swap_b32 v46, v45
    s_nop 1
    v_max_f32 v45, v45, v46
    s_xor_b32 s27, s12, 3
    s_lshl_b32 s28, s11, 2
    s_add_u32 s27, s27, s28
    s_lshl_b32 s27, s27, 9
    v_add_u32 v187, s27, v5
    s_lshl_b32 s28, s12, 7
    v_add_u32 v191, s28, v187
    ds_write_b32 v191, v45 offset:2048
    s_waitcnt lgkmcnt(0)
    s_barrier
    ds_read_b32 v200, v184 offset:2048
    ds_read_b32 v201, v184 offset:2176
    ds_read_b32 v202, v184 offset:2304
    ds_read_b32 v203, v184 offset:2432
    ds_read_b32 v204, v185 offset:2048
    ds_read_b32 v205, v185 offset:2176
    ds_read_b32 v206, v185 offset:2304
    ds_read_b32 v207, v185 offset:2432
    ds_read_b32 v208, v186 offset:2048
    ds_read_b32 v209, v186 offset:2176
    ds_read_b32 v210, v186 offset:2304
    ds_read_b32 v211, v186 offset:2432
    ds_read_b32 v212, v187 offset:2048
    ds_read_b32 v213, v187 offset:2176
    ds_read_b32 v214, v187 offset:2304
    ds_read_b32 v215, v187 offset:2432
    buffer_load_dwordx4 v[80:83], v2, s[4:7], s31 offen offset:0
    buffer_load_dword v96, v3, s[4:7], s32 offen offset:0
    s_mov_b64 exec, s[20:21]
    buffer_load_dwordx4 v[104:107], v4, s[4:7], s33 offen offset:0
    buffer_load_dwordx4 v[108:111], v4, s[4:7], s33 offen offset:576
    s_mov_b64 exec, -1
    s_waitcnt lgkmcnt(0)
    v_max3_f32 v42, v200, v201, v202
    v_max_f32 v42, v42, v203
    v_cvt_pk_bf16_f32 v50, -v42, -v42
    v_lshlrev_b32 v50, 16, v50
    v_add_f32 v51, v42, v50
    v_cvt_pk_bf16_f32 v52, v50, -v51
    v_and_b32 v53, 0xffff0000, v52
    v_add_f32 v51, v51, v53
    v_cvt_pk_bf16_f32 v53, -v51, 0
    v_cndmask_b32 v73, v53, v52, s[34:35]
    v_max3_f32 v43, v204, v205, v206
    v_max_f32 v43, v43, v207
    v_cvt_pk_bf16_f32 v50, -v43, -v43
    v_lshlrev_b32 v50, 16, v50
    v_add_f32 v51, v43, v50
    v_cvt_pk_bf16_f32 v52, v50, -v51
    v_and_b32 v53, 0xffff0000, v52
    v_add_f32 v51, v51, v53
    v_cvt_pk_bf16_f32 v53, -v51, 0
    v_cndmask_b32 v75, v53, v52, s[34:35]
    v_max3_f32 v44, v208, v209, v210
    v_max_f32 v44, v44, v211
    v_cvt_pk_bf16_f32 v50, -v44, -v44
    v_lshlrev_b32 v50, 16, v50
    v_add_f32 v51, v44, v50
    v_cvt_pk_bf16_f32 v52, v50, -v51
    v_and_b32 v53, 0xffff0000, v52
    v_add_f32 v51, v51, v53
    v_cvt_pk_bf16_f32 v53, -v51, 0
    v_cndmask_b32 v77, v53, v52, s[34:35]
    v_max3_f32 v45, v212, v213, v214
    v_max_f32 v45, v45, v215
    v_cvt_pk_bf16_f32 v50, -v45, -v45
    v_lshlrev_b32 v50, 16, v50
    v_add_f32 v51, v45, v50
    v_cvt_pk_bf16_f32 v52, v50, -v51
    v_and_b32 v53, 0xffff0000, v52
    v_add_f32 v51, v51, v53
    v_cvt_pk_bf16_f32 v53, -v51, 0
    v_cndmask_b32 v79, v53, v52, s[34:35]
    s_branch L_k2_main
.section .rodata,"a"
.p2align 6
.amdhsa_kernel k1_kernel
  .amdhsa_next_free_vgpr 248
  .amdhsa_next_free_sgpr 80
  .amdhsa_accum_offset 248
  .amdhsa_group_segment_fixed_size 0
  .amdhsa_kernarg_size 80
  .amdhsa_user_sgpr_count 2
  .amdhsa_user_sgpr_kernarg_segment_ptr 1
  .amdhsa_system_sgpr_workgroup_id_x 1
.end_amdhsa_kernel
.p2align 6
.amdhsa_kernel k2_kernel
  .amdhsa_next_free_vgpr 256
  .amdhsa_next_free_sgpr 96
  .amdhsa_accum_offset 256
  .amdhsa_group_segment_fixed_size 0
  .amdhsa_kernarg_size 80
  .amdhsa_user_sgpr_count 2
  .amdhsa_user_sgpr_kernarg_segment_ptr 1
  .amdhsa_system_sgpr_workgroup_id_x 1
.end_amdhsa_kernel
```
